```python
import torch

def _softmax(x, axis=-1):
    return torch.softmax(x, dim=axis)
def _gelu(x):
    return torch.nn.functional.gelu(x, approximate="tanh")
def _silu(x):
    return torch.nn.functional.silu(x)
def _sigmoid(x):
    return torch.sigmoid(x)
def _layernorm(x, axis=-1, eps=1e-5):
    m = x.mean(dim=axis, keepdim=True)
    v = x.var(dim=axis, keepdim=True, unbiased=False)
    return (x - m) / torch.sqrt(v + eps)
def _scatter_add(tgt, idx, src, axis=0):
    return tgt.clone().index_add_(axis, idx, src)
def _segment_sum(src, seg, n):
    out = torch.zeros((n,) + src.shape[1:], dtype=src.dtype)
    return out.index_add_(0, seg, src)
def _pad(x, pw):
    flat = tuple(v for pair in reversed(pw) for v in pair)
    return torch.nn.functional.pad(x, flat)

kernel_name = 'recurrent_scan__gqa_block_cached__dense_activation_relu__prompt'

def setup_inputs():

    _w = (lambda a: (lambda t: t.to(torch.bfloat16) if t.is_floating_point() else t)(torch.as_tensor(a)))
    def _A_setup():
        B, Sq, D = 1, 2048, 512
        Hq, Hkv, Sk, Dh = 32, 8, 2048, 128
        assert Hq % Hkv == 0, (Hq, Hkv)
        return {
            "x": _w((lambda *s: torch.randn(*s, dtype=torch.bfloat16) * 0.05)(B, Sq, D)),
            "k_cache": _w((lambda *s: torch.randn(*s, dtype=torch.bfloat16) * 1.6)(B, Hkv, Sk, Dh)),
            "v_cache": _w((lambda *s: torch.randn(*s, dtype=torch.bfloat16) * 0.2)(B, Hkv, Sk, Dh)),
            "wq": _w((lambda *s: torch.randn(*s, dtype=torch.bfloat16) * 1.6)(D, Hq * Dh) * (D ** -0.5)),
            "wo": _w((lambda *s: torch.randn(*s, dtype=torch.bfloat16) * 0.2)(Hq * Dh, D) * ((Hq * Dh) ** -0.5)),
        }
    _A_in = _A_setup()

    def _B_setup():
        B, S, D, Dff = 1, 2048, 512, 1792
        return {
            "x": _w((lambda *s: torch.randn(*s, dtype=torch.bfloat16) * 0.05)(B, S, D)),
            "w1": _w((lambda *s: torch.randn(*s, dtype=torch.bfloat16) * 0.1)(D, Dff)),
            "w2": _w((lambda *s: torch.randn(*s, dtype=torch.bfloat16) * 0.1)(Dff, D)),
        }
    _B_in = _B_setup()

    return {
        "A_x": _A_in["x"],
        "A_k_cache": _A_in["k_cache"],
        "A_v_cache": _A_in["v_cache"],
        "A_wq": _A_in["wq"],
        "A_wo": _A_in["wo"],
        "B_x": _B_in["x"],
        "B_w1": _B_in["w1"],
        "B_w2": _B_in["w2"],
    }

def reference(A_x, A_k_cache, A_v_cache, A_wq, A_wo, B_x, B_w1, B_w2):
    def _A_ref(x, k_cache, v_cache, wq, wo):
        B, Sq, D = x.shape
        Hq, Dh = 32, 128
        Hkv = k_cache.shape[1]
        rep = Hq // Hkv
        q = (lambda x, *d: x.permute(*d))((x @ wq).reshape(B, Sq, Hq, Dh), 0, 2, 1, 3)
        k = (lambda x, n, axis: torch.repeat_interleave(x, n, dim=axis))(k_cache, rep, axis=1)
        v = (lambda x, n, axis: torch.repeat_interleave(x, n, dim=axis))(v_cache, rep, axis=1)
        scores = torch.einsum("bhqd,bhkd->bhqk", q, k) * (Dh ** -0.5)
        p = _softmax(scores, axis=-1)
        o = torch.einsum("bhqk,bhkd->bhqd", p, v)
        return (lambda x, *d: x.permute(*d))(o, 0, 2, 1, 3).reshape(B, Sq, Hq * Dh) @ wo

    def _B_ref(x, w1, w2):
        h = torch.einsum("bsd,df->bsf", x, w1)
        zero = torch.zeros_like(h)
        h = torch.maximum(h, zero)
        return torch.einsum("bsf,fd->bsd", h, w2)

    x = A_x
    xn = _layernorm(x, axis=-1)
    s = _A_ref(xn, A_k_cache, A_v_cache, A_wq, A_wo)
    g = _silu(_B_ref(xn, B_w1, B_w2))
    return x + s * g
```

```asm
; @launch grid=(256,1,1) block=(256,1,1) lds=163840
.amdgcn_target "amdgcn-amd-amdhsa--gfx950"
.text
.globl recurrent_scan__gqa_block_cached__dense_activation_relu__prompt_kernel
.p2align 8
.type recurrent_scan__gqa_block_cached__dense_activation_relu__prompt_kernel,@function
recurrent_scan__gqa_block_cached__dense_activation_relu__prompt_kernel:
  s_cmp_ge_u32 s2, 256
  s_cbranch_scc1 L_main_end
  s_load_dwordx16 s[64:79], s[0:1], 0
  s_load_dwordx2 s[80:81], s[0:1], 80
  s_load_dwordx4 s[84:87], s[0:1], 64
  s_getpc_b64 s[82:83]
L_pc0:
  s_lshr_b32 s50, s2, 3
  s_lshr_b32 s54, s2, 4
  s_and_b32 s40, s2, 6
  s_and_b32 s49, s50, 1
  s_or_b32 s40, s40, s49
  s_lshl_b32 s41, s54, 1
  s_and_b32 s49, s2, 1
  s_or_b32 s41, s41, s49
  s_mul_i32 s49, s50, 2304
  v_lshl_add_u32 v7, v0, 4, s49
  v_min_u32 v7, L_code_end-L_pc0, v7
  global_load_dword v206, v7, s[82:83]
  v_and_b32 v247, 63, v0
  v_lshrrev_b32 v1, 6, v0
  v_lshrrev_b32 v2, 2, v247
  v_readfirstlane_b32 s42, v1
  v_lshlrev_b32 v3, 10, v2
  v_and_b32 v4, 2, v247
  v_lshl_add_u32 v3, v4, 5, v3
  v_and_b32 v5, 1, v247
  v_lshl_add_u32 v3, v5, 4, v3
  s_lshl_b32 s48, s41, 16
  s_lshl_b32 s49, s42, 14
  s_add_u32 s48, s48, s49
  s_lshl_b32 s61, s40, 2
  s_add_u32 s61, s61, s54
  s_and_b32 s61, s61, 7
  s_lshl_b32 s61, s61, 7
  s_lshl_b32 s47, s40, 19
  s_lshl_b32 s51, s54, 8
  v_add_u32 v9, s51, v0
  v_mul_u32_u24 v208, 24, v9
  v_lshlrev_b32 v209, 4, v9
  v_lshlrev_b32 v210, 4, v9
  s_mov_b32 s58, s47
  v_lshrrev_b32 v13, 3, v9
  v_mul_u32_u24 v13, 3584, v13
  v_and_b32 v14, 7, v0
  v_lshl_add_u32 v17, v14, 6, v13
  s_mul_i32 s63, s40, 448
  s_waitcnt lgkmcnt(0)
  s_mov_b32 s8, s64
  s_and_b32 s9, s65, 0xffff
  s_mov_b32 s10, 2097152
  s_mov_b32 s11, 0x20000
  s_add_u32 s51, s61, 0
  s_and_b32 s51, s51, 1023
  s_add_u32 s51, s51, s48
  buffer_load_dwordx4 v[128:131], v3, s[8:11], s51 offen offset:0
  buffer_load_dwordx4 v[132:135], v3, s[8:11], s51 offen offset:32
  s_add_u32 s51, s61, 128
  s_and_b32 s51, s51, 1023
  s_add_u32 s51, s51, s48
  buffer_load_dwordx4 v[136:139], v3, s[8:11], s51 offen offset:0
  buffer_load_dwordx4 v[140:143], v3, s[8:11], s51 offen offset:32
  s_add_u32 s51, s61, 256
  s_and_b32 s51, s51, 1023
  s_add_u32 s51, s51, s48
  buffer_load_dwordx4 v[144:147], v3, s[8:11], s51 offen offset:0
  buffer_load_dwordx4 v[148:151], v3, s[8:11], s51 offen offset:32
  s_add_u32 s51, s61, 384
  s_and_b32 s51, s51, 1023
  s_add_u32 s51, s51, s48
  buffer_load_dwordx4 v[152:155], v3, s[8:11], s51 offen offset:0
  buffer_load_dwordx4 v[156:159], v3, s[8:11], s51 offen offset:32
  s_add_u32 s51, s61, 512
  s_and_b32 s51, s51, 1023
  s_add_u32 s51, s51, s48
  buffer_load_dwordx4 v[160:163], v3, s[8:11], s51 offen offset:0
  buffer_load_dwordx4 v[164:167], v3, s[8:11], s51 offen offset:32
  s_mov_b32 s28, s76
  s_and_b32 s29, s77, 0xffff
  s_mov_b32 s30, 1835008
  s_mov_b32 s31, 0x20000
  buffer_load_dword v211, v17, s[28:31], s63 offen
  s_mov_b32 s20, s70
  s_and_b32 s21, s71, 0xffff
  s_mov_b32 s22, 4194304
  s_mov_b32 s23, 0x20000
  s_mov_b32 s75, s48
  s_lshl_b32 s53, s42, 13
  s_add_u32 s43, s53, 65536
  s_lshl_b32 s44, s40, 10
  s_lshl_b32 s3, s54, 18
  s_add_u32 s3, s3, s44
  s_lshl_b32 s50, s61, 12
  s_add_u32 s44, s44, s50
  s_and_b32 s45, s63, 0xffffff80
  s_lshl_b32 s50, s42, 7
  s_add_u32 s45, s45, s50
  s_mul_i32 s50, s61, 1792
  s_add_u32 s45, s45, s50
  v_lshrrev_b32 v6, 3, v0
  v_lshlrev_b32 v6, 13, v6
  v_lshl_add_u32 v228, v14, 7, v6
  v_lshrrev_b32 v6, 3, v247
  v_lshrrev_b32 v7, 4, v247
  v_lshlrev_b32 v9, 1, v7
  v_and_b32 v8, 7, v247
  v_xor_b32 v8, v8, v9
  v_lshlrev_b32 v9, 4, v8
  v_lshl_add_u32 v248, v6, 13, v9
  v_lshl_add_u32 v243, v6, 10, v9
  s_lshl_b32 s49, s42, 1
  s_and_b32 s50, s40, 1
  s_sub_u32 s49, s49, s50
  v_lshrrev_b32 v10, 2, v8
  v_add_u32 v10, s49, v10
  v_cmp_le_u32 vcc, 7, v10
  v_mov_b32 v16, 1073741824
  v_mul_u32_u24 v10, 3584, v6
  v_add_u32 v252, v10, v9
  v_cndmask_b32 v252, v252, v16, vcc
  v_add_u32 v253, 27648, v252
  v_add_u32 v254, 55296, v252
  v_add_u32 v255, 82944, v252
  v_bfe_u32 v6, v247, 2, 2
  v_and_b32 v8, 3, v247
  v_bfe_u32 v9, v247, 3, 2
  v_lshlrev_b32 v10, 3, v8
  v_lshl_add_u32 v10, v6, 7, v10
  v_lshl_add_u32 v10, v9, 5, v10
  v_lshl_add_u32 v11, v7, 9, v10
  v_add_u32 v11, s43, v11
  v_xor_b32 v232, 0, v11
  v_add_u32 v236, 0x10000, v232
  v_xor_b32 v233, 32, v11
  v_add_u32 v237, 0x10000, v233
  v_xor_b32 v234, 64, v11
  v_add_u32 v238, 0x10000, v234
  v_xor_b32 v235, 96, v11
  v_add_u32 v239, 0x10000, v235
  v_lshrrev_b32 v12, 5, v247
  v_lshl_add_u32 v13, v12, 1, v247
  v_add_u32 v14, 0, v13
  v_and_b32 v14, 15, v14
  v_lshlrev_b32 v14, 4, v14
  v_lshl_add_u32 v240, v7, 8, v14
  v_add_u32 v14, 4, v13
  v_and_b32 v14, 15, v14
  v_lshlrev_b32 v14, 4, v14
  v_lshl_add_u32 v241, v7, 8, v14
  s_lshl_b32 s49, s42, 10
  v_lshl_add_u32 v13, v8, 1, v2
  v_and_b32 v13, 15, v13
  v_lshlrev_b32 v13, 4, v13
  v_lshl_add_u32 v13, v4, 11, v13
  v_lshl_add_u32 v13, v5, 9, v13
  v_add_u32 v216, s49, v13
  s_add_u32 s51, s61, 640
  s_and_b32 s51, s51, 1023
  s_add_u32 s51, s51, s48
  buffer_load_dwordx4 v[168:171], v3, s[8:11], s51 offen offset:0
  buffer_load_dwordx4 v[172:175], v3, s[8:11], s51 offen offset:32
  s_add_u32 s51, s61, 768
  s_and_b32 s51, s51, 1023
  s_add_u32 s51, s51, s48
  buffer_load_dwordx4 v[176:179], v3, s[8:11], s51 offen offset:0
  buffer_load_dwordx4 v[180:183], v3, s[8:11], s51 offen offset:32
  s_add_u32 s51, s61, 896
  s_and_b32 s51, s51, 1023
  s_add_u32 s51, s51, s48
  buffer_load_dwordx4 v[184:187], v3, s[8:11], s51 offen offset:0
  buffer_load_dwordx4 v[188:191], v3, s[8:11], s51 offen offset:32
  s_mov_b64 exec, 0
  s_cmp_eq_u32 s42, 0
  s_cbranch_scc1 L_hop0
  s_cmp_eq_u32 s42, 1
  s_cbranch_scc1 L_hop1
  s_cmp_eq_u32 s42, 2
  s_cbranch_scc1 L_hop2
  s_branch L_hop3
.p2align 12
L_hop_done:
  s_mov_b64 exec, -1
  v_mov_b32 v218, 0
  v_mov_b32 v224, 0
  v_mov_b32 v219, 0
  v_mov_b32 v225, 0
  v_mov_b32 v220, 0
  v_mov_b32 v226, 0
  v_mov_b32 v221, 0
  v_mov_b32 v227, 0
  s_waitcnt vmcnt(15)
  v_lshlrev_b32 v222, 16, v128
  v_xor_b32 v222, 0x80000000, v222
  s_nop 1
  v_mov_b32 v222, v222 quad_perm:[0,0,0,0] row_mask:0xf bank_mask:0xf
  v_mov_b32 v223, v222
  v_lshlrev_b32 v0, 16, v128
  v_and_b32 v1, 0xffff0000, v128
  v_pk_add_f32 v[0:1], v[0:1], v[222:223]
  v_pk_fma_f32 v[224:225], v[0:1], v[0:1], v[224:225]
  v_pk_add_f32 v[218:219], v[218:219], v[0:1]
  v_lshlrev_b32 v2, 16, v129
  v_and_b32 v3, 0xffff0000, v129
  v_pk_add_f32 v[2:3], v[2:3], v[222:223]
  v_pk_fma_f32 v[226:227], v[2:3], v[2:3], v[226:227]
  v_pk_add_f32 v[220:221], v[220:221], v[2:3]
  v_lshlrev_b32 v4, 16, v130
  v_and_b32 v5, 0xffff0000, v130
  v_pk_add_f32 v[4:5], v[4:5], v[222:223]
  v_pk_fma_f32 v[224:225], v[4:5], v[4:5], v[224:225]
  v_pk_add_f32 v[218:219], v[218:219], v[4:5]
  v_lshlrev_b32 v6, 16, v131
  v_and_b32 v7, 0xffff0000, v131
  v_pk_add_f32 v[6:7], v[6:7], v[222:223]
  v_pk_fma_f32 v[226:227], v[6:7], v[6:7], v[226:227]
  v_pk_add_f32 v[220:221], v[220:221], v[6:7]
  v_lshlrev_b32 v8, 16, v132
  v_and_b32 v9, 0xffff0000, v132
  v_pk_add_f32 v[8:9], v[8:9], v[222:223]
  v_pk_fma_f32 v[224:225], v[8:9], v[8:9], v[224:225]
  v_pk_add_f32 v[218:219], v[218:219], v[8:9]
  v_lshlrev_b32 v10, 16, v133
  v_and_b32 v11, 0xffff0000, v133
  v_pk_add_f32 v[10:11], v[10:11], v[222:223]
  v_pk_fma_f32 v[226:227], v[10:11], v[10:11], v[226:227]
  v_pk_add_f32 v[220:221], v[220:221], v[10:11]
  v_lshlrev_b32 v12, 16, v134
  v_and_b32 v13, 0xffff0000, v134
  v_pk_add_f32 v[12:13], v[12:13], v[222:223]
  v_pk_fma_f32 v[224:225], v[12:13], v[12:13], v[224:225]
  v_pk_add_f32 v[218:219], v[218:219], v[12:13]
  v_lshlrev_b32 v14, 16, v135
  v_and_b32 v15, 0xffff0000, v135
  v_pk_add_f32 v[14:15], v[14:15], v[222:223]
  v_pk_fma_f32 v[226:227], v[14:15], v[14:15], v[226:227]
  v_pk_add_f32 v[220:221], v[220:221], v[14:15]
  s_waitcnt vmcnt(13)
  v_lshlrev_b32 v16, 16, v136
  v_and_b32 v17, 0xffff0000, v136
  v_pk_add_f32 v[16:17], v[16:17], v[222:223]
  v_pk_fma_f32 v[224:225], v[16:17], v[16:17], v[224:225]
  v_pk_add_f32 v[218:219], v[218:219], v[16:17]
  v_lshlrev_b32 v18, 16, v137
  v_and_b32 v19, 0xffff0000, v137
  v_pk_add_f32 v[18:19], v[18:19], v[222:223]
  v_pk_fma_f32 v[226:227], v[18:19], v[18:19], v[226:227]
  v_pk_add_f32 v[220:221], v[220:221], v[18:19]
  v_lshlrev_b32 v20, 16, v138
  v_and_b32 v21, 0xffff0000, v138
  v_pk_add_f32 v[20:21], v[20:21], v[222:223]
  v_pk_fma_f32 v[224:225], v[20:21], v[20:21], v[224:225]
  v_pk_add_f32 v[218:219], v[218:219], v[20:21]
  v_lshlrev_b32 v22, 16, v139
  v_and_b32 v23, 0xffff0000, v139
  v_pk_add_f32 v[22:23], v[22:23], v[222:223]
  v_pk_fma_f32 v[226:227], v[22:23], v[22:23], v[226:227]
  v_pk_add_f32 v[220:221], v[220:221], v[22:23]
  v_lshlrev_b32 v24, 16, v140
  v_and_b32 v25, 0xffff0000, v140
  v_pk_add_f32 v[24:25], v[24:25], v[222:223]
  v_pk_fma_f32 v[224:225], v[24:25], v[24:25], v[224:225]
  v_pk_add_f32 v[218:219], v[218:219], v[24:25]
  v_lshlrev_b32 v26, 16, v141
  v_and_b32 v27, 0xffff0000, v141
  v_pk_add_f32 v[26:27], v[26:27], v[222:223]
  v_pk_fma_f32 v[226:227], v[26:27], v[26:27], v[226:227]
  v_pk_add_f32 v[220:221], v[220:221], v[26:27]
  v_lshlrev_b32 v28, 16, v142
  v_and_b32 v29, 0xffff0000, v142
  v_pk_add_f32 v[28:29], v[28:29], v[222:223]
  v_pk_fma_f32 v[224:225], v[28:29], v[28:29], v[224:225]
  v_pk_add_f32 v[218:219], v[218:219], v[28:29]
  s_add_u32 m0, s43, 65536
  s_add_u32 s48, s45, 0
  s_sub_u32 s51, s48, 1835008
  s_min_u32 s48, s48, s51
  buffer_load_dwordx4 v252, s[28:31], s48 offen lds
  v_lshlrev_b32 v30, 16, v143
  v_and_b32 v31, 0xffff0000, v143
  v_pk_add_f32 v[30:31], v[30:31], v[222:223]
  v_pk_fma_f32 v[226:227], v[30:31], v[30:31], v[226:227]
  v_pk_add_f32 v[220:221], v[220:221], v[30:31]
  s_waitcnt vmcnt(12)
  v_lshlrev_b32 v32, 16, v144
  v_and_b32 v33, 0xffff0000, v144
  v_pk_add_f32 v[32:33], v[32:33], v[222:223]
  v_pk_fma_f32 v[224:225], v[32:33], v[32:33], v[224:225]
  v_pk_add_f32 v[218:219], v[218:219], v[32:33]
  buffer_load_dwordx4 v253, s[28:31], s48 offen offset:1024 lds
  v_lshlrev_b32 v34, 16, v145
  v_and_b32 v35, 0xffff0000, v145
  v_pk_add_f32 v[34:35], v[34:35], v[222:223]
  v_pk_fma_f32 v[226:227], v[34:35], v[34:35], v[226:227]
  v_pk_add_f32 v[220:221], v[220:221], v[34:35]
  v_lshlrev_b32 v36, 16, v146
  v_and_b32 v37, 0xffff0000, v146
  v_pk_add_f32 v[36:37], v[36:37], v[222:223]
  v_pk_fma_f32 v[224:225], v[36:37], v[36:37], v[224:225]
  v_pk_add_f32 v[218:219], v[218:219], v[36:37]
  buffer_load_dwordx4 v254, s[28:31], s48 offen offset:2048 lds
  v_lshlrev_b32 v38, 16, v147
  v_and_b32 v39, 0xffff0000, v147
  v_pk_add_f32 v[38:39], v[38:39], v[222:223]
  v_pk_fma_f32 v[226:227], v[38:39], v[38:39], v[226:227]
  v_pk_add_f32 v[220:221], v[220:221], v[38:39]
  v_lshlrev_b32 v40, 16, v148
  v_and_b32 v41, 0xffff0000, v148
  v_pk_add_f32 v[40:41], v[40:41], v[222:223]
  v_pk_fma_f32 v[224:225], v[40:41], v[40:41], v[224:225]
  v_pk_add_f32 v[218:219], v[218:219], v[40:41]
  buffer_load_dwordx4 v255, s[28:31], s48 offen offset:3072 lds
  v_lshlrev_b32 v42, 16, v149
  v_and_b32 v43, 0xffff0000, v149
  v_pk_add_f32 v[42:43], v[42:43], v[222:223]
  v_pk_fma_f32 v[226:227], v[42:43], v[42:43], v[226:227]
  v_pk_add_f32 v[220:221], v[220:221], v[42:43]
  v_lshlrev_b32 v44, 16, v150
  v_and_b32 v45, 0xffff0000, v150
  v_pk_add_f32 v[44:45], v[44:45], v[222:223]
  v_pk_fma_f32 v[224:225], v[44:45], v[44:45], v[224:225]
  v_pk_add_f32 v[218:219], v[218:219], v[44:45]
  s_add_u32 m0, s43, 69632
  s_add_u32 s48, s45, 114688
  s_sub_u32 s51, s48, 1835008
  s_min_u32 s48, s48, s51
  buffer_load_dwordx4 v252, s[28:31], s48 offen lds
  v_lshlrev_b32 v46, 16, v151
  v_and_b32 v47, 0xffff0000, v151
  v_pk_add_f32 v[46:47], v[46:47], v[222:223]
  v_pk_fma_f32 v[226:227], v[46:47], v[46:47], v[226:227]
  v_pk_add_f32 v[220:221], v[220:221], v[46:47]
  s_waitcnt vmcnt(14)
  v_lshlrev_b32 v48, 16, v152
  v_and_b32 v49, 0xffff0000, v152
  v_pk_add_f32 v[48:49], v[48:49], v[222:223]
  v_pk_fma_f32 v[224:225], v[48:49], v[48:49], v[224:225]
  v_pk_add_f32 v[218:219], v[218:219], v[48:49]
  buffer_load_dwordx4 v253, s[28:31], s48 offen offset:1024 lds
  v_lshlrev_b32 v50, 16, v153
  v_and_b32 v51, 0xffff0000, v153
  v_pk_add_f32 v[50:51], v[50:51], v[222:223]
  v_pk_fma_f32 v[226:227], v[50:51], v[50:51], v[226:227]
  v_pk_add_f32 v[220:221], v[220:221], v[50:51]
  v_lshlrev_b32 v52, 16, v154
  v_and_b32 v53, 0xffff0000, v154
  v_pk_add_f32 v[52:53], v[52:53], v[222:223]
  v_pk_fma_f32 v[224:225], v[52:53], v[52:53], v[224:225]
  v_pk_add_f32 v[218:219], v[218:219], v[52:53]
  buffer_load_dwordx4 v254, s[28:31], s48 offen offset:2048 lds
  v_lshlrev_b32 v54, 16, v155
  v_and_b32 v55, 0xffff0000, v155
  v_pk_add_f32 v[54:55], v[54:55], v[222:223]
  v_pk_fma_f32 v[226:227], v[54:55], v[54:55], v[226:227]
  v_pk_add_f32 v[220:221], v[220:221], v[54:55]
  v_lshlrev_b32 v56, 16, v156
  v_and_b32 v57, 0xffff0000, v156
  v_pk_add_f32 v[56:57], v[56:57], v[222:223]
  v_pk_fma_f32 v[224:225], v[56:57], v[56:57], v[224:225]
  v_pk_add_f32 v[218:219], v[218:219], v[56:57]
  buffer_load_dwordx4 v255, s[28:31], s48 offen offset:3072 lds
  v_lshlrev_b32 v58, 16, v157
  v_and_b32 v59, 0xffff0000, v157
  v_pk_add_f32 v[58:59], v[58:59], v[222:223]
  v_pk_fma_f32 v[226:227], v[58:59], v[58:59], v[226:227]
  v_pk_add_f32 v[220:221], v[220:221], v[58:59]
  v_lshlrev_b32 v60, 16, v158
  v_and_b32 v61, 0xffff0000, v158
  v_pk_add_f32 v[60:61], v[60:61], v[222:223]
  v_pk_fma_f32 v[224:225], v[60:61], v[60:61], v[224:225]
  v_pk_add_f32 v[218:219], v[218:219], v[60:61]
  s_add_u32 m0, s43, 0
  s_add_u32 s48, s45, 229376
  s_sub_u32 s51, s48, 1835008
  s_min_u32 s48, s48, s51
  buffer_load_dwordx4 v252, s[28:31], s48 offen lds
  v_lshlrev_b32 v62, 16, v159
  v_and_b32 v63, 0xffff0000, v159
  v_pk_add_f32 v[62:63], v[62:63], v[222:223]
  v_pk_fma_f32 v[226:227], v[62:63], v[62:63], v[226:227]
  v_pk_add_f32 v[220:221], v[220:221], v[62:63]
  s_waitcnt vmcnt(16)
  v_lshlrev_b32 v64, 16, v160
  v_and_b32 v65, 0xffff0000, v160
  v_pk_add_f32 v[64:65], v[64:65], v[222:223]
  v_pk_fma_f32 v[224:225], v[64:65], v[64:65], v[224:225]
  v_pk_add_f32 v[218:219], v[218:219], v[64:65]
  buffer_load_dwordx4 v253, s[28:31], s48 offen offset:1024 lds
  v_lshlrev_b32 v66, 16, v161
  v_and_b32 v67, 0xffff0000, v161
  v_pk_add_f32 v[66:67], v[66:67], v[222:223]
  v_pk_fma_f32 v[226:227], v[66:67], v[66:67], v[226:227]
  v_pk_add_f32 v[220:221], v[220:221], v[66:67]
  v_lshlrev_b32 v68, 16, v162
  v_and_b32 v69, 0xffff0000, v162
  v_pk_add_f32 v[68:69], v[68:69], v[222:223]
  v_pk_fma_f32 v[224:225], v[68:69], v[68:69], v[224:225]
  v_pk_add_f32 v[218:219], v[218:219], v[68:69]
  buffer_load_dwordx4 v254, s[28:31], s48 offen offset:2048 lds
  v_lshlrev_b32 v70, 16, v163
  v_and_b32 v71, 0xffff0000, v163
  v_pk_add_f32 v[70:71], v[70:71], v[222:223]
  v_pk_fma_f32 v[226:227], v[70:71], v[70:71], v[226:227]
  v_pk_add_f32 v[220:221], v[220:221], v[70:71]
  v_lshlrev_b32 v72, 16, v164
  v_and_b32 v73, 0xffff0000, v164
  v_pk_add_f32 v[72:73], v[72:73], v[222:223]
  v_pk_fma_f32 v[224:225], v[72:73], v[72:73], v[224:225]
  v_pk_add_f32 v[218:219], v[218:219], v[72:73]
  buffer_load_dwordx4 v255, s[28:31], s48 offen offset:3072 lds
  v_lshlrev_b32 v74, 16, v165
  v_and_b32 v75, 0xffff0000, v165
  v_pk_add_f32 v[74:75], v[74:75], v[222:223]
  v_pk_fma_f32 v[226:227], v[74:75], v[74:75], v[226:227]
  v_pk_add_f32 v[220:221], v[220:221], v[74:75]
  v_lshlrev_b32 v76, 16, v166
  v_and_b32 v77, 0xffff0000, v166
  v_pk_add_f32 v[76:77], v[76:77], v[222:223]
  v_pk_fma_f32 v[224:225], v[76:77], v[76:77], v[224:225]
  v_pk_add_f32 v[218:219], v[218:219], v[76:77]
  s_add_u32 m0, s43, 4096
  s_add_u32 s48, s45, 344064
  s_sub_u32 s51, s48, 1835008
  s_min_u32 s48, s48, s51
  buffer_load_dwordx4 v252, s[28:31], s48 offen lds
  v_lshlrev_b32 v78, 16, v167
  v_and_b32 v79, 0xffff0000, v167
  v_pk_add_f32 v[78:79], v[78:79], v[222:223]
  v_pk_fma_f32 v[226:227], v[78:79], v[78:79], v[226:227]
  v_pk_add_f32 v[220:221], v[220:221], v[78:79]
  s_waitcnt vmcnt(17)
  v_lshlrev_b32 v80, 16, v168
  v_and_b32 v81, 0xffff0000, v168
  v_pk_add_f32 v[80:81], v[80:81], v[222:223]
  v_pk_fma_f32 v[224:225], v[80:81], v[80:81], v[224:225]
  v_pk_add_f32 v[218:219], v[218:219], v[80:81]
  buffer_load_dwordx4 v253, s[28:31], s48 offen offset:1024 lds
  v_lshlrev_b32 v82, 16, v169
  v_and_b32 v83, 0xffff0000, v169
  v_pk_add_f32 v[82:83], v[82:83], v[222:223]
  v_pk_fma_f32 v[226:227], v[82:83], v[82:83], v[226:227]
  v_pk_add_f32 v[220:221], v[220:221], v[82:83]
  v_lshlrev_b32 v84, 16, v170
  v_and_b32 v85, 0xffff0000, v170
  v_pk_add_f32 v[84:85], v[84:85], v[222:223]
  v_pk_fma_f32 v[224:225], v[84:85], v[84:85], v[224:225]
  v_pk_add_f32 v[218:219], v[218:219], v[84:85]
  buffer_load_dwordx4 v254, s[28:31], s48 offen offset:2048 lds
  v_lshlrev_b32 v86, 16, v171
  v_and_b32 v87, 0xffff0000, v171
  v_pk_add_f32 v[86:87], v[86:87], v[222:223]
  v_pk_fma_f32 v[226:227], v[86:87], v[86:87], v[226:227]
  v_pk_add_f32 v[220:221], v[220:221], v[86:87]
  v_lshlrev_b32 v88, 16, v172
  v_and_b32 v89, 0xffff0000, v172
  v_pk_add_f32 v[88:89], v[88:89], v[222:223]
  v_pk_fma_f32 v[224:225], v[88:89], v[88:89], v[224:225]
  v_pk_add_f32 v[218:219], v[218:219], v[88:89]
  buffer_load_dwordx4 v255, s[28:31], s48 offen offset:3072 lds
  v_lshlrev_b32 v90, 16, v173
  v_and_b32 v91, 0xffff0000, v173
  v_pk_add_f32 v[90:91], v[90:91], v[222:223]
  v_pk_fma_f32 v[226:227], v[90:91], v[90:91], v[226:227]
  v_pk_add_f32 v[220:221], v[220:221], v[90:91]
  v_lshlrev_b32 v92, 16, v174
  v_and_b32 v93, 0xffff0000, v174
  v_pk_add_f32 v[92:93], v[92:93], v[222:223]
  v_pk_fma_f32 v[224:225], v[92:93], v[92:93], v[224:225]
  v_pk_add_f32 v[218:219], v[218:219], v[92:93]
  s_add_u32 m0, s43, 32768
  s_add_u32 s48, s45, 458752
  s_sub_u32 s51, s48, 1835008
  s_min_u32 s48, s48, s51
  buffer_load_dwordx4 v252, s[28:31], s48 offen lds
  v_lshlrev_b32 v94, 16, v175
  v_and_b32 v95, 0xffff0000, v175
  v_pk_add_f32 v[94:95], v[94:95], v[222:223]
  v_pk_fma_f32 v[226:227], v[94:95], v[94:95], v[226:227]
  v_pk_add_f32 v[220:221], v[220:221], v[94:95]
  s_waitcnt vmcnt(19)
  v_lshlrev_b32 v96, 16, v176
  v_and_b32 v97, 0xffff0000, v176
  v_pk_add_f32 v[96:97], v[96:97], v[222:223]
  v_pk_fma_f32 v[224:225], v[96:97], v[96:97], v[224:225]
  v_pk_add_f32 v[218:219], v[218:219], v[96:97]
  buffer_load_dwordx4 v253, s[28:31], s48 offen offset:1024 lds
  v_lshlrev_b32 v98, 16, v177
  v_and_b32 v99, 0xffff0000, v177
  v_pk_add_f32 v[98:99], v[98:99], v[222:223]
  v_pk_fma_f32 v[226:227], v[98:99], v[98:99], v[226:227]
  v_pk_add_f32 v[220:221], v[220:221], v[98:99]
  v_lshlrev_b32 v100, 16, v178
  v_and_b32 v101, 0xffff0000, v178
  v_pk_add_f32 v[100:101], v[100:101], v[222:223]
  v_pk_fma_f32 v[224:225], v[100:101], v[100:101], v[224:225]
  v_pk_add_f32 v[218:219], v[218:219], v[100:101]
  buffer_load_dwordx4 v254, s[28:31], s48 offen offset:2048 lds
  v_lshlrev_b32 v102, 16, v179
  v_and_b32 v103, 0xffff0000, v179
  v_pk_add_f32 v[102:103], v[102:103], v[222:223]
  v_pk_fma_f32 v[226:227], v[102:103], v[102:103], v[226:227]
  v_pk_add_f32 v[220:221], v[220:221], v[102:103]
  v_lshlrev_b32 v104, 16, v180
  v_and_b32 v105, 0xffff0000, v180
  v_pk_add_f32 v[104:105], v[104:105], v[222:223]
  v_pk_fma_f32 v[224:225], v[104:105], v[104:105], v[224:225]
  v_pk_add_f32 v[218:219], v[218:219], v[104:105]
  buffer_load_dwordx4 v255, s[28:31], s48 offen offset:3072 lds
  v_lshlrev_b32 v106, 16, v181
  v_and_b32 v107, 0xffff0000, v181
  v_pk_add_f32 v[106:107], v[106:107], v[222:223]
  v_pk_fma_f32 v[226:227], v[106:107], v[106:107], v[226:227]
  v_pk_add_f32 v[220:221], v[220:221], v[106:107]
  v_lshlrev_b32 v108, 16, v182
  v_and_b32 v109, 0xffff0000, v182
  v_pk_add_f32 v[108:109], v[108:109], v[222:223]
  v_pk_fma_f32 v[224:225], v[108:109], v[108:109], v[224:225]
  v_pk_add_f32 v[218:219], v[218:219], v[108:109]
  s_add_u32 m0, s43, 36864
  s_add_u32 s48, s45, 573440
  s_sub_u32 s51, s48, 1835008
  s_min_u32 s48, s48, s51
  buffer_load_dwordx4 v252, s[28:31], s48 offen lds
  v_lshlrev_b32 v110, 16, v183
  v_and_b32 v111, 0xffff0000, v183
  v_pk_add_f32 v[110:111], v[110:111], v[222:223]
  v_pk_fma_f32 v[226:227], v[110:111], v[110:111], v[226:227]
  v_pk_add_f32 v[220:221], v[220:221], v[110:111]
  s_waitcnt vmcnt(21)
  v_lshlrev_b32 v112, 16, v184
  v_and_b32 v113, 0xffff0000, v184
  v_pk_add_f32 v[112:113], v[112:113], v[222:223]
  v_pk_fma_f32 v[224:225], v[112:113], v[112:113], v[224:225]
  v_pk_add_f32 v[218:219], v[218:219], v[112:113]
  buffer_load_dwordx4 v253, s[28:31], s48 offen offset:1024 lds
  v_lshlrev_b32 v114, 16, v185
  v_and_b32 v115, 0xffff0000, v185
  v_pk_add_f32 v[114:115], v[114:115], v[222:223]
  v_pk_fma_f32 v[226:227], v[114:115], v[114:115], v[226:227]
  v_pk_add_f32 v[220:221], v[220:221], v[114:115]
  v_lshlrev_b32 v116, 16, v186
  v_and_b32 v117, 0xffff0000, v186
  v_pk_add_f32 v[116:117], v[116:117], v[222:223]
  v_pk_fma_f32 v[224:225], v[116:117], v[116:117], v[224:225]
  v_pk_add_f32 v[218:219], v[218:219], v[116:117]
  buffer_load_dwordx4 v254, s[28:31], s48 offen offset:2048 lds
  v_lshlrev_b32 v118, 16, v187
  v_and_b32 v119, 0xffff0000, v187
  v_pk_add_f32 v[118:119], v[118:119], v[222:223]
  v_pk_fma_f32 v[226:227], v[118:119], v[118:119], v[226:227]
  v_pk_add_f32 v[220:221], v[220:221], v[118:119]
  v_lshlrev_b32 v120, 16, v188
  v_and_b32 v121, 0xffff0000, v188
  v_pk_add_f32 v[120:121], v[120:121], v[222:223]
  v_pk_fma_f32 v[224:225], v[120:121], v[120:121], v[224:225]
  v_pk_add_f32 v[218:219], v[218:219], v[120:121]
  buffer_load_dwordx4 v255, s[28:31], s48 offen offset:3072 lds
  v_lshlrev_b32 v122, 16, v189
  v_and_b32 v123, 0xffff0000, v189
  v_pk_add_f32 v[122:123], v[122:123], v[222:223]
  v_pk_fma_f32 v[226:227], v[122:123], v[122:123], v[226:227]
  v_pk_add_f32 v[220:221], v[220:221], v[122:123]
  v_lshlrev_b32 v124, 16, v190
  v_and_b32 v125, 0xffff0000, v190
  v_pk_add_f32 v[124:125], v[124:125], v[222:223]
  v_pk_fma_f32 v[224:225], v[124:125], v[124:125], v[224:225]
  v_pk_add_f32 v[218:219], v[218:219], v[124:125]
  buffer_load_dword v207, v228, s[20:23], s3 offen
  v_lshlrev_b32 v126, 16, v191
  v_and_b32 v127, 0xffff0000, v191
  v_pk_add_f32 v[126:127], v[126:127], v[222:223]
  v_pk_fma_f32 v[226:227], v[126:127], v[126:127], v[226:227]
  v_pk_add_f32 v[220:221], v[220:221], v[126:127]
  v_add_f32 v218, v218, v219
  v_add_f32 v220, v220, v221
  v_add_f32 v224, v224, v225
  v_add_f32 v226, v226, v227
  v_add_f32 v218, v218, v220
  v_add_f32 v224, v224, v226
  s_nop 0
  v_add_f32 v218, v218, v218 quad_perm:[1,0,3,2] row_mask:0xf bank_mask:0xf
  v_add_f32 v224, v224, v224 quad_perm:[1,0,3,2] row_mask:0xf bank_mask:0xf
  s_nop 0
  v_add_f32 v218, v218, v218 quad_perm:[2,3,0,1] row_mask:0xf bank_mask:0xf
  v_add_f32 v224, v224, v224 quad_perm:[2,3,0,1] row_mask:0xf bank_mask:0xf
  v_mul_f32 v218, 0x3b000000, v218
  v_mul_f32 v224, 0x3b000000, v224
  v_fma_f32 v224, -v218, v218, v224
  v_max_f32 v224, 0, v224
  v_cvt_pk_bf16_f32 v224, v224, v224
  v_and_b32 v224, 0xffff0000, v224
  v_add_f32 v224, 0x3727c5ac, v224
  v_cvt_pk_bf16_f32 v224, v224, v224
  v_and_b32 v224, 0xffff0000, v224
  v_sqrt_f32 v224, v224
  v_sub_f32 v218, v218, v222
  v_cvt_pk_bf16_f32 v218, v218, v218
  v_and_b32 v218, 0xffff0000, v218
  v_add_f32 v218, v218, v222
  v_cvt_pk_bf16_f32 v224, v224, v224
  v_and_b32 v224, 0xffff0000, v224
  v_rcp_f32 v224, v224
  s_nop 0
  v_mul_f32 v222, 0x3e0293ee, v224
  v_mov_b32 v223, v222
  v_mul_f32 v218, -v218, v222
  v_mov_b32 v219, v218
  v_pk_fma_f32 v[0:1], v[0:1], v[222:223], v[218:219]
  v_cvt_pk_bf16_f32 v128, v0, v1
  v_pk_fma_f32 v[2:3], v[2:3], v[222:223], v[218:219]
  v_cvt_pk_bf16_f32 v129, v2, v3
  v_pk_fma_f32 v[4:5], v[4:5], v[222:223], v[218:219]
  v_cvt_pk_bf16_f32 v132, v4, v5
  v_pk_fma_f32 v[6:7], v[6:7], v[222:223], v[218:219]
  v_cvt_pk_bf16_f32 v133, v6, v7
  v_pk_fma_f32 v[8:9], v[8:9], v[222:223], v[218:219]
  v_cvt_pk_bf16_f32 v130, v8, v9
  v_pk_fma_f32 v[10:11], v[10:11], v[222:223], v[218:219]
  v_cvt_pk_bf16_f32 v131, v10, v11
  v_pk_fma_f32 v[12:13], v[12:13], v[222:223], v[218:219]
  v_cvt_pk_bf16_f32 v134, v12, v13
  v_pk_fma_f32 v[14:15], v[14:15], v[222:223], v[218:219]
  v_cvt_pk_bf16_f32 v135, v14, v15
  ds_write_b128 v216, v[128:131] offset:0
  ds_write_b128 v216, v[132:135] offset:256
  v_pk_fma_f32 v[16:17], v[16:17], v[222:223], v[218:219]
  v_cvt_pk_bf16_f32 v136, v16, v17
  v_pk_fma_f32 v[18:19], v[18:19], v[222:223], v[218:219]
  v_cvt_pk_bf16_f32 v137, v18, v19
  v_pk_fma_f32 v[20:21], v[20:21], v[222:223], v[218:219]
  v_cvt_pk_bf16_f32 v140, v20, v21
  v_pk_fma_f32 v[22:23], v[22:23], v[222:223], v[218:219]
  v_cvt_pk_bf16_f32 v141, v22, v23
  v_pk_fma_f32 v[24:25], v[24:25], v[222:223], v[218:219]
  v_cvt_pk_bf16_f32 v138, v24, v25
  v_pk_fma_f32 v[26:27], v[26:27], v[222:223], v[218:219]
  v_cvt_pk_bf16_f32 v139, v26, v27
  v_pk_fma_f32 v[28:29], v[28:29], v[222:223], v[218:219]
  v_cvt_pk_bf16_f32 v142, v28, v29
  v_pk_fma_f32 v[30:31], v[30:31], v[222:223], v[218:219]
  v_cvt_pk_bf16_f32 v143, v30, v31
  ds_write_b128 v216, v[136:139] offset:8192
  ds_write_b128 v216, v[140:143] offset:8448
  v_pk_fma_f32 v[32:33], v[32:33], v[222:223], v[218:219]
  v_cvt_pk_bf16_f32 v144, v32, v33
  v_pk_fma_f32 v[34:35], v[34:35], v[222:223], v[218:219]
  v_cvt_pk_bf16_f32 v145, v34, v35
  v_pk_fma_f32 v[36:37], v[36:37], v[222:223], v[218:219]
  v_cvt_pk_bf16_f32 v148, v36, v37
  v_pk_fma_f32 v[38:39], v[38:39], v[222:223], v[218:219]
  v_cvt_pk_bf16_f32 v149, v38, v39
  v_pk_fma_f32 v[40:41], v[40:41], v[222:223], v[218:219]
  v_cvt_pk_bf16_f32 v146, v40, v41
  v_pk_fma_f32 v[42:43], v[42:43], v[222:223], v[218:219]
  v_cvt_pk_bf16_f32 v147, v42, v43
  v_pk_fma_f32 v[44:45], v[44:45], v[222:223], v[218:219]
  v_cvt_pk_bf16_f32 v150, v44, v45
  v_pk_fma_f32 v[46:47], v[46:47], v[222:223], v[218:219]
  v_cvt_pk_bf16_f32 v151, v46, v47
  ds_write_b128 v216, v[144:147] offset:16384
  ds_write_b128 v216, v[148:151] offset:16640
  v_pk_fma_f32 v[48:49], v[48:49], v[222:223], v[218:219]
  v_cvt_pk_bf16_f32 v152, v48, v49
  v_pk_fma_f32 v[50:51], v[50:51], v[222:223], v[218:219]
  v_cvt_pk_bf16_f32 v153, v50, v51
  v_pk_fma_f32 v[52:53], v[52:53], v[222:223], v[218:219]
  v_cvt_pk_bf16_f32 v156, v52, v53
  v_pk_fma_f32 v[54:55], v[54:55], v[222:223], v[218:219]
  v_cvt_pk_bf16_f32 v157, v54, v55
  v_pk_fma_f32 v[56:57], v[56:57], v[222:223], v[218:219]
  v_cvt_pk_bf16_f32 v154, v56, v57
  v_pk_fma_f32 v[58:59], v[58:59], v[222:223], v[218:219]
  v_cvt_pk_bf16_f32 v155, v58, v59
  v_pk_fma_f32 v[60:61], v[60:61], v[222:223], v[218:219]
  v_cvt_pk_bf16_f32 v158, v60, v61
  v_pk_fma_f32 v[62:63], v[62:63], v[222:223], v[218:219]
  v_cvt_pk_bf16_f32 v159, v62, v63
  ds_write_b128 v216, v[152:155] offset:24576
  ds_write_b128 v216, v[156:159] offset:24832
  v_pk_fma_f32 v[64:65], v[64:65], v[222:223], v[218:219]
  v_cvt_pk_bf16_f32 v160, v64, v65
  v_pk_fma_f32 v[66:67], v[66:67], v[222:223], v[218:219]
  v_cvt_pk_bf16_f32 v161, v66, v67
  v_pk_fma_f32 v[68:69], v[68:69], v[222:223], v[218:219]
  v_cvt_pk_bf16_f32 v164, v68, v69
  v_pk_fma_f32 v[70:71], v[70:71], v[222:223], v[218:219]
  v_cvt_pk_bf16_f32 v165, v70, v71
  v_pk_fma_f32 v[72:73], v[72:73], v[222:223], v[218:219]
  v_cvt_pk_bf16_f32 v162, v72, v73
  v_pk_fma_f32 v[74:75], v[74:75], v[222:223], v[218:219]
  v_cvt_pk_bf16_f32 v163, v74, v75
  v_pk_fma_f32 v[76:77], v[76:77], v[222:223], v[218:219]
  v_cvt_pk_bf16_f32 v166, v76, v77
  v_pk_fma_f32 v[78:79], v[78:79], v[222:223], v[218:219]
  v_cvt_pk_bf16_f32 v167, v78, v79
  ds_write_b128 v216, v[160:163] offset:32768
  ds_write_b128 v216, v[164:167] offset:33024
  v_pk_fma_f32 v[80:81], v[80:81], v[222:223], v[218:219]
  v_cvt_pk_bf16_f32 v168, v80, v81
  v_pk_fma_f32 v[82:83], v[82:83], v[222:223], v[218:219]
  v_cvt_pk_bf16_f32 v169, v82, v83
  v_pk_fma_f32 v[84:85], v[84:85], v[222:223], v[218:219]
  v_cvt_pk_bf16_f32 v172, v84, v85
  v_pk_fma_f32 v[86:87], v[86:87], v[222:223], v[218:219]
  v_cvt_pk_bf16_f32 v173, v86, v87
  v_pk_fma_f32 v[88:89], v[88:89], v[222:223], v[218:219]
  v_cvt_pk_bf16_f32 v170, v88, v89
  v_pk_fma_f32 v[90:91], v[90:91], v[222:223], v[218:219]
  v_cvt_pk_bf16_f32 v171, v90, v91
  v_pk_fma_f32 v[92:93], v[92:93], v[222:223], v[218:219]
  v_cvt_pk_bf16_f32 v174, v92, v93
  v_pk_fma_f32 v[94:95], v[94:95], v[222:223], v[218:219]
  v_cvt_pk_bf16_f32 v175, v94, v95
  ds_write_b128 v216, v[168:171] offset:40960
  ds_write_b128 v216, v[172:175] offset:41216
  v_pk_fma_f32 v[96:97], v[96:97], v[222:223], v[218:219]
  v_cvt_pk_bf16_f32 v176, v96, v97
  v_pk_fma_f32 v[98:99], v[98:99], v[222:223], v[218:219]
  v_cvt_pk_bf16_f32 v177, v98, v99
  v_pk_fma_f32 v[100:101], v[100:101], v[222:223], v[218:219]
  v_cvt_pk_bf16_f32 v180, v100, v101
  v_pk_fma_f32 v[102:103], v[102:103], v[222:223], v[218:219]
  v_cvt_pk_bf16_f32 v181, v102, v103
  v_pk_fma_f32 v[104:105], v[104:105], v[222:223], v[218:219]
  v_cvt_pk_bf16_f32 v178, v104, v105
  v_pk_fma_f32 v[106:107], v[106:107], v[222:223], v[218:219]
  v_cvt_pk_bf16_f32 v179, v106, v107
  v_pk_fma_f32 v[108:109], v[108:109], v[222:223], v[218:219]
  v_cvt_pk_bf16_f32 v182, v108, v109
  v_pk_fma_f32 v[110:111], v[110:111], v[222:223], v[218:219]
  v_cvt_pk_bf16_f32 v183, v110, v111
  ds_write_b128 v216, v[176:179] offset:49152
  ds_write_b128 v216, v[180:183] offset:49408
  v_pk_fma_f32 v[112:113], v[112:113], v[222:223], v[218:219]
  v_cvt_pk_bf16_f32 v184, v112, v113
  v_pk_fma_f32 v[114:115], v[114:115], v[222:223], v[218:219]
  v_cvt_pk_bf16_f32 v185, v114, v115
  v_pk_fma_f32 v[116:117], v[116:117], v[222:223], v[218:219]
  v_cvt_pk_bf16_f32 v188, v116, v117
  v_pk_fma_f32 v[118:119], v[118:119], v[222:223], v[218:219]
  v_cvt_pk_bf16_f32 v189, v118, v119
  v_pk_fma_f32 v[120:121], v[120:121], v[222:223], v[218:219]
  v_cvt_pk_bf16_f32 v186, v120, v121
  v_pk_fma_f32 v[122:123], v[122:123], v[222:223], v[218:219]
  v_cvt_pk_bf16_f32 v187, v122, v123
  v_pk_fma_f32 v[124:125], v[124:125], v[222:223], v[218:219]
  v_cvt_pk_bf16_f32 v190, v124, v125
  v_pk_fma_f32 v[126:127], v[126:127], v[222:223], v[218:219]
  v_cvt_pk_bf16_f32 v191, v126, v127
  ds_write_b128 v216, v[184:187] offset:57344
  ds_write_b128 v216, v[188:191] offset:57600
  s_waitcnt vmcnt(17)
L_hop0:
  s_cbranch_execz L_hop4
  ds_read_b64_tr_b16 a[192:193], v236 offset:0
  ds_read_b64_tr_b16 a[194:195], v236 offset:2048
  ds_read_b64_tr_b16 a[196:197], v237 offset:0
  ds_read_b64_tr_b16 a[198:199], v237 offset:2048
  ds_read_b64_tr_b16 a[200:201], v238 offset:0
  ds_read_b64_tr_b16 a[202:203], v238 offset:2048
  ds_read_b64_tr_b16 a[204:205], v239 offset:0
  ds_read_b64_tr_b16 a[206:207], v239 offset:2048
  s_waitcnt lgkmcnt(0)
  s_add_u32 m0, s43, 65536
  s_add_u32 s48, s45, 1146880
  s_sub_u32 s51, s48, 1835008
  s_min_u32 s48, s48, s51
  buffer_load_dwordx4 v252, s[28:31], s48 offen lds
  buffer_load_dwordx4 v253, s[28:31], s48 offen offset:1024 lds
  buffer_load_dwordx4 v254, s[28:31], s48 offen offset:2048 lds
  buffer_load_dwordx4 v255, s[28:31], s48 offen offset:3072 lds
  s_barrier
  ds_read_b128 a[0:3], v240 offset:0
  ds_read_b128 a[4:7], v240 offset:1024
  ds_read_b128 a[16:19], v241 offset:4096
  ds_read_b128 a[20:23], v241 offset:5120
  ds_read_b64_tr_b16 a[208:209], v236 offset:4096
  ds_read_b64_tr_b16 a[210:211], v236 offset:6144
  ds_read_b128 a[8:11], v240 offset:2048
  ds_read_b128 a[12:15], v240 offset:3072
  ds_read_b128 a[24:27], v241 offset:6144
  ds_read_b128 a[28:31], v241 offset:7168
  ds_read_b64_tr_b16 a[212:213], v237 offset:4096
  ds_read_b64_tr_b16 a[214:215], v237 offset:6144
  ds_read_b64_tr_b16 a[216:217], v238 offset:4096
  ds_read_b64_tr_b16 a[218:219], v238 offset:6144
  ds_read_b64_tr_b16 a[220:221], v239 offset:4096
  ds_read_b64_tr_b16 a[222:223], v239 offset:6144
  s_waitcnt lgkmcnt(15)
  v_mfma_f32_16x16x32_bf16 v[128:131], a[192:195], a[0:3], 0
  s_waitcnt lgkmcnt(10)
  s_add_u32 m0, s43, 69632
  s_add_u32 s48, s45, 1261568
  ds_read_b128 a[32:35], v240 offset:8192
  v_mfma_f32_16x16x32_bf16 v[128:131], a[208:211], a[16:19], v[128:131]
  s_sub_u32 s51, s48, 1835008
  ds_read_b128 a[36:39], v240 offset:9216
  s_lshl_b32 s49, s42, 8
  v_mfma_f32_16x16x32_bf16 v[132:135], a[208:211], a[20:23], 0
  s_min_u32 s48, s48, s51
  ds_read_b128 a[40:43], v240 offset:10240
  s_add_u32 s44, s44, s49
  v_mfma_f32_16x16x32_bf16 v[132:135], a[192:195], a[4:7], v[132:135]
  s_waitcnt lgkmcnt(3)
  buffer_load_dwordx4 v252, s[28:31], s48 offen lds
  v_mfma_f32_16x16x32_bf16 v[136:139], a[192:195], a[8:11], 0
  ds_read_b128 a[44:47], v240 offset:11264
  v_add_u32 v249, 64512, v248
  v_mfma_f32_16x16x32_bf16 v[136:139], a[208:211], a[24:27], v[136:139]
  s_waitcnt vmcnt(18)
  ds_read_b64_tr_b16 a[160:161], v232 offset:0
  v_add_u32 v244, 7168, v243
  v_mfma_f32_16x16x32_bf16 v[140:143], a[208:211], a[28:31], 0
  ds_read_b64_tr_b16 a[162:163], v232 offset:2048
  v_add_u32 v250, 129024, v248
  v_mfma_f32_16x16x32_bf16 v[140:143], a[192:195], a[12:15], v[140:143]
  buffer_load_dwordx4 v253, s[28:31], s48 offen offset:1024 lds
  v_mfma_f32_16x16x32_bf16 v[156:159], a[196:199], a[12:15], 0
  ds_read_b64_tr_b16 a[164:165], v233 offset:0
  v_add_u32 v245, 14336, v243
  v_mfma_f32_16x16x32_bf16 v[156:159], a[212:215], a[28:31], v[156:159]
  ds_read_b64_tr_b16 a[166:167], v233 offset:2048
  v_add_u32 v251, 193536, v248
  v_mfma_f32_16x16x32_bf16 v[152:155], a[212:215], a[24:27], 0
  ds_read_b64_tr_b16 a[168:169], v234 offset:0
  v_add_u32 v246, 21504, v243
  v_mfma_f32_16x16x32_bf16 v[152:155], a[196:199], a[8:11], v[152:155]
  s_mov_b32 s12, s66
  buffer_load_dwordx4 v254, s[28:31], s48 offen offset:2048 lds
  v_mfma_f32_16x16x32_bf16 v[148:151], a[196:199], a[4:7], 0
  s_and_b32 s13, s67, 0xffff
  ds_read_b64_tr_b16 a[170:171], v234 offset:2048
  s_mov_b32 s14, 4194304
  v_mfma_f32_16x16x32_bf16 v[148:151], a[212:215], a[20:23], v[148:151]
  s_mov_b32 s15, 0x20000
  ds_read_b64_tr_b16 a[172:173], v235 offset:0
  s_mov_b32 s16, s68
  v_mfma_f32_16x16x32_bf16 v[144:147], a[212:215], a[16:19], 0
  s_and_b32 s17, s69, 0xffff
  ds_read_b64_tr_b16 a[174:175], v235 offset:2048
  s_mov_b32 s18, 4194304
  v_mfma_f32_16x16x32_bf16 v[144:147], a[196:199], a[0:3], v[144:147]
  s_mov_b32 s19, 0x20000
  buffer_load_dwordx4 v255, s[28:31], s48 offen offset:3072 lds
  v_mfma_f32_16x16x32_bf16 v[160:163], a[200:203], a[0:3], 0
  s_add_u32 m0, s43, 0
  s_add_u32 s48, s45, 688128
  ds_read_b128 a[48:51], v241 offset:12288
  v_mfma_f32_16x16x32_bf16 v[160:163], a[216:219], a[16:19], v[160:163]
  s_sub_u32 s51, s48, 1835008
  ds_read_b128 a[52:55], v241 offset:13312
  s_mov_b32 s24, s72
  v_mfma_f32_16x16x32_bf16 v[164:167], a[216:219], a[20:23], 0
  s_min_u32 s48, s48, s51
  ds_read_b128 a[56:59], v241 offset:14336
  s_and_b32 s25, s73, 0xffff
  v_mfma_f32_16x16x32_bf16 v[164:167], a[200:203], a[4:7], v[164:167]
  s_waitcnt lgkmcnt(3)
  buffer_load_dwordx4 v252, s[28:31], s48 offen lds
  v_mfma_f32_16x16x32_bf16 v[168:171], a[200:203], a[8:11], 0
  s_mov_b32 s26, 4194304
  ds_read_b128 a[60:63], v241 offset:15360
  s_mov_b32 s27, 0x20000
  v_mfma_f32_16x16x32_bf16 v[168:171], a[216:219], a[24:27], v[168:171]
  s_waitcnt vmcnt(18)
  ds_read_b64_tr_b16 a[176:177], v232 offset:4096
  s_mov_b32 s32, s78
  v_mfma_f32_16x16x32_bf16 v[172:175], a[216:219], a[28:31], 0
  s_and_b32 s33, s79, 0xffff
  ds_read_b64_tr_b16 a[178:179], v232 offset:6144
  s_mov_b32 s34, 229376
  v_mfma_f32_16x16x32_bf16 v[172:175], a[200:203], a[12:15], v[172:175]
  s_mov_b32 s35, 0x20000
  buffer_load_dwordx4 v253, s[28:31], s48 offen offset:1024 lds
  v_mfma_f32_16x16x32_bf16 v[188:191], a[204:207], a[12:15], 0
  s_mov_b32 s36, s80
  ds_read_b64_tr_b16 a[180:181], v233 offset:4096
  s_and_b32 s37, s81, 0xffff
  v_mfma_f32_16x16x32_bf16 v[188:191], a[220:223], a[28:31], v[188:191]
  s_mov_b32 s38, 67108864
  ds_read_b64_tr_b16 a[182:183], v233 offset:6144
  s_mov_b32 s39, 0x20000
  v_mfma_f32_16x16x32_bf16 v[184:187], a[220:223], a[24:27], 0
  s_mov_b32 s96, s84
  ds_read_b64_tr_b16 a[184:185], v234 offset:4096
  s_and_b32 s97, s85, 0xffff
  v_mfma_f32_16x16x32_bf16 v[184:187], a[204:207], a[8:11], v[184:187]
  s_mov_b32 s98, 2097152
  buffer_load_dwordx4 v254, s[28:31], s48 offen offset:2048 lds
  v_mfma_f32_16x16x32_bf16 v[180:183], a[204:207], a[4:7], 0
  s_mov_b32 s99, 0x20000
  ds_read_b64_tr_b16 a[186:187], v234 offset:6144
  s_mov_b32 s4, s86
  v_mfma_f32_16x16x32_bf16 v[180:183], a[220:223], a[20:23], v[180:183]
  s_and_b32 s5, s87, 0xffff
  ds_read_b64_tr_b16 a[188:189], v235 offset:4096
  s_mov_b32 s6, 256
  v_mfma_f32_16x16x32_bf16 v[176:179], a[220:223], a[16:19], 0
  s_mov_b32 s7, 0x20000
  ds_read_b64_tr_b16 a[190:191], v235 offset:6144
  s_mul_i32 s56, s40, 2265088
  v_mfma_f32_16x16x32_bf16 v[176:179], a[204:207], a[0:3], v[176:179]
  s_mul_i32 s50, s41, 70656
  buffer_load_dwordx4 v255, s[28:31], s48 offen offset:3072 lds
  v_mfma_f32_16x16x32_bf16 v[128:131], a[160:163], a[32:35], v[128:131]
  s_waitcnt lgkmcnt(6)
  s_add_u32 m0, s43, 4096
  s_add_u32 s48, s45, 802816
  ds_read_b128 a[64:67], v240 offset:16384
  v_mfma_f32_16x16x32_bf16 v[128:131], a[176:179], a[48:51], v[128:131]
  s_sub_u32 s51, s48, 1835008
  ds_read_b128 a[68:71], v240 offset:17408
  s_add_u32 s56, s56, s50
  v_mfma_f32_16x16x32_bf16 v[132:135], a[176:179], a[52:55], v[132:135]
  s_min_u32 s48, s48, s51
  ds_read_b128 a[72:75], v240 offset:18432
  s_mul_i32 s50, s42, 17408
  v_mfma_f32_16x16x32_bf16 v[132:135], a[160:163], a[36:39], v[132:135]
  s_waitcnt lgkmcnt(3)
  buffer_load_dwordx4 v252, s[28:31], s48 offen lds
  v_mfma_f32_16x16x32_bf16 v[136:139], a[160:163], a[40:43], v[136:139]
  s_add_u32 s56, s56, s50
  ds_read_b128 a[76:79], v240 offset:19456
  s_mul_i32 s50, s40, 229376
  v_mfma_f32_16x16x32_bf16 v[136:139], a[176:179], a[56:59], v[136:139]
  s_waitcnt vmcnt(18)
  ds_read_b64_tr_b16 a[192:193], v232 offset:32768
  s_add_u32 s32, s32, s50
  s_addc_u32 s33, s33, 0
  v_mfma_f32_16x16x32_bf16 v[140:143], a[176:179], a[60:63], v[140:143]
  s_mul_i32 s79, s54, 37
  ds_read_b64_tr_b16 a[194:195], v232 offset:34816
  s_lshr_b32 s79, s79, 8
  v_mfma_f32_16x16x32_bf16 v[140:143], a[160:163], a[44:47], v[140:143]
  s_mul_i32 s79, s79, 7
  buffer_load_dwordx4 v253, s[28:31], s48 offen offset:1024 lds
  v_mfma_f32_16x16x32_bf16 v[156:159], a[164:167], a[44:47], v[156:159]
  s_sub_u32 s79, s54, s79
  ds_read_b64_tr_b16 a[196:197], v233 offset:32768
  s_lshl_b32 s46, s79, 15
  v_mfma_f32_16x16x32_bf16 v[156:159], a[180:183], a[60:63], v[156:159]
  s_add_u32 s46, s46, s49
  ds_read_b64_tr_b16 a[198:199], v233 offset:34816
  s_and_b32 s78, s40, 1
  v_mfma_f32_16x16x32_bf16 v[152:155], a[180:183], a[56:59], v[152:155]
  s_lshl_b32 s50, s42, 1
  ds_read_b64_tr_b16 a[200:201], v234 offset:32768
  s_add_u32 s50, s50, 0
  v_mfma_f32_16x16x32_bf16 v[152:155], a[164:167], a[40:43], v[152:155]
  s_cmp_eq_u32 s50, s40
  s_cselect_b32 s88, 1073741824, 0
  buffer_load_dwordx4 v254, s[28:31], s48 offen offset:2048 lds
  v_mfma_f32_16x16x32_bf16 v[148:151], a[164:167], a[36:39], v[148:151]
  s_sub_u32 s50, s50, s78
  ds_read_b64_tr_b16 a[202:203], v234 offset:34816
  s_sub_u32 s0, s50, s79
  v_mfma_f32_16x16x32_bf16 v[148:151], a[180:183], a[52:55], v[148:151]
  s_add_u32 s76, s0, 7
  ds_read_b64_tr_b16 a[204:205], v235 offset:32768
  s_min_u32 s76, s76, s0
  v_mfma_f32_16x16x32_bf16 v[144:147], a[180:183], a[48:51], v[144:147]
  s_cmp_ge_u32 s50, 7
  s_cselect_b32 s76, 7, s76
  ds_read_b64_tr_b16 a[206:207], v235 offset:34816
  s_lshl_b32 s76, s76, 12
  v_mfma_f32_16x16x32_bf16 v[144:147], a[164:167], a[32:35], v[144:147]
  s_lshl_b32 s50, s42, 1
  buffer_load_dwordx4 v255, s[28:31], s48 offen offset:3072 lds
  v_mfma_f32_16x16x32_bf16 v[160:163], a[168:171], a[32:35], v[160:163]
  s_add_u32 m0, s43, 32768
  s_add_u32 s48, s45, 1376256
  ds_read_b128 a[80:83], v241 offset:20480
  v_mfma_f32_16x16x32_bf16 v[160:163], a[184:187], a[48:51], v[160:163]
  s_sub_u32 s51, s48, 1835008
  ds_read_b128 a[84:87], v241 offset:21504
  s_add_u32 s50, s50, 1
  v_mfma_f32_16x16x32_bf16 v[164:167], a[184:187], a[52:55], v[164:167]
  s_min_u32 s48, s48, s51
  ds_read_b128 a[88:91], v241 offset:22528
  s_cmp_eq_u32 s50, s40
  s_cselect_b32 s89, 1073741824, 0
  v_mfma_f32_16x16x32_bf16 v[164:167], a[168:171], a[36:39], v[164:167]
  s_waitcnt lgkmcnt(3)
  buffer_load_dwordx4 v252, s[28:31], s48 offen lds
  v_mfma_f32_16x16x32_bf16 v[168:171], a[168:171], a[40:43], v[168:171]
  s_sub_u32 s50, s50, s78
  ds_read_b128 a[92:95], v241 offset:23552
  s_sub_u32 s0, s50, s79
  v_mfma_f32_16x16x32_bf16 v[168:171], a[184:187], a[56:59], v[168:171]
  s_waitcnt vmcnt(18)
  ds_read_b64_tr_b16 a[208:209], v232 offset:36864
  s_add_u32 s77, s0, 7
  v_mfma_f32_16x16x32_bf16 v[172:175], a[184:187], a[60:63], v[172:175]
  s_min_u32 s77, s77, s0
  ds_read_b64_tr_b16 a[210:211], v232 offset:38912
  s_cmp_ge_u32 s50, 7
  s_cselect_b32 s77, 7, s77
  v_mfma_f32_16x16x32_bf16 v[172:175], a[168:171], a[44:47], v[172:175]
  s_lshl_b32 s77, s77, 12
  buffer_load_dwordx4 v253, s[28:31], s48 offen offset:1024 lds
  v_mfma_f32_16x16x32_bf16 v[188:191], a[172:175], a[44:47], v[188:191]
  s_lshl_b32 s62, s54, 15
  ds_read_b64_tr_b16 a[212:213], v233 offset:36864
  s_add_u32 s62, s62, s47
  v_mfma_f32_16x16x32_bf16 v[188:191], a[188:191], a[60:63], v[188:191]
  s_lshl_b32 s50, s42, 11
  ds_read_b64_tr_b16 a[214:215], v233 offset:38912
  s_add_u32 s62, s62, s50
  v_mfma_f32_16x16x32_bf16 v[184:187], a[188:191], a[56:59], v[184:187]
  s_add_u32 s57, s47, s53
  ds_read_b64_tr_b16 a[216:217], v234 offset:36864
  s_add_u32 s47, s47, s49
  v_mfma_f32_16x16x32_bf16 v[184:187], a[172:175], a[40:43], v[184:187]
  s_mov_b32 s52, s57
  buffer_load_dwordx4 v254, s[28:31], s48 offen offset:2048 lds
  v_mfma_f32_16x16x32_bf16 v[180:183], a[172:175], a[36:39], v[180:183]
  s_mov_b32 s55, 0
  ds_read_b64_tr_b16 a[218:219], v234 offset:38912
  s_mov_b32 s60, 0
  v_mfma_f32_16x16x32_bf16 v[180:183], a[188:191], a[52:55], v[180:183]
  s_lshl_b32 s59, s41, 3
  ds_read_b64_tr_b16 a[220:221], v235 offset:36864
  s_add_u32 s64, s56, 18120704
  v_mfma_f32_16x16x32_bf16 v[176:179], a[188:191], a[48:51], v[176:179]
  s_add_u32 s65, s56, 18124800
  ds_read_b64_tr_b16 a[222:223], v235 offset:38912
  s_add_u32 s66, s56, 18128896
  v_mfma_f32_16x16x32_bf16 v[176:179], a[172:175], a[32:35], v[176:179]
  s_add_u32 s67, s56, 18132992
  buffer_load_dwordx4 v255, s[28:31], s48 offen offset:3072 lds
  v_mfma_f32_16x16x32_bf16 v[128:131], a[192:195], a[64:67], v[128:131]
  s_waitcnt lgkmcnt(6)
  s_add_u32 m0, s43, 36864
  s_add_u32 s48, s45, 1490944
  ds_read_b128 a[224:227], v240 offset:40960
  v_mfma_f32_16x16x32_bf16 v[128:131], a[208:211], a[80:83], v[128:131]
  s_sub_u32 s51, s48, 1835008
  ds_read_b128 a[228:231], v240 offset:41984
  s_cmp_lt_u32 s42, 2
  s_cselect_b64 s[68:69], s[12:13], s[16:17]
  s_cselect_b32 s72, 3, 2
  v_mfma_f32_16x16x32_bf16 v[132:135], a[208:211], a[84:87], v[132:135]
  s_min_u32 s48, s48, s51
  ds_read_b128 a[232:235], v240 offset:43008
  s_lshl_b32 s72, s72, 15
  v_mfma_f32_16x16x32_bf16 v[132:135], a[192:195], a[68:71], v[132:135]
  s_waitcnt lgkmcnt(3)
  buffer_load_dwordx4 v252, s[28:31], s48 offen lds
  v_mfma_f32_16x16x32_bf16 v[136:139], a[192:195], a[72:75], v[136:139]
  s_mov_b32 s70, 4194304
  ds_read_b128 a[236:239], v240 offset:44032
  s_mov_b32 s71, 0x20000
  v_mfma_f32_16x16x32_bf16 v[136:139], a[208:211], a[88:91], v[136:139]
  s_waitcnt vmcnt(17)
  ds_read_b64_tr_b16 a[160:161], v236 offset:0
  s_lshl_b32 s49, s54, 12
  v_mfma_f32_16x16x32_bf16 v[140:143], a[208:211], a[92:95], v[140:143]
  s_add_u32 s72, s72, s49
  ds_read_b64_tr_b16 a[162:163], v236 offset:2048
  s_and_b32 s49, s42, 1
  v_mfma_f32_16x16x32_bf16 v[140:143], a[192:195], a[76:79], v[140:143]
  s_lshl_b32 s49, s49, 11
  buffer_load_dwordx4 v253, s[28:31], s48 offen offset:1024 lds
  v_mfma_f32_16x16x32_bf16 v[156:159], a[196:199], a[76:79], v[156:159]
  s_add_u32 s72, s72, s49
  ds_read_b64_tr_b16 a[164:165], v237 offset:0
  s_sub_u32 s72, s72, s53
  v_mfma_f32_16x16x32_bf16 v[156:159], a[212:215], a[92:95], v[156:159]
  s_and_b32 s49, s40, 6
  ds_read_b64_tr_b16 a[166:167], v237 offset:2048
  s_add_u32 s49, s49, s40
  v_mfma_f32_16x16x32_bf16 v[152:155], a[212:215], a[88:91], v[152:155]
  s_lshl_b32 s49, s49, 6
  ds_read_b64_tr_b16 a[168:169], v238 offset:0
  s_add_u32 s75, s75, s49
  v_mfma_f32_16x16x32_bf16 v[152:155], a[196:199], a[72:75], v[152:155]
  s_mul_i32 s74, s41, 70656
  buffer_load_dwordx4 v254, s[28:31], s48 offen offset:2048 lds
  v_mfma_f32_16x16x32_bf16 v[148:151], a[196:199], a[68:71], v[148:151]
  s_lshr_b32 s49, s40, 1
  ds_read_b64_tr_b16 a[170:171], v238 offset:2048
  s_mul_i32 s49, s49, 17408
  v_mfma_f32_16x16x32_bf16 v[148:151], a[212:215], a[84:87], v[148:151]
  s_add_u32 s74, s74, s49
  ds_read_b64_tr_b16 a[172:173], v239 offset:0
  s_and_b32 s49, s40, 1
  v_mfma_f32_16x16x32_bf16 v[144:147], a[212:215], a[80:83], v[144:147]
  s_lshl_b32 s49, s49, 12
  ds_read_b64_tr_b16 a[174:175], v239 offset:2048
  s_add_u32 s74, s74, s49
  v_mfma_f32_16x16x32_bf16 v[144:147], a[196:199], a[64:67], v[144:147]
  s_lshl_b32 s49, s42, 10
  buffer_load_dwordx4 v255, s[28:31], s48 offen offset:3072 lds
  v_mfma_f32_16x16x32_bf16 v[160:163], a[200:203], a[64:67], v[160:163]
  s_add_u32 m0, s43, 65536
  s_add_u32 s48, s45, 917504
  ds_read_b128 a[240:243], v241 offset:45056
  v_mfma_f32_16x16x32_bf16 v[160:163], a[216:219], a[80:83], v[160:163]
  s_sub_u32 s51, s48, 1835008
  ds_read_b128 a[244:247], v241 offset:46080
  s_add_u32 s74, s74, s49
  v_mfma_f32_16x16x32_bf16 v[164:167], a[216:219], a[84:87], v[164:167]
  s_min_u32 s48, s48, s51
  ds_read_b128 a[248:251], v241 offset:47104
  s_add_u32 s73, s74, 18120704
  v_mfma_f32_16x16x32_bf16 v[164:167], a[200:203], a[68:71], v[164:167]
  s_waitcnt lgkmcnt(3)
  buffer_load_dwordx4 v252, s[28:31], s48 offen lds
  v_mfma_f32_16x16x32_bf16 v[168:171], a[200:203], a[72:75], v[168:171]
  s_add_u32 s81, s40, 1
  ds_read_b128 a[252:255], v241 offset:48128
  s_and_b32 s81, s81, 7
  v_mfma_f32_16x16x32_bf16 v[168:171], a[216:219], a[88:91], v[168:171]
  s_waitcnt vmcnt(17)
  ds_read_b64_tr_b16 a[176:177], v236 offset:4096
  s_mul_i32 s81, s81, 2265088
  v_mfma_f32_16x16x32_bf16 v[172:175], a[216:219], a[92:95], v[172:175]
  s_add_u32 s81, s81, s74
  ds_read_b64_tr_b16 a[178:179], v236 offset:6144
  s_add_u32 s82, s40, 2
  v_mfma_f32_16x16x32_bf16 v[172:175], a[200:203], a[76:79], v[172:175]
  s_and_b32 s82, s82, 7
  buffer_load_dwordx4 v253, s[28:31], s48 offen offset:1024 lds
  v_mfma_f32_16x16x32_bf16 v[188:191], a[204:207], a[76:79], v[188:191]
  s_mul_i32 s82, s82, 2265088
  ds_read_b64_tr_b16 a[180:181], v237 offset:4096
  s_add_u32 s82, s82, s74
  v_mfma_f32_16x16x32_bf16 v[188:191], a[220:223], a[92:95], v[188:191]
  s_add_u32 s83, s40, 3
  ds_read_b64_tr_b16 a[182:183], v237 offset:6144
  s_and_b32 s83, s83, 7
  v_mfma_f32_16x16x32_bf16 v[184:187], a[220:223], a[88:91], v[184:187]
  s_mul_i32 s83, s83, 2265088
  ds_read_b64_tr_b16 a[184:185], v238 offset:4096
  s_add_u32 s83, s83, s74
  v_mfma_f32_16x16x32_bf16 v[184:187], a[204:207], a[72:75], v[184:187]
  s_add_u32 s84, s40, 4
  buffer_load_dwordx4 v254, s[28:31], s48 offen offset:2048 lds
  v_mfma_f32_16x16x32_bf16 v[180:183], a[204:207], a[68:71], v[180:183]
  s_and_b32 s84, s84, 7
  ds_read_b64_tr_b16 a[186:187], v238 offset:6144
  s_mul_i32 s84, s84, 2265088
  v_mfma_f32_16x16x32_bf16 v[180:183], a[220:223], a[84:87], v[180:183]
  s_add_u32 s84, s84, s74
  ds_read_b64_tr_b16 a[188:189], v239 offset:4096
  s_add_u32 s85, s40, 5
  v_mfma_f32_16x16x32_bf16 v[176:179], a[220:223], a[80:83], v[176:179]
  s_and_b32 s85, s85, 7
  ds_read_b64_tr_b16 a[190:191], v239 offset:6144
  s_mul_i32 s85, s85, 2265088
  v_mfma_f32_16x16x32_bf16 v[176:179], a[204:207], a[64:67], v[176:179]
  s_add_u32 s85, s85, s74
  buffer_load_dwordx4 v255, s[28:31], s48 offen offset:3072 lds
  v_mfma_f32_16x16x32_bf16 v[128:131], a[160:163], a[224:227], v[128:131]
  s_waitcnt lgkmcnt(6)
  s_add_u32 m0, s43, 69632
  s_add_u32 s48, s45, 1032192
  ds_read_b128 a[96:99], v240 offset:24576
  v_mfma_f32_16x16x32_bf16 v[128:131], a[176:179], a[240:243], v[128:131]
  s_sub_u32 s51, s48, 1835008
  ds_read_b128 a[100:103], v240 offset:25600
  s_add_u32 s86, s40, 6
  v_mfma_f32_16x16x32_bf16 v[132:135], a[176:179], a[244:247], v[132:135]
  s_min_u32 s48, s48, s51
  ds_read_b128 a[104:107], v240 offset:26624
  s_and_b32 s86, s86, 7
  v_mfma_f32_16x16x32_bf16 v[132:135], a[160:163], a[228:231], v[132:135]
  s_waitcnt lgkmcnt(3)
  buffer_load_dwordx4 v252, s[28:31], s48 offen lds
  v_mfma_f32_16x16x32_bf16 v[136:139], a[160:163], a[232:235], v[136:139]
  s_mul_i32 s86, s86, 2265088
  ds_read_b128 a[108:111], v240 offset:27648
  s_add_u32 s86, s86, s74
  v_mfma_f32_16x16x32_bf16 v[136:139], a[176:179], a[248:251], v[136:139]
  s_waitcnt vmcnt(17)
  ds_read_b64_tr_b16 a[192:193], v232 offset:0
  s_add_u32 s87, s40, 7
  v_mfma_f32_16x16x32_bf16 v[140:143], a[176:179], a[252:255], v[140:143]
  s_and_b32 s87, s87, 7
  ds_read_b64_tr_b16 a[194:195], v232 offset:2048
  s_mul_i32 s87, s87, 2265088
  v_mfma_f32_16x16x32_bf16 v[140:143], a[160:163], a[236:239], v[140:143]
  s_add_u32 s87, s87, s74
  buffer_load_dwordx4 v253, s[28:31], s48 offen offset:1024 lds
  v_mfma_f32_16x16x32_bf16 v[156:159], a[164:167], a[236:239], v[156:159]
  s_lshr_b32 s78, s40, 1
  ds_read_b64_tr_b16 a[196:197], v233 offset:0
  s_lshl_b32 s78, s78, 13
  v_mfma_f32_16x16x32_bf16 v[156:159], a[180:183], a[252:255], v[156:159]
  s_add_u32 s78, s78, 98304
  ds_read_b64_tr_b16 a[198:199], v233 offset:2048
  v_lshlrev_b32 v242, 4, v247
  v_mfma_f32_16x16x32_bf16 v[152:155], a[180:183], a[248:251], v[152:155]
  ds_read_b64_tr_b16 a[200:201], v234 offset:0
  v_mov_b32 v229, v242
  v_mfma_f32_16x16x32_bf16 v[152:155], a[164:167], a[232:235], v[152:155]
  buffer_load_dwordx4 v254, s[28:31], s48 offen offset:2048 lds
  v_mfma_f32_16x16x32_bf16 v[148:151], a[164:167], a[228:231], v[148:151]
  ds_read_b64_tr_b16 a[202:203], v234 offset:2048
  v_and_b32 v11, 15, v247
  v_mfma_f32_16x16x32_bf16 v[148:151], a[180:183], a[244:247], v[148:151]
  ds_read_b64_tr_b16 a[204:205], v235 offset:0
  v_and_b32 v7, 48, v247
  v_mfma_f32_16x16x32_bf16 v[144:147], a[180:183], a[240:243], v[144:147]
  ds_read_b64_tr_b16 a[206:207], v235 offset:2048
  v_lshl_add_u32 v230, v11, 10, v7
  v_mfma_f32_16x16x32_bf16 v[144:147], a[164:167], a[224:227], v[144:147]
  buffer_load_dwordx4 v255, s[28:31], s48 offen offset:3072 lds
  v_mfma_f32_16x16x32_bf16 v[160:163], a[168:171], a[224:227], v[160:163]
  s_add_u32 m0, s43, 0
  s_add_u32 s48, s45, 1605632
  ds_read_b128 a[112:115], v241 offset:28672
  v_mfma_f32_16x16x32_bf16 v[160:163], a[184:187], a[240:243], v[160:163]
  s_sub_u32 s51, s48, 1835008
  ds_read_b128 a[116:119], v241 offset:29696
  v_lshrrev_b32 v7, 4, v247
  v_mfma_f32_16x16x32_bf16 v[164:167], a[184:187], a[244:247], v[164:167]
  s_min_u32 s48, s48, s51
  ds_read_b128 a[120:123], v241 offset:30720
  s_sub_u32 s49, 98304, s43
  v_mfma_f32_16x16x32_bf16 v[164:167], a[168:171], a[228:231], v[164:167]
  s_waitcnt lgkmcnt(3)
  buffer_load_dwordx4 v252, s[28:31], s48 offen lds
  v_mfma_f32_16x16x32_bf16 v[168:171], a[168:171], a[232:235], v[168:171]
  ds_read_b128 a[124:127], v241 offset:31744
  v_lshl_add_u32 v12, v7, 9, s49
  v_mfma_f32_16x16x32_bf16 v[168:171], a[184:187], a[248:251], v[168:171]
  s_waitcnt vmcnt(17)
  ds_read_b64_tr_b16 a[208:209], v232 offset:4096
  v_add_u32 v196, v232, v12
  v_mfma_f32_16x16x32_bf16 v[172:175], a[184:187], a[252:255], v[172:175]
  ds_read_b64_tr_b16 a[210:211], v232 offset:6144
  v_add_u32 v197, v233, v12
  v_mfma_f32_16x16x32_bf16 v[172:175], a[168:171], a[236:239], v[172:175]
  buffer_load_dwordx4 v253, s[28:31], s48 offen offset:1024 lds
  v_mfma_f32_16x16x32_bf16 v[188:191], a[172:175], a[236:239], v[188:191]
  ds_read_b64_tr_b16 a[212:213], v233 offset:4096
  v_add_u32 v198, v234, v12
  v_mfma_f32_16x16x32_bf16 v[188:191], a[188:191], a[252:255], v[188:191]
  ds_read_b64_tr_b16 a[214:215], v233 offset:6144
  v_add_u32 v199, v235, v12
  v_mfma_f32_16x16x32_bf16 v[184:187], a[188:191], a[248:251], v[184:187]
  ds_read_b64_tr_b16 a[216:217], v234 offset:4096
  v_xor_b32 v13, v7, v11
  v_mfma_f32_16x16x32_bf16 v[184:187], a[172:175], a[232:235], v[184:187]
  buffer_load_dwordx4 v254, s[28:31], s48 offen offset:2048 lds
  v_mfma_f32_16x16x32_bf16 v[180:183], a[172:175], a[228:231], v[180:183]
  ds_read_b64_tr_b16 a[218:219], v234 offset:6144
  v_lshlrev_b32 v13, 4, v13
  v_mfma_f32_16x16x32_bf16 v[180:183], a[188:191], a[244:247], v[180:183]
  ds_read_b64_tr_b16 a[220:221], v235 offset:4096
  v_lshl_add_u32 v14, v11, 8, v13
  v_mfma_f32_16x16x32_bf16 v[176:179], a[188:191], a[240:243], v[176:179]
  ds_read_b64_tr_b16 a[222:223], v235 offset:6144
  v_lshl_add_u32 v15, v7, 8, v13
  v_mfma_f32_16x16x32_bf16 v[176:179], a[172:175], a[224:227], v[176:179]
  buffer_load_dwordx4 v255, s[28:31], s48 offen offset:3072 lds
  v_mfma_f32_16x16x32_bf16 v[128:131], a[192:195], a[96:99], v[128:131]
  s_waitcnt lgkmcnt(6)
  s_add_u32 m0, s43, 4096
  s_add_u32 s48, s45, 1720320
  ds_read_b128 a[224:227], v240 offset:49152
  v_mfma_f32_16x16x32_bf16 v[128:131], a[208:211], a[112:115], v[128:131]
  s_sub_u32 s51, s48, 1835008
  ds_read_b128 a[228:231], v240 offset:50176
  v_xor_b32 v192, 0, v14
  v_mfma_f32_16x16x32_bf16 v[132:135], a[208:211], a[116:119], v[132:135]
  s_min_u32 s48, s48, s51
  ds_read_b128 a[232:235], v240 offset:51200
  v_xor_b32 v200, 0, v15
  v_mfma_f32_16x16x32_bf16 v[132:135], a[192:195], a[100:103], v[132:135]
  s_waitcnt lgkmcnt(3)
  buffer_load_dwordx4 v252, s[28:31], s48 offen lds
  v_mfma_f32_16x16x32_bf16 v[136:139], a[192:195], a[104:107], v[136:139]
  ds_read_b128 a[236:239], v240 offset:52224
  v_xor_b32 v193, 64, v14
  v_mfma_f32_16x16x32_bf16 v[136:139], a[208:211], a[120:123], v[136:139]
  s_waitcnt vmcnt(17)
  ds_read_b64_tr_b16 a[160:161], v232 offset:32768
  v_xor_b32 v201, 64, v15
  v_mfma_f32_16x16x32_bf16 v[140:143], a[208:211], a[124:127], v[140:143]
  ds_read_b64_tr_b16 a[162:163], v232 offset:34816
  v_xor_b32 v194, 128, v14
  v_mfma_f32_16x16x32_bf16 v[140:143], a[192:195], a[108:111], v[140:143]
  buffer_load_dwordx4 v253, s[28:31], s48 offen offset:1024 lds
  v_mfma_f32_16x16x32_bf16 v[156:159], a[196:199], a[108:111], v[156:159]
  ds_read_b64_tr_b16 a[164:165], v233 offset:32768
  v_xor_b32 v202, 128, v15
  v_mfma_f32_16x16x32_bf16 v[156:159], a[212:215], a[124:127], v[156:159]
  ds_read_b64_tr_b16 a[166:167], v233 offset:34816
  v_xor_b32 v195, 192, v14
  v_mfma_f32_16x16x32_bf16 v[152:155], a[212:215], a[120:123], v[152:155]
  ds_read_b64_tr_b16 a[168:169], v234 offset:32768
  v_xor_b32 v203, 192, v15
  v_mfma_f32_16x16x32_bf16 v[152:155], a[196:199], a[104:107], v[152:155]
  buffer_load_dwordx4 v254, s[28:31], s48 offen offset:2048 lds
  v_mfma_f32_16x16x32_bf16 v[148:151], a[196:199], a[100:103], v[148:151]
  ds_read_b64_tr_b16 a[170:171], v234 offset:34816
  v_lshrrev_b32 v12, 5, v247
  v_mfma_f32_16x16x32_bf16 v[148:151], a[212:215], a[116:119], v[148:151]
  ds_read_b64_tr_b16 a[172:173], v235 offset:32768
  v_bfe_u32 v9, v247, 3, 2
  v_mfma_f32_16x16x32_bf16 v[144:147], a[212:215], a[112:115], v[144:147]
  ds_read_b64_tr_b16 a[174:175], v235 offset:34816
  v_and_b32 v13, 7, v247
  v_mfma_f32_16x16x32_bf16 v[144:147], a[196:199], a[96:99], v[144:147]
  buffer_load_dwordx4 v255, s[28:31], s48 offen offset:3072 lds
  v_mfma_f32_16x16x32_bf16 v[160:163], a[200:203], a[96:99], v[160:163]
  s_add_u32 m0, s43, 32768
  ds_read_b128 a[240:243], v241 offset:53248
  v_and_b32 v14, 2, v9
  v_mfma_f32_16x16x32_bf16 v[160:163], a[216:219], a[112:115], v[160:163]
  s_add_u32 s48, s44, 3670016
  ds_read_b128 a[244:247], v241 offset:54272
  v_xor_b32 v13, v13, v14
  v_mfma_f32_16x16x32_bf16 v[164:167], a[216:219], a[116:119], v[164:167]
  s_and_b32 s48, s48, 0x3fffff
  ds_read_b128 a[248:251], v241 offset:55296
  v_lshlrev_b32 v13, 4, v13
  v_mfma_f32_16x16x32_bf16 v[164:167], a[200:203], a[100:103], v[164:167]
  s_waitcnt lgkmcnt(3)
  buffer_load_dwordx4 v248, s[20:23], s48 offen lds
  v_mfma_f32_16x16x32_bf16 v[168:171], a[200:203], a[104:107], v[168:171]
  ds_read_b128 a[252:255], v241 offset:56320
  v_lshl_add_u32 v13, v12, 7, v13
  v_mfma_f32_16x16x32_bf16 v[168:171], a[216:219], a[120:123], v[168:171]
  s_waitcnt vmcnt(17)
  ds_read_b64_tr_b16 a[176:177], v232 offset:36864
  v_lshl_add_u32 v204, v9, 8, v13
  v_mfma_f32_16x16x32_bf16 v[172:175], a[216:219], a[124:127], v[172:175]
  ds_read_b64_tr_b16 a[178:179], v232 offset:38912
  v_xor_b32 v205, 64, v204
  v_mfma_f32_16x16x32_bf16 v[172:175], a[200:203], a[108:111], v[172:175]
  buffer_load_dwordx4 v249, s[20:23], s48 offen offset:1024 lds
  v_mfma_f32_16x16x32_bf16 v[188:191], a[204:207], a[108:111], v[188:191]
  ds_read_b64_tr_b16 a[180:181], v233 offset:36864
  v_or_b32 v13, s42, v247
  v_mfma_f32_16x16x32_bf16 v[188:191], a[220:223], a[124:127], v[188:191]
  ds_read_b64_tr_b16 a[182:183], v233 offset:38912
  v_cmp_eq_u32 vcc, 0, v13
  v_mfma_f32_16x16x32_bf16 v[184:187], a[220:223], a[120:123], v[184:187]
  ds_read_b64_tr_b16 a[184:185], v234 offset:36864
  v_mov_b32 v14, s59
  v_mfma_f32_16x16x32_bf16 v[184:187], a[204:207], a[104:107], v[184:187]
L_hop1:
  s_cbranch_execz L_hop5
  buffer_load_dwordx4 v250, s[20:23], s48 offen offset:2048 lds
  v_mfma_f32_16x16x32_bf16 v[180:183], a[204:207], a[100:103], v[180:183]
  ds_read_b64_tr_b16 a[186:187], v234 offset:38912
  v_mov_b32 v16, 1073741824
  v_mfma_f32_16x16x32_bf16 v[180:183], a[220:223], a[116:119], v[180:183]
  ds_read_b64_tr_b16 a[188:189], v235 offset:36864
  v_cndmask_b32 v207, v16, v14, vcc
  v_mfma_f32_16x16x32_bf16 v[176:179], a[220:223], a[112:115], v[176:179]
  ds_read_b64_tr_b16 a[190:191], v235 offset:38912
  v_lshrrev_b32 v13, 1, v11
  v_mfma_f32_16x16x32_bf16 v[176:179], a[204:207], a[96:99], v[176:179]
  buffer_load_dwordx4 v251, s[20:23], s48 offen offset:3072 lds
  v_mfma_f32_16x16x32_bf16 v[128:131], a[160:163], a[224:227], v[128:131]
  s_waitcnt lgkmcnt(6)
  s_add_u32 m0, s43, 36864
  ds_read_b128 a[128:131], v240 offset:32768
  v_cmp_eq_u32 vcc, v13, v12
  v_mfma_f32_16x16x32_bf16 v[128:131], a[176:179], a[240:243], v[128:131]
  s_add_u32 s48, s44, 3932160
  ds_read_b128 a[132:135], v240 offset:33792
  v_mov_b32 v14, 0x3f803f80
  v_mfma_f32_16x16x32_bf16 v[132:135], a[176:179], a[244:247], v[132:135]
  s_and_b32 s48, s48, 0x3fffff
  ds_read_b128 a[136:139], v240 offset:34816
  v_cndmask_b32 v212, 0, v14, vcc
  v_mfma_f32_16x16x32_bf16 v[132:135], a[160:163], a[228:231], v[132:135]
  s_waitcnt lgkmcnt(3)
  buffer_load_dwordx4 v248, s[20:23], s48 offen lds
  v_mfma_f32_16x16x32_bf16 v[136:139], a[160:163], a[232:235], v[136:139]
  ds_read_b128 a[140:143], v240 offset:35840
  v_mov_b32 v213, v212
  v_mfma_f32_16x16x32_bf16 v[136:139], a[176:179], a[248:251], v[136:139]
  s_waitcnt vmcnt(17)
  ds_read_b64_tr_b16 a[192:193], v236 offset:0
  v_mov_b32 v214, v212
  v_mfma_f32_16x16x32_bf16 v[140:143], a[176:179], a[252:255], v[140:143]
  ds_read_b64_tr_b16 a[194:195], v236 offset:2048
  v_mov_b32 v215, v212
  v_mfma_f32_16x16x32_bf16 v[140:143], a[160:163], a[236:239], v[140:143]
  buffer_load_dwordx4 v249, s[20:23], s48 offen offset:1024 lds
  v_mfma_f32_16x16x32_bf16 v[156:159], a[164:167], a[236:239], v[156:159]
  ds_read_b64_tr_b16 a[196:197], v237 offset:0
  v_mfma_f32_16x16x32_bf16 v[156:159], a[180:183], a[252:255], v[156:159]
  ds_read_b64_tr_b16 a[198:199], v237 offset:2048
  v_mfma_f32_16x16x32_bf16 v[152:155], a[180:183], a[248:251], v[152:155]
  ds_read_b64_tr_b16 a[200:201], v238 offset:0
  v_mfma_f32_16x16x32_bf16 v[152:155], a[164:167], a[232:235], v[152:155]
  buffer_load_dwordx4 v250, s[20:23], s48 offen offset:2048 lds
  v_mfma_f32_16x16x32_bf16 v[148:151], a[164:167], a[228:231], v[148:151]
  ds_read_b64_tr_b16 a[202:203], v238 offset:2048
  v_mfma_f32_16x16x32_bf16 v[148:151], a[180:183], a[244:247], v[148:151]
  ds_read_b64_tr_b16 a[204:205], v239 offset:0
  v_mfma_f32_16x16x32_bf16 v[144:147], a[180:183], a[240:243], v[144:147]
  ds_read_b64_tr_b16 a[206:207], v239 offset:2048
  v_mfma_f32_16x16x32_bf16 v[144:147], a[164:167], a[224:227], v[144:147]
  buffer_load_dwordx4 v251, s[20:23], s48 offen offset:3072 lds
  v_mfma_f32_16x16x32_bf16 v[160:163], a[168:171], a[224:227], v[160:163]
  s_add_u32 m0, s43, 65536
  ds_read_b128 a[144:147], v241 offset:36864
  v_mfma_f32_16x16x32_bf16 v[160:163], a[184:187], a[240:243], v[160:163]
  s_add_u32 s48, s44, 3670144
  ds_read_b128 a[148:151], v241 offset:37888
  v_mfma_f32_16x16x32_bf16 v[164:167], a[184:187], a[244:247], v[164:167]
  s_and_b32 s48, s48, 0x3fffff
  ds_read_b128 a[152:155], v241 offset:38912
  v_mfma_f32_16x16x32_bf16 v[164:167], a[168:171], a[228:231], v[164:167]
  s_waitcnt lgkmcnt(3)
  buffer_load_dwordx4 v248, s[20:23], s48 offen lds
  v_mfma_f32_16x16x32_bf16 v[168:171], a[168:171], a[232:235], v[168:171]
  ds_read_b128 a[156:159], v241 offset:39936
  v_mfma_f32_16x16x32_bf16 v[168:171], a[184:187], a[248:251], v[168:171]
  s_waitcnt vmcnt(17)
  ds_read_b64_tr_b16 a[208:209], v236 offset:4096
  v_mfma_f32_16x16x32_bf16 v[172:175], a[184:187], a[252:255], v[172:175]
  ds_read_b64_tr_b16 a[210:211], v236 offset:6144
  v_mfma_f32_16x16x32_bf16 v[172:175], a[168:171], a[236:239], v[172:175]
  buffer_load_dwordx4 v249, s[20:23], s48 offen offset:1024 lds
  v_mfma_f32_16x16x32_bf16 v[188:191], a[172:175], a[236:239], v[188:191]
  ds_read_b64_tr_b16 a[212:213], v237 offset:4096
  v_mfma_f32_16x16x32_bf16 v[188:191], a[188:191], a[252:255], v[188:191]
  ds_read_b64_tr_b16 a[214:215], v237 offset:6144
  v_mfma_f32_16x16x32_bf16 v[184:187], a[188:191], a[248:251], v[184:187]
  ds_read_b64_tr_b16 a[216:217], v238 offset:4096
  v_mfma_f32_16x16x32_bf16 v[184:187], a[172:175], a[232:235], v[184:187]
  buffer_load_dwordx4 v250, s[20:23], s48 offen offset:2048 lds
  v_mfma_f32_16x16x32_bf16 v[180:183], a[172:175], a[228:231], v[180:183]
  ds_read_b64_tr_b16 a[218:219], v238 offset:6144
  v_mfma_f32_16x16x32_bf16 v[180:183], a[188:191], a[244:247], v[180:183]
  ds_read_b64_tr_b16 a[220:221], v239 offset:4096
  v_mfma_f32_16x16x32_bf16 v[176:179], a[188:191], a[240:243], v[176:179]
  ds_read_b64_tr_b16 a[222:223], v239 offset:6144
  v_mfma_f32_16x16x32_bf16 v[176:179], a[172:175], a[224:227], v[176:179]
  buffer_load_dwordx4 v251, s[20:23], s48 offen offset:3072 lds
  v_mfma_f32_16x16x32_bf16 v[128:131], a[192:195], a[128:131], v[128:131]
  s_waitcnt lgkmcnt(6)
  s_add_u32 m0, s43, 69632
  ds_read_b128 a[224:227], v240 offset:57344
  v_mfma_f32_16x16x32_bf16 v[128:131], a[208:211], a[144:147], v[128:131]
  s_add_u32 s48, s44, 3932288
  ds_read_b128 a[228:231], v240 offset:58368
  v_mfma_f32_16x16x32_bf16 v[132:135], a[208:211], a[148:151], v[132:135]
  s_and_b32 s48, s48, 0x3fffff
  ds_read_b128 a[232:235], v240 offset:59392
  v_mfma_f32_16x16x32_bf16 v[132:135], a[192:195], a[132:135], v[132:135]
  s_waitcnt lgkmcnt(3)
  buffer_load_dwordx4 v248, s[20:23], s48 offen lds
  v_mfma_f32_16x16x32_bf16 v[136:139], a[192:195], a[136:139], v[136:139]
  ds_read_b128 a[236:239], v240 offset:60416
  v_mfma_f32_16x16x32_bf16 v[136:139], a[208:211], a[152:155], v[136:139]
  s_waitcnt vmcnt(17)
  ds_read_b64_tr_b16 a[160:161], v232 offset:0
  v_mfma_f32_16x16x32_bf16 v[140:143], a[208:211], a[156:159], v[140:143]
  ds_read_b64_tr_b16 a[162:163], v232 offset:2048
  v_mfma_f32_16x16x32_bf16 v[140:143], a[192:195], a[140:143], v[140:143]
  buffer_load_dwordx4 v249, s[20:23], s48 offen offset:1024 lds
  v_mfma_f32_16x16x32_bf16 v[156:159], a[196:199], a[140:143], v[156:159]
  ds_read_b64_tr_b16 a[164:165], v233 offset:0
  v_mfma_f32_16x16x32_bf16 v[156:159], a[212:215], a[156:159], v[156:159]
  ds_read_b64_tr_b16 a[166:167], v233 offset:2048
  v_mfma_f32_16x16x32_bf16 v[152:155], a[212:215], a[152:155], v[152:155]
  ds_read_b64_tr_b16 a[168:169], v234 offset:0
  v_mfma_f32_16x16x32_bf16 v[152:155], a[196:199], a[136:139], v[152:155]
  buffer_load_dwordx4 v250, s[20:23], s48 offen offset:2048 lds
  v_mfma_f32_16x16x32_bf16 v[148:151], a[196:199], a[132:135], v[148:151]
  ds_read_b64_tr_b16 a[170:171], v234 offset:2048
  v_mfma_f32_16x16x32_bf16 v[148:151], a[212:215], a[148:151], v[148:151]
  ds_read_b64_tr_b16 a[172:173], v235 offset:0
  v_mfma_f32_16x16x32_bf16 v[144:147], a[212:215], a[144:147], v[144:147]
  ds_read_b64_tr_b16 a[174:175], v235 offset:2048
  v_mfma_f32_16x16x32_bf16 v[144:147], a[196:199], a[128:131], v[144:147]
  buffer_load_dwordx4 v251, s[20:23], s48 offen offset:3072 lds
  v_mfma_f32_16x16x32_bf16 v[160:163], a[200:203], a[128:131], v[160:163]
  s_add_u32 m0, s43, 0
  ds_read_b128 a[240:243], v241 offset:61440
  v_mfma_f32_16x16x32_bf16 v[160:163], a[216:219], a[144:147], v[160:163]
  s_add_u32 s48, s44, 0
  ds_read_b128 a[244:247], v241 offset:62464
  v_mfma_f32_16x16x32_bf16 v[164:167], a[216:219], a[148:151], v[164:167]
  s_and_b32 s48, s48, 0x3fffff
  ds_read_b128 a[248:251], v241 offset:63488
  v_mfma_f32_16x16x32_bf16 v[164:167], a[200:203], a[132:135], v[164:167]
  s_waitcnt lgkmcnt(3)
  buffer_load_dwordx4 v248, s[20:23], s48 offen lds
  v_mfma_f32_16x16x32_bf16 v[168:171], a[200:203], a[136:139], v[168:171]
  ds_read_b128 a[252:255], v241 offset:64512
  v_mfma_f32_16x16x32_bf16 v[168:171], a[216:219], a[152:155], v[168:171]
  s_waitcnt vmcnt(17)
  ds_read_b64_tr_b16 a[176:177], v232 offset:4096
  v_mfma_f32_16x16x32_bf16 v[172:175], a[216:219], a[156:159], v[172:175]
  ds_read_b64_tr_b16 a[178:179], v232 offset:6144
  v_mfma_f32_16x16x32_bf16 v[172:175], a[200:203], a[140:143], v[172:175]
  buffer_load_dwordx4 v249, s[20:23], s48 offen offset:1024 lds
  v_mfma_f32_16x16x32_bf16 v[188:191], a[204:207], a[140:143], v[188:191]
  ds_read_b64_tr_b16 a[180:181], v233 offset:4096
  v_mfma_f32_16x16x32_bf16 v[188:191], a[220:223], a[156:159], v[188:191]
  ds_read_b64_tr_b16 a[182:183], v233 offset:6144
  v_mfma_f32_16x16x32_bf16 v[184:187], a[220:223], a[152:155], v[184:187]
  ds_read_b64_tr_b16 a[184:185], v234 offset:4096
  v_mfma_f32_16x16x32_bf16 v[184:187], a[204:207], a[136:139], v[184:187]
  buffer_load_dwordx4 v250, s[20:23], s48 offen offset:2048 lds
  v_mfma_f32_16x16x32_bf16 v[180:183], a[204:207], a[132:135], v[180:183]
  ds_read_b64_tr_b16 a[186:187], v234 offset:6144
  v_mfma_f32_16x16x32_bf16 v[180:183], a[220:223], a[148:151], v[180:183]
  ds_read_b64_tr_b16 a[188:189], v235 offset:4096
  v_mfma_f32_16x16x32_bf16 v[176:179], a[220:223], a[144:147], v[176:179]
  ds_read_b64_tr_b16 a[190:191], v235 offset:6144
  v_mfma_f32_16x16x32_bf16 v[176:179], a[204:207], a[128:131], v[176:179]
  buffer_load_dwordx4 v251, s[20:23], s48 offen offset:3072 lds
  v_mfma_f32_16x16x32_bf16 v[128:131], a[160:163], a[224:227], v[128:131]
  s_waitcnt vmcnt(16)
  s_waitcnt lgkmcnt(6)
  s_add_u32 m0, s43, 4096
  ds_read_b64_tr_b16 a[192:193], v232 offset:32768
  v_mfma_f32_16x16x32_bf16 v[128:131], a[176:179], a[240:243], v[128:131]
  s_add_u32 s48, s44, 262144
  ds_read_b64_tr_b16 a[194:195], v232 offset:34816
  v_mfma_f32_16x16x32_bf16 v[132:135], a[176:179], a[244:247], v[132:135]
  s_and_b32 s48, s48, 0x3fffff
  ds_read_b64_tr_b16 a[196:197], v233 offset:32768
  v_mfma_f32_16x16x32_bf16 v[132:135], a[160:163], a[228:231], v[132:135]
  s_waitcnt lgkmcnt(3)
  buffer_load_dwordx4 v248, s[20:23], s48 offen lds
  v_mfma_f32_16x16x32_bf16 v[136:139], a[160:163], a[232:235], v[136:139]
  ds_read_b64_tr_b16 a[198:199], v233 offset:34816
  v_mfma_f32_16x16x32_bf16 v[136:139], a[176:179], a[248:251], v[136:139]
  ds_read_b64_tr_b16 a[200:201], v234 offset:32768
  v_mfma_f32_16x16x32_bf16 v[140:143], a[176:179], a[252:255], v[140:143]
  ds_read_b64_tr_b16 a[202:203], v234 offset:34816
  v_mfma_f32_16x16x32_bf16 v[140:143], a[160:163], a[236:239], v[140:143]
  buffer_load_dwordx4 v249, s[20:23], s48 offen offset:1024 lds
  v_mfma_f32_16x16x32_bf16 v[156:159], a[164:167], a[236:239], v[156:159]
  ds_read_b64_tr_b16 a[204:205], v235 offset:32768
  v_mfma_f32_16x16x32_bf16 v[156:159], a[180:183], a[252:255], v[156:159]
  ds_read_b64_tr_b16 a[206:207], v235 offset:34816
  v_mfma_f32_16x16x32_bf16 v[152:155], a[180:183], a[248:251], v[152:155]
  v_mfma_f32_16x16x32_bf16 v[152:155], a[164:167], a[232:235], v[152:155]
  buffer_load_dwordx4 v250, s[20:23], s48 offen offset:2048 lds
  v_mfma_f32_16x16x32_bf16 v[148:151], a[164:167], a[228:231], v[148:151]
  v_mfma_f32_16x16x32_bf16 v[148:151], a[180:183], a[244:247], v[148:151]
  v_mfma_f32_16x16x32_bf16 v[144:147], a[180:183], a[240:243], v[144:147]
  v_mfma_f32_16x16x32_bf16 v[144:147], a[164:167], a[224:227], v[144:147]
  buffer_load_dwordx4 v251, s[20:23], s48 offen offset:3072 lds
  v_mfma_f32_16x16x32_bf16 v[160:163], a[168:171], a[224:227], v[160:163]
  s_waitcnt vmcnt(16)
  s_add_u32 m0, s43, 32768
  ds_read_b64_tr_b16 a[208:209], v232 offset:36864
  v_mfma_f32_16x16x32_bf16 v[160:163], a[184:187], a[240:243], v[160:163]
  s_add_u32 s48, s44, 3145728
  ds_read_b64_tr_b16 a[210:211], v232 offset:38912
  v_mfma_f32_16x16x32_bf16 v[164:167], a[184:187], a[244:247], v[164:167]
  s_and_b32 s48, s48, 0x3fffff
  ds_read_b64_tr_b16 a[212:213], v233 offset:36864
  v_mfma_f32_16x16x32_bf16 v[164:167], a[168:171], a[228:231], v[164:167]
  s_waitcnt lgkmcnt(3)
  buffer_load_dwordx4 v248, s[20:23], s48 offen lds
  v_mfma_f32_16x16x32_bf16 v[168:171], a[168:171], a[232:235], v[168:171]
  ds_read_b64_tr_b16 a[214:215], v233 offset:38912
  v_mfma_f32_16x16x32_bf16 v[168:171], a[184:187], a[248:251], v[168:171]
  ds_read_b64_tr_b16 a[216:217], v234 offset:36864
  v_mfma_f32_16x16x32_bf16 v[172:175], a[184:187], a[252:255], v[172:175]
  ds_read_b64_tr_b16 a[218:219], v234 offset:38912
  v_mfma_f32_16x16x32_bf16 v[172:175], a[168:171], a[236:239], v[172:175]
  buffer_load_dwordx4 v249, s[20:23], s48 offen offset:1024 lds
  v_mfma_f32_16x16x32_bf16 v[188:191], a[172:175], a[236:239], v[188:191]
  ds_read_b64_tr_b16 a[220:221], v235 offset:36864
  v_mfma_f32_16x16x32_bf16 v[188:191], a[188:191], a[252:255], v[188:191]
  ds_read_b64_tr_b16 a[222:223], v235 offset:38912
  v_mfma_f32_16x16x32_bf16 v[184:187], a[188:191], a[248:251], v[184:187]
  v_mfma_f32_16x16x32_bf16 v[184:187], a[172:175], a[232:235], v[184:187]
  buffer_load_dwordx4 v250, s[20:23], s48 offen offset:2048 lds
  v_mfma_f32_16x16x32_bf16 v[180:183], a[172:175], a[228:231], v[180:183]
  v_mfma_f32_16x16x32_bf16 v[180:183], a[188:191], a[244:247], v[180:183]
  v_mfma_f32_16x16x32_bf16 v[176:179], a[188:191], a[240:243], v[176:179]
  v_mfma_f32_16x16x32_bf16 v[176:179], a[172:175], a[224:227], v[176:179]
  buffer_load_dwordx4 v251, s[20:23], s48 offen offset:3072 lds
  v_mfma_f32_16x16x32_bf16 v[0:3], a[192:195], a[224:227], 0
  s_waitcnt vmcnt(16)
  s_waitcnt lgkmcnt(6)
  s_add_u32 m0, s43, 36864
  ds_read_b64_tr_b16 a[160:161], v236 offset:0
  v_mfma_f32_16x16x32_bf16 v[0:3], a[208:211], a[240:243], v[0:3]
  s_add_u32 s48, s44, 3407872
  ds_read_b64_tr_b16 a[162:163], v236 offset:2048
  v_add_u32 v216, s76, v242
  v_mfma_f32_16x16x32_bf16 v[4:7], a[208:211], a[244:247], 0
  s_and_b32 s48, s48, 0x3fffff
  ds_read_b64_tr_b16 a[164:165], v237 offset:0
  v_add_u32 v217, s77, v242
  v_mfma_f32_16x16x32_bf16 v[4:7], a[192:195], a[228:231], v[4:7]
  s_waitcnt lgkmcnt(3)
  buffer_load_dwordx4 v248, s[20:23], s48 offen lds
  v_mfma_f32_16x16x32_bf16 v[8:11], a[192:195], a[232:235], 0
  ds_read_b64_tr_b16 a[166:167], v237 offset:2048
  v_add_u32 v228, 8192, v242
  v_mfma_f32_16x16x32_bf16 v[8:11], a[208:211], a[248:251], v[8:11]
  s_barrier
  ds_read_b64_tr_b16 a[168:169], v238 offset:0
  v_max_f32 v128, 0, v128
  v_mfma_f32_16x16x32_bf16 v[12:15], a[208:211], a[252:255], 0
  ds_read_b64_tr_b16 a[170:171], v238 offset:2048
  v_max_f32 v129, 0, v129
  v_mfma_f32_16x16x32_bf16 v[12:15], a[192:195], a[236:239], v[12:15]
  buffer_load_dwordx4 v249, s[20:23], s48 offen offset:1024 lds
  v_mfma_f32_16x16x32_bf16 v[28:31], a[196:199], a[236:239], 0
  ds_read_b64_tr_b16 a[172:173], v239 offset:0
  v_max_f32 v130, 0, v130
  v_mfma_f32_16x16x32_bf16 v[28:31], a[212:215], a[252:255], v[28:31]
  ds_read_b64_tr_b16 a[174:175], v239 offset:2048
  v_max_f32 v131, 0, v131
  v_mfma_f32_16x16x32_bf16 v[24:27], a[212:215], a[248:251], 0
  v_max_f32 v144, 0, v144
  v_max_f32 v145, 0, v145
  v_mfma_f32_16x16x32_bf16 v[24:27], a[196:199], a[232:235], v[24:27]
  buffer_load_dwordx4 v250, s[20:23], s48 offen offset:2048 lds
  v_mfma_f32_16x16x32_bf16 v[20:23], a[196:199], a[228:231], 0
  v_max_f32 v146, 0, v146
  v_max_f32 v147, 0, v147
  v_mfma_f32_16x16x32_bf16 v[20:23], a[212:215], a[244:247], v[20:23]
  v_cvt_pk_bf16_f32 v128, v128, v129
  v_cvt_pk_bf16_f32 v129, v130, v131
  v_mfma_f32_16x16x32_bf16 v[16:19], a[212:215], a[240:243], 0
  v_cvt_pk_bf16_f32 v130, v144, v145
  v_cvt_pk_bf16_f32 v131, v146, v147
  v_mfma_f32_16x16x32_bf16 v[16:19], a[196:199], a[224:227], v[16:19]
  buffer_load_dwordx4 v251, s[20:23], s48 offen offset:3072 lds
  v_mfma_f32_16x16x32_bf16 v[32:35], a[200:203], a[224:227], 0
  s_waitcnt vmcnt(16)
  s_add_u32 m0, s43, 65536
  ds_read_b64_tr_b16 a[176:177], v236 offset:4096
  v_mfma_f32_16x16x32_bf16 v[32:35], a[216:219], a[240:243], v[32:35]
  s_add_u32 s48, s44, 3145856
  ds_read_b64_tr_b16 a[178:179], v236 offset:6144
  v_max_f32 v132, 0, v132
  v_mfma_f32_16x16x32_bf16 v[36:39], a[216:219], a[244:247], 0
  s_and_b32 s48, s48, 0x3fffff
  ds_read_b64_tr_b16 a[180:181], v237 offset:4096
  v_max_f32 v133, 0, v133
  v_mfma_f32_16x16x32_bf16 v[36:39], a[200:203], a[228:231], v[36:39]
  s_waitcnt lgkmcnt(3)
  buffer_load_dwordx4 v248, s[20:23], s48 offen lds
  v_mfma_f32_16x16x32_bf16 v[40:43], a[200:203], a[232:235], 0
  ds_read_b64_tr_b16 a[182:183], v237 offset:6144
  v_max_f32 v134, 0, v134
  v_mfma_f32_16x16x32_bf16 v[40:43], a[216:219], a[248:251], v[40:43]
  ds_read_b64_tr_b16 a[184:185], v238 offset:4096
  v_max_f32 v135, 0, v135
  v_mfma_f32_16x16x32_bf16 v[44:47], a[216:219], a[252:255], 0
  ds_read_b64_tr_b16 a[186:187], v238 offset:6144
  v_max_f32 v148, 0, v148
  v_mfma_f32_16x16x32_bf16 v[44:47], a[200:203], a[236:239], v[44:47]
  buffer_load_dwordx4 v249, s[20:23], s48 offen offset:1024 lds
  v_mfma_f32_16x16x32_bf16 v[60:63], a[204:207], a[236:239], 0
  ds_read_b64_tr_b16 a[188:189], v239 offset:4096
  v_max_f32 v149, 0, v149
  v_mfma_f32_16x16x32_bf16 v[60:63], a[220:223], a[252:255], v[60:63]
  ds_read_b64_tr_b16 a[190:191], v239 offset:6144
  v_max_f32 v150, 0, v150
  v_mfma_f32_16x16x32_bf16 v[56:59], a[220:223], a[248:251], 0
  v_max_f32 v151, 0, v151
  v_cvt_pk_bf16_f32 v132, v132, v133
  v_mfma_f32_16x16x32_bf16 v[56:59], a[204:207], a[232:235], v[56:59]
  buffer_load_dwordx4 v250, s[20:23], s48 offen offset:2048 lds
  v_mfma_f32_16x16x32_bf16 v[52:55], a[204:207], a[228:231], 0
  v_cvt_pk_bf16_f32 v133, v134, v135
  v_cvt_pk_bf16_f32 v134, v148, v149
  v_mfma_f32_16x16x32_bf16 v[52:55], a[220:223], a[244:247], v[52:55]
  v_cvt_pk_bf16_f32 v135, v150, v151
  v_max_f32 v136, 0, v136
  v_mfma_f32_16x16x32_bf16 v[48:51], a[220:223], a[240:243], 0
  v_max_f32 v137, 0, v137
  v_max_f32 v138, 0, v138
  v_mfma_f32_16x16x32_bf16 v[48:51], a[204:207], a[224:227], v[48:51]
  buffer_load_dwordx4 v251, s[20:23], s48 offen offset:3072 lds
  v_mfma_f32_16x16x32_bf16 v[64:67], a[160:163], a[224:227], 0
  s_waitcnt vmcnt(16)
  s_waitcnt lgkmcnt(6)
  s_add_u32 m0, s43, 69632
  ds_read_b64_tr_b16 a[192:193], v232 offset:0
  v_mfma_f32_16x16x32_bf16 v[64:67], a[176:179], a[240:243], v[64:67]
  s_add_u32 s48, s44, 3408000
  ds_read_b64_tr_b16 a[194:195], v232 offset:2048
  v_max_f32 v139, 0, v139
  v_mfma_f32_16x16x32_bf16 v[68:71], a[176:179], a[244:247], 0
  s_and_b32 s48, s48, 0x3fffff
  ds_read_b64_tr_b16 a[196:197], v233 offset:0
  v_max_f32 v152, 0, v152
  v_mfma_f32_16x16x32_bf16 v[68:71], a[160:163], a[228:231], v[68:71]
  s_waitcnt lgkmcnt(3)
  buffer_load_dwordx4 v248, s[20:23], s48 offen lds
  v_mfma_f32_16x16x32_bf16 v[72:75], a[160:163], a[232:235], 0
  ds_read_b64_tr_b16 a[198:199], v233 offset:2048
  v_max_f32 v153, 0, v153
  v_mfma_f32_16x16x32_bf16 v[72:75], a[176:179], a[248:251], v[72:75]
  ds_read_b64_tr_b16 a[200:201], v234 offset:0
  v_max_f32 v154, 0, v154
  v_mfma_f32_16x16x32_bf16 v[76:79], a[176:179], a[252:255], 0
  ds_read_b64_tr_b16 a[202:203], v234 offset:2048
  v_max_f32 v155, 0, v155
  v_mfma_f32_16x16x32_bf16 v[76:79], a[160:163], a[236:239], v[76:79]
  buffer_load_dwordx4 v249, s[20:23], s48 offen offset:1024 lds
  v_mfma_f32_16x16x32_bf16 v[92:95], a[164:167], a[236:239], 0
  ds_read_b64_tr_b16 a[204:205], v235 offset:0
  v_cvt_pk_bf16_f32 v136, v136, v137
  v_mfma_f32_16x16x32_bf16 v[92:95], a[180:183], a[252:255], v[92:95]
  ds_read_b64_tr_b16 a[206:207], v235 offset:2048
  v_cvt_pk_bf16_f32 v137, v138, v139
  v_mfma_f32_16x16x32_bf16 v[88:91], a[180:183], a[248:251], 0
  v_cvt_pk_bf16_f32 v138, v152, v153
  v_cvt_pk_bf16_f32 v139, v154, v155
  v_mfma_f32_16x16x32_bf16 v[88:91], a[164:167], a[232:235], v[88:91]
  buffer_load_dwordx4 v250, s[20:23], s48 offen offset:2048 lds
  v_mfma_f32_16x16x32_bf16 v[84:87], a[164:167], a[228:231], 0
  v_max_f32 v140, 0, v140
  v_max_f32 v141, 0, v141
  v_mfma_f32_16x16x32_bf16 v[84:87], a[180:183], a[244:247], v[84:87]
  v_max_f32 v142, 0, v142
  v_max_f32 v143, 0, v143
  v_mfma_f32_16x16x32_bf16 v[80:83], a[180:183], a[240:243], 0
  v_max_f32 v156, 0, v156
  v_max_f32 v157, 0, v157
  v_mfma_f32_16x16x32_bf16 v[80:83], a[164:167], a[224:227], v[80:83]
  buffer_load_dwordx4 v251, s[20:23], s48 offen offset:3072 lds
  v_mfma_f32_16x16x32_bf16 v[96:99], a[168:171], a[224:227], 0
  s_waitcnt vmcnt(16)
  s_add_u32 m0, s43, 0
  ds_read_b64_tr_b16 a[208:209], v232 offset:4096
  v_mfma_f32_16x16x32_bf16 v[96:99], a[184:187], a[240:243], v[96:99]
  s_add_u32 s48, s44, 524288
  ds_read_b64_tr_b16 a[210:211], v232 offset:6144
  v_max_f32 v158, 0, v158
  v_mfma_f32_16x16x32_bf16 v[100:103], a[184:187], a[244:247], 0
  s_and_b32 s48, s48, 0x3fffff
  ds_read_b64_tr_b16 a[212:213], v233 offset:4096
  v_max_f32 v159, 0, v159
  v_mfma_f32_16x16x32_bf16 v[100:103], a[168:171], a[228:231], v[100:103]
  s_waitcnt lgkmcnt(3)
  buffer_load_dwordx4 v248, s[20:23], s48 offen lds
  v_mfma_f32_16x16x32_bf16 v[104:107], a[168:171], a[232:235], 0
  ds_read_b64_tr_b16 a[214:215], v233 offset:6144
  v_cvt_pk_bf16_f32 v140, v140, v141
  v_mfma_f32_16x16x32_bf16 v[104:107], a[184:187], a[248:251], v[104:107]
  ds_read_b64_tr_b16 a[216:217], v234 offset:4096
  v_cvt_pk_bf16_f32 v141, v142, v143
  v_mfma_f32_16x16x32_bf16 v[108:111], a[184:187], a[252:255], 0
  ds_read_b64_tr_b16 a[218:219], v234 offset:6144
  v_cvt_pk_bf16_f32 v142, v156, v157
  v_mfma_f32_16x16x32_bf16 v[108:111], a[168:171], a[236:239], v[108:111]
  buffer_load_dwordx4 v249, s[20:23], s48 offen offset:1024 lds
  v_mfma_f32_16x16x32_bf16 v[124:127], a[172:175], a[236:239], 0
  ds_read_b64_tr_b16 a[220:221], v235 offset:4096
  v_cvt_pk_bf16_f32 v143, v158, v159
  v_mfma_f32_16x16x32_bf16 v[124:127], a[188:191], a[252:255], v[124:127]
  ds_read_b64_tr_b16 a[222:223], v235 offset:6144
  v_max_f32 v160, 0, v160
  v_mfma_f32_16x16x32_bf16 v[120:123], a[188:191], a[248:251], 0
  v_max_f32 v161, 0, v161
  v_max_f32 v162, 0, v162
  v_mfma_f32_16x16x32_bf16 v[120:123], a[172:175], a[232:235], v[120:123]
  buffer_load_dwordx4 v250, s[20:23], s48 offen offset:2048 lds
  v_mfma_f32_16x16x32_bf16 v[116:119], a[172:175], a[228:231], 0
  v_max_f32 v163, 0, v163
  v_max_f32 v176, 0, v176
  v_mfma_f32_16x16x32_bf16 v[116:119], a[188:191], a[244:247], v[116:119]
  v_max_f32 v177, 0, v177
  v_max_f32 v178, 0, v178
  v_mfma_f32_16x16x32_bf16 v[112:115], a[188:191], a[240:243], 0
  v_max_f32 v179, 0, v179
  v_cvt_pk_bf16_f32 v160, v160, v161
  v_mfma_f32_16x16x32_bf16 v[112:115], a[172:175], a[224:227], v[112:115]
  buffer_load_dwordx4 v251, s[20:23], s48 offen offset:3072 lds
  v_mfma_f32_16x16x32_bf16 v[0:3], a[192:195], a[0:3], v[0:3]
  s_waitcnt lgkmcnt(6)
  s_add_u32 m0, s43, 4096
  ds_read_b128 a[224:227], v240 offset:49152
  v_cvt_pk_bf16_f32 v161, v162, v163
  v_mfma_f32_16x16x32_bf16 v[0:3], a[208:211], a[16:19], v[0:3]
  s_add_u32 s48, s44, 786432
  ds_read_b128 a[228:231], v240 offset:50176
  v_cvt_pk_bf16_f32 v162, v176, v177
  v_mfma_f32_16x16x32_bf16 v[4:7], a[208:211], a[20:23], v[4:7]
  s_and_b32 s48, s48, 0x3fffff
  ds_read_b128 a[232:235], v240 offset:51200
  v_cvt_pk_bf16_f32 v163, v178, v179
  v_mfma_f32_16x16x32_bf16 v[4:7], a[192:195], a[4:7], v[4:7]
  s_waitcnt lgkmcnt(3)
  buffer_load_dwordx4 v248, s[20:23], s48 offen lds
  v_mfma_f32_16x16x32_bf16 v[8:11], a[192:195], a[8:11], v[8:11]
  ds_read_b128 a[236:239], v240 offset:52224
  v_max_f32 v164, 0, v164
  v_mfma_f32_16x16x32_bf16 v[8:11], a[208:211], a[24:27], v[8:11]
  s_waitcnt vmcnt(17)
  ds_read_b64_tr_b16 a[160:161], v232 offset:32768
  v_max_f32 v165, 0, v165
  v_mfma_f32_16x16x32_bf16 v[12:15], a[208:211], a[28:31], v[12:15]
  ds_read_b64_tr_b16 a[162:163], v232 offset:34816
  v_max_f32 v166, 0, v166
  v_mfma_f32_16x16x32_bf16 v[12:15], a[192:195], a[12:15], v[12:15]
  buffer_load_dwordx4 v249, s[20:23], s48 offen offset:1024 lds
  v_mfma_f32_16x16x32_bf16 v[28:31], a[196:199], a[12:15], v[28:31]
  ds_read_b64_tr_b16 a[164:165], v233 offset:32768
  v_max_f32 v167, 0, v167
  v_mfma_f32_16x16x32_bf16 v[28:31], a[212:215], a[28:31], v[28:31]
  ds_read_b64_tr_b16 a[166:167], v233 offset:34816
  v_max_f32 v180, 0, v180
  v_mfma_f32_16x16x32_bf16 v[24:27], a[212:215], a[24:27], v[24:27]
  ds_read_b64_tr_b16 a[168:169], v234 offset:32768
  v_max_f32 v181, 0, v181
  v_mfma_f32_16x16x32_bf16 v[24:27], a[196:199], a[8:11], v[24:27]
  buffer_load_dwordx4 v250, s[20:23], s48 offen offset:2048 lds
  v_mfma_f32_16x16x32_bf16 v[20:23], a[196:199], a[4:7], v[20:23]
  ds_read_b64_tr_b16 a[170:171], v234 offset:34816
  v_max_f32 v182, 0, v182
  v_mfma_f32_16x16x32_bf16 v[20:23], a[212:215], a[20:23], v[20:23]
  ds_read_b64_tr_b16 a[172:173], v235 offset:32768
  v_max_f32 v183, 0, v183
  v_mfma_f32_16x16x32_bf16 v[16:19], a[212:215], a[16:19], v[16:19]
  ds_read_b64_tr_b16 a[174:175], v235 offset:34816
  v_cvt_pk_bf16_f32 v164, v164, v165
  v_mfma_f32_16x16x32_bf16 v[16:19], a[196:199], a[0:3], v[16:19]
  buffer_load_dwordx4 v251, s[20:23], s48 offen offset:3072 lds
  v_mfma_f32_16x16x32_bf16 v[32:35], a[200:203], a[0:3], v[32:35]
  s_add_u32 m0, s43, 32768
  ds_read_b128 a[240:243], v241 offset:53248
  v_cvt_pk_bf16_f32 v165, v166, v167
  v_mfma_f32_16x16x32_bf16 v[32:35], a[216:219], a[16:19], v[32:35]
  s_add_u32 s48, s44, 2621440
  ds_read_b128 a[244:247], v241 offset:54272
  v_cvt_pk_bf16_f32 v166, v180, v181
  v_mfma_f32_16x16x32_bf16 v[36:39], a[216:219], a[20:23], v[36:39]
  s_and_b32 s48, s48, 0x3fffff
  ds_read_b128 a[248:251], v241 offset:55296
  v_cvt_pk_bf16_f32 v167, v182, v183
  v_mfma_f32_16x16x32_bf16 v[36:39], a[200:203], a[4:7], v[36:39]
  s_waitcnt lgkmcnt(3)
  buffer_load_dwordx4 v248, s[20:23], s48 offen lds
  v_mfma_f32_16x16x32_bf16 v[40:43], a[200:203], a[8:11], v[40:43]
  ds_read_b128 a[252:255], v241 offset:56320
  v_max_f32 v168, 0, v168
  v_mfma_f32_16x16x32_bf16 v[40:43], a[216:219], a[24:27], v[40:43]
  s_waitcnt vmcnt(17)
  ds_read_b64_tr_b16 a[176:177], v232 offset:36864
  v_max_f32 v169, 0, v169
  v_mfma_f32_16x16x32_bf16 v[44:47], a[216:219], a[28:31], v[44:47]
  ds_read_b64_tr_b16 a[178:179], v232 offset:38912
  v_max_f32 v170, 0, v170
  v_mfma_f32_16x16x32_bf16 v[44:47], a[200:203], a[12:15], v[44:47]
  buffer_load_dwordx4 v249, s[20:23], s48 offen offset:1024 lds
  v_mfma_f32_16x16x32_bf16 v[60:63], a[204:207], a[12:15], v[60:63]
  ds_read_b64_tr_b16 a[180:181], v233 offset:36864
  v_max_f32 v171, 0, v171
  v_mfma_f32_16x16x32_bf16 v[60:63], a[220:223], a[28:31], v[60:63]
  ds_read_b64_tr_b16 a[182:183], v233 offset:38912
  v_max_f32 v184, 0, v184
  v_mfma_f32_16x16x32_bf16 v[56:59], a[220:223], a[24:27], v[56:59]
  ds_read_b64_tr_b16 a[184:185], v234 offset:36864
  v_max_f32 v185, 0, v185
  v_mfma_f32_16x16x32_bf16 v[56:59], a[204:207], a[8:11], v[56:59]
  buffer_load_dwordx4 v250, s[20:23], s48 offen offset:2048 lds
  v_mfma_f32_16x16x32_bf16 v[52:55], a[204:207], a[4:7], v[52:55]
  ds_read_b64_tr_b16 a[186:187], v234 offset:38912
  v_max_f32 v186, 0, v186
  buffer_load_dword v208, v208, s[12:15], s58 offen
  buffer_load_dword v209, v209, s[16:19], s58 offen
  buffer_load_dword v210, v210, s[24:27], s58 offen
  v_mfma_f32_16x16x32_bf16 v[52:55], a[220:223], a[20:23], v[52:55]
  ds_read_b64_tr_b16 a[188:189], v235 offset:36864
  v_max_f32 v187, 0, v187
  v_mfma_f32_16x16x32_bf16 v[48:51], a[220:223], a[16:19], v[48:51]
  ds_read_b64_tr_b16 a[190:191], v235 offset:38912
  v_cvt_pk_bf16_f32 v168, v168, v169
  v_mfma_f32_16x16x32_bf16 v[48:51], a[204:207], a[0:3], v[48:51]
  buffer_load_dwordx4 v251, s[20:23], s48 offen offset:3072 lds
  v_mfma_f32_16x16x32_bf16 v[0:3], a[160:163], a[224:227], v[0:3]
  s_waitcnt vmcnt(19)
  s_waitcnt lgkmcnt(6)
  s_add_u32 m0, s43, 36864
  ds_read_b64_tr_b16 a[192:193], v236 offset:0
  v_mfma_f32_16x16x32_bf16 v[0:3], a[176:179], a[240:243], v[0:3]
  s_add_u32 s48, s44, 2883584
  ds_read_b64_tr_b16 a[194:195], v236 offset:2048
  v_cvt_pk_bf16_f32 v169, v170, v171
  v_mfma_f32_16x16x32_bf16 v[4:7], a[176:179], a[244:247], v[4:7]
  s_and_b32 s48, s48, 0x3fffff
  ds_read_b64_tr_b16 a[196:197], v237 offset:0
  v_cvt_pk_bf16_f32 v170, v184, v185
  v_mfma_f32_16x16x32_bf16 v[4:7], a[160:163], a[228:231], v[4:7]
  s_waitcnt lgkmcnt(3)
  buffer_load_dwordx4 v248, s[20:23], s48 offen lds
  v_mfma_f32_16x16x32_bf16 v[8:11], a[160:163], a[232:235], v[8:11]
  ds_read_b64_tr_b16 a[198:199], v237 offset:2048
  v_cvt_pk_bf16_f32 v171, v186, v187
  v_mfma_f32_16x16x32_bf16 v[8:11], a[176:179], a[248:251], v[8:11]
  ds_read_b64_tr_b16 a[200:201], v238 offset:0
  v_max_f32 v172, 0, v172
  v_mfma_f32_16x16x32_bf16 v[12:15], a[176:179], a[252:255], v[12:15]
  ds_read_b64_tr_b16 a[202:203], v238 offset:2048
  v_max_f32 v173, 0, v173
  v_mfma_f32_16x16x32_bf16 v[12:15], a[160:163], a[236:239], v[12:15]
  buffer_load_dwordx4 v249, s[20:23], s48 offen offset:1024 lds
  v_mfma_f32_16x16x32_bf16 v[28:31], a[164:167], a[236:239], v[28:31]
  ds_read_b64_tr_b16 a[204:205], v239 offset:0
  v_max_f32 v174, 0, v174
  v_mfma_f32_16x16x32_bf16 v[28:31], a[180:183], a[252:255], v[28:31]
L_hop2:
  s_cbranch_execz L_hop6
  ds_read_b64_tr_b16 a[206:207], v239 offset:2048
  v_max_f32 v175, 0, v175
  v_mfma_f32_16x16x32_bf16 v[24:27], a[180:183], a[248:251], v[24:27]
  v_max_f32 v188, 0, v188
  v_max_f32 v189, 0, v189
  v_mfma_f32_16x16x32_bf16 v[24:27], a[164:167], a[232:235], v[24:27]
  buffer_load_dwordx4 v250, s[20:23], s48 offen offset:2048 lds
  v_mfma_f32_16x16x32_bf16 v[20:23], a[164:167], a[228:231], v[20:23]
  v_max_f32 v190, 0, v190
  v_max_f32 v191, 0, v191
  v_mfma_f32_16x16x32_bf16 v[20:23], a[180:183], a[244:247], v[20:23]
  v_cvt_pk_bf16_f32 v172, v172, v173
  v_cvt_pk_bf16_f32 v173, v174, v175
  v_mfma_f32_16x16x32_bf16 v[16:19], a[180:183], a[240:243], v[16:19]
  v_cvt_pk_bf16_f32 v174, v188, v189
  v_cvt_pk_bf16_f32 v175, v190, v191
  v_mfma_f32_16x16x32_bf16 v[16:19], a[164:167], a[224:227], v[16:19]
  buffer_load_dwordx4 v251, s[20:23], s48 offen offset:3072 lds
  v_mfma_f32_16x16x32_bf16 v[32:35], a[168:171], a[224:227], v[32:35]
  s_waitcnt vmcnt(19)
  s_add_u32 m0, s43, 65536
  ds_read_b64_tr_b16 a[208:209], v236 offset:4096
  v_mfma_f32_16x16x32_bf16 v[32:35], a[184:187], a[240:243], v[32:35]
  s_add_u32 s48, s44, 2621568
  ds_read_b64_tr_b16 a[210:211], v236 offset:6144
  v_mfma_f32_16x16x32_bf16 v[36:39], a[184:187], a[244:247], v[36:39]
  s_and_b32 s48, s48, 0x3fffff
  ds_read_b64_tr_b16 a[212:213], v237 offset:4096
  v_mfma_f32_16x16x32_bf16 v[36:39], a[168:171], a[228:231], v[36:39]
  s_waitcnt lgkmcnt(3)
  buffer_load_dwordx4 v248, s[20:23], s48 offen lds
  v_mfma_f32_16x16x32_bf16 v[40:43], a[168:171], a[232:235], v[40:43]
  ds_read_b64_tr_b16 a[214:215], v237 offset:6144
  v_mfma_f32_16x16x32_bf16 v[40:43], a[184:187], a[248:251], v[40:43]
  ds_read_b64_tr_b16 a[216:217], v238 offset:4096
  v_mfma_f32_16x16x32_bf16 v[44:47], a[184:187], a[252:255], v[44:47]
  ds_read_b64_tr_b16 a[218:219], v238 offset:6144
  v_mfma_f32_16x16x32_bf16 v[44:47], a[168:171], a[236:239], v[44:47]
  buffer_load_dwordx4 v249, s[20:23], s48 offen offset:1024 lds
  v_mfma_f32_16x16x32_bf16 v[60:63], a[172:175], a[236:239], v[60:63]
  ds_read_b64_tr_b16 a[220:221], v239 offset:4096
  v_mfma_f32_16x16x32_bf16 v[60:63], a[188:191], a[252:255], v[60:63]
  ds_read_b64_tr_b16 a[222:223], v239 offset:6144
  v_mfma_f32_16x16x32_bf16 v[56:59], a[188:191], a[248:251], v[56:59]
  v_mfma_f32_16x16x32_bf16 v[56:59], a[172:175], a[232:235], v[56:59]
  buffer_load_dwordx4 v250, s[20:23], s48 offen offset:2048 lds
  v_mfma_f32_16x16x32_bf16 v[52:55], a[172:175], a[228:231], v[52:55]
  v_mfma_f32_16x16x32_bf16 v[52:55], a[188:191], a[244:247], v[52:55]
  ds_write_b128 v216, v[128:131] offset:0
  ds_write_b128 v216, v[132:135] offset:1024
  ds_write_b128 v216, v[136:139] offset:2048
  ds_write_b128 v216, v[140:143] offset:3072
  ds_write_b128 v217, v[160:163] offset:0
  ds_write_b128 v217, v[164:167] offset:1024
  ds_write_b128 v217, v[168:171] offset:2048
  ds_write_b128 v217, v[172:175] offset:3072
  v_mfma_f32_16x16x32_bf16 v[48:51], a[188:191], a[240:243], v[48:51]
  v_mfma_f32_16x16x32_bf16 v[48:51], a[172:175], a[224:227], v[48:51]
  buffer_load_dwordx4 v251, s[20:23], s48 offen offset:3072 lds
  v_mfma_f32_16x16x32_bf16 v[64:67], a[192:195], a[224:227], v[64:67]
  s_waitcnt vmcnt(19)
  s_waitcnt lgkmcnt(14)
  s_add_u32 m0, s43, 69632
  ds_read_b64_tr_b16 a[160:161], v232 offset:0
  v_mfma_f32_16x16x32_bf16 v[64:67], a[208:211], a[240:243], v[64:67]
  s_add_u32 s48, s44, 2883712
  ds_read_b64_tr_b16 a[162:163], v232 offset:2048
  v_mfma_f32_16x16x32_bf16 v[68:71], a[208:211], a[244:247], v[68:71]
  s_and_b32 s48, s48, 0x3fffff
  ds_read_b64_tr_b16 a[164:165], v233 offset:0
  v_mfma_f32_16x16x32_bf16 v[68:71], a[192:195], a[228:231], v[68:71]
  s_waitcnt lgkmcnt(11)
  buffer_load_dwordx4 v248, s[20:23], s48 offen lds
  v_mfma_f32_16x16x32_bf16 v[72:75], a[192:195], a[232:235], v[72:75]
  ds_read_b64_tr_b16 a[166:167], v233 offset:2048
  v_mfma_f32_16x16x32_bf16 v[72:75], a[208:211], a[248:251], v[72:75]
  ds_read_b64_tr_b16 a[168:169], v234 offset:0
  v_mfma_f32_16x16x32_bf16 v[76:79], a[208:211], a[252:255], v[76:79]
  ds_read_b64_tr_b16 a[170:171], v234 offset:2048
  v_mfma_f32_16x16x32_bf16 v[76:79], a[192:195], a[236:239], v[76:79]
  buffer_load_dwordx4 v249, s[20:23], s48 offen offset:1024 lds
  v_mfma_f32_16x16x32_bf16 v[92:95], a[196:199], a[236:239], v[92:95]
  ds_read_b64_tr_b16 a[172:173], v235 offset:0
  v_mfma_f32_16x16x32_bf16 v[92:95], a[212:215], a[252:255], v[92:95]
  ds_read_b64_tr_b16 a[174:175], v235 offset:2048
  v_mfma_f32_16x16x32_bf16 v[88:91], a[212:215], a[248:251], v[88:91]
  v_mfma_f32_16x16x32_bf16 v[88:91], a[196:199], a[232:235], v[88:91]
  buffer_load_dwordx4 v250, s[20:23], s48 offen offset:2048 lds
  v_mfma_f32_16x16x32_bf16 v[84:87], a[196:199], a[228:231], v[84:87]
  v_mfma_f32_16x16x32_bf16 v[84:87], a[212:215], a[244:247], v[84:87]
  v_mfma_f32_16x16x32_bf16 v[80:83], a[212:215], a[240:243], v[80:83]
  v_mfma_f32_16x16x32_bf16 v[80:83], a[196:199], a[224:227], v[80:83]
  buffer_load_dwordx4 v251, s[20:23], s48 offen offset:3072 lds
  v_mfma_f32_16x16x32_bf16 v[96:99], a[200:203], a[224:227], v[96:99]
  s_waitcnt vmcnt(19)
  s_add_u32 m0, s43, 0
  ds_read_b64_tr_b16 a[176:177], v232 offset:4096
  v_mfma_f32_16x16x32_bf16 v[96:99], a[216:219], a[240:243], v[96:99]
  s_add_u32 s48, s44, 1048576
  ds_read_b64_tr_b16 a[178:179], v232 offset:6144
  v_mfma_f32_16x16x32_bf16 v[100:103], a[216:219], a[244:247], v[100:103]
  s_and_b32 s48, s48, 0x3fffff
  ds_read_b64_tr_b16 a[180:181], v233 offset:4096
  v_mfma_f32_16x16x32_bf16 v[100:103], a[200:203], a[228:231], v[100:103]
  s_waitcnt lgkmcnt(3)
  buffer_load_dwordx4 v248, s[20:23], s48 offen lds
  v_mfma_f32_16x16x32_bf16 v[104:107], a[200:203], a[232:235], v[104:107]
  ds_read_b64_tr_b16 a[182:183], v233 offset:6144
  v_mfma_f32_16x16x32_bf16 v[104:107], a[216:219], a[248:251], v[104:107]
  ds_read_b64_tr_b16 a[184:185], v234 offset:4096
  v_mfma_f32_16x16x32_bf16 v[108:111], a[216:219], a[252:255], v[108:111]
  ds_read_b64_tr_b16 a[186:187], v234 offset:6144
  v_mfma_f32_16x16x32_bf16 v[108:111], a[200:203], a[236:239], v[108:111]
  buffer_load_dwordx4 v249, s[20:23], s48 offen offset:1024 lds
  v_mfma_f32_16x16x32_bf16 v[124:127], a[204:207], a[236:239], v[124:127]
  ds_read_b64_tr_b16 a[188:189], v235 offset:4096
  v_mfma_f32_16x16x32_bf16 v[124:127], a[220:223], a[252:255], v[124:127]
  ds_read_b64_tr_b16 a[190:191], v235 offset:6144
  v_mfma_f32_16x16x32_bf16 v[120:123], a[220:223], a[248:251], v[120:123]
  v_mfma_f32_16x16x32_bf16 v[120:123], a[204:207], a[232:235], v[120:123]
  buffer_load_dwordx4 v250, s[20:23], s48 offen offset:2048 lds
  v_mfma_f32_16x16x32_bf16 v[116:119], a[204:207], a[228:231], v[116:119]
  v_mfma_f32_16x16x32_bf16 v[116:119], a[220:223], a[244:247], v[116:119]
  v_mfma_f32_16x16x32_bf16 v[112:115], a[220:223], a[240:243], v[112:115]
  v_mfma_f32_16x16x32_bf16 v[112:115], a[204:207], a[224:227], v[112:115]
  buffer_load_dwordx4 v251, s[20:23], s48 offen offset:3072 lds
  v_mfma_f32_16x16x32_bf16 v[0:3], a[160:163], a[32:35], v[0:3]
  s_waitcnt lgkmcnt(6)
  s_add_u32 m0, s43, 4096
  ds_read_b128 a[224:227], v240 offset:40960
  v_mfma_f32_16x16x32_bf16 v[0:3], a[176:179], a[48:51], v[0:3]
  s_add_u32 s48, s44, 1310720
  ds_read_b128 a[228:231], v240 offset:41984
  v_mfma_f32_16x16x32_bf16 v[4:7], a[176:179], a[52:55], v[4:7]
  s_and_b32 s48, s48, 0x3fffff
  ds_read_b128 a[232:235], v240 offset:43008
  v_mfma_f32_16x16x32_bf16 v[4:7], a[160:163], a[36:39], v[4:7]
  s_waitcnt lgkmcnt(3)
  buffer_load_dwordx4 v248, s[20:23], s48 offen lds
  v_mfma_f32_16x16x32_bf16 v[8:11], a[160:163], a[40:43], v[8:11]
  ds_read_b128 a[236:239], v240 offset:44032
  v_mfma_f32_16x16x32_bf16 v[8:11], a[176:179], a[56:59], v[8:11]
  s_waitcnt vmcnt(17)
  ds_read_b64_tr_b16 a[192:193], v232 offset:32768
  v_mfma_f32_16x16x32_bf16 v[12:15], a[176:179], a[60:63], v[12:15]
  ds_read_b64_tr_b16 a[194:195], v232 offset:34816
  v_mfma_f32_16x16x32_bf16 v[12:15], a[160:163], a[44:47], v[12:15]
  buffer_load_dwordx4 v249, s[20:23], s48 offen offset:1024 lds
  v_mfma_f32_16x16x32_bf16 v[28:31], a[164:167], a[44:47], v[28:31]
  ds_read_b64_tr_b16 a[196:197], v233 offset:32768
  v_mfma_f32_16x16x32_bf16 v[28:31], a[180:183], a[60:63], v[28:31]
  ds_read_b64_tr_b16 a[198:199], v233 offset:34816
  v_mfma_f32_16x16x32_bf16 v[24:27], a[180:183], a[56:59], v[24:27]
  ds_read_b64_tr_b16 a[200:201], v234 offset:32768
  v_mfma_f32_16x16x32_bf16 v[24:27], a[164:167], a[40:43], v[24:27]
  buffer_load_dwordx4 v250, s[20:23], s48 offen offset:2048 lds
  v_mfma_f32_16x16x32_bf16 v[20:23], a[164:167], a[36:39], v[20:23]
  ds_read_b64_tr_b16 a[202:203], v234 offset:34816
  v_mfma_f32_16x16x32_bf16 v[20:23], a[180:183], a[52:55], v[20:23]
  ds_read_b64_tr_b16 a[204:205], v235 offset:32768
  v_mfma_f32_16x16x32_bf16 v[16:19], a[180:183], a[48:51], v[16:19]
  ds_read_b64_tr_b16 a[206:207], v235 offset:34816
  v_mfma_f32_16x16x32_bf16 v[16:19], a[164:167], a[32:35], v[16:19]
  buffer_load_dwordx4 v251, s[20:23], s48 offen offset:3072 lds
  v_mfma_f32_16x16x32_bf16 v[32:35], a[168:171], a[32:35], v[32:35]
  s_add_u32 m0, s43, 32768
  ds_read_b128 a[240:243], v241 offset:45056
  v_mfma_f32_16x16x32_bf16 v[32:35], a[184:187], a[48:51], v[32:35]
  s_add_u32 s48, s44, 1572864
  ds_read_b128 a[244:247], v241 offset:46080
  v_mfma_f32_16x16x32_bf16 v[36:39], a[184:187], a[52:55], v[36:39]
  s_and_b32 s48, s48, 0x3fffff
  ds_read_b128 a[248:251], v241 offset:47104
  v_mfma_f32_16x16x32_bf16 v[36:39], a[168:171], a[36:39], v[36:39]
  s_waitcnt lgkmcnt(3)
  buffer_load_dwordx4 v248, s[20:23], s48 offen lds
  v_mfma_f32_16x16x32_bf16 v[40:43], a[168:171], a[40:43], v[40:43]
  ds_read_b128 a[252:255], v241 offset:48128
  v_mfma_f32_16x16x32_bf16 v[40:43], a[184:187], a[56:59], v[40:43]
  s_waitcnt vmcnt(17)
  ds_read_b64_tr_b16 a[208:209], v232 offset:36864
  v_mfma_f32_16x16x32_bf16 v[44:47], a[184:187], a[60:63], v[44:47]
  ds_read_b64_tr_b16 a[210:211], v232 offset:38912
  v_mfma_f32_16x16x32_bf16 v[44:47], a[168:171], a[44:47], v[44:47]
  buffer_load_dwordx4 v249, s[20:23], s48 offen offset:1024 lds
  v_mfma_f32_16x16x32_bf16 v[60:63], a[172:175], a[44:47], v[60:63]
  ds_read_b64_tr_b16 a[212:213], v233 offset:36864
  v_mfma_f32_16x16x32_bf16 v[60:63], a[188:191], a[60:63], v[60:63]
  ds_read_b64_tr_b16 a[214:215], v233 offset:38912
  v_mfma_f32_16x16x32_bf16 v[56:59], a[188:191], a[56:59], v[56:59]
  ds_read_b64_tr_b16 a[216:217], v234 offset:36864
  v_mfma_f32_16x16x32_bf16 v[56:59], a[172:175], a[40:43], v[56:59]
  buffer_load_dwordx4 v250, s[20:23], s48 offen offset:2048 lds
  v_mfma_f32_16x16x32_bf16 v[52:55], a[172:175], a[36:39], v[52:55]
  ds_read_b64_tr_b16 a[218:219], v234 offset:38912
  v_mfma_f32_16x16x32_bf16 v[52:55], a[188:191], a[52:55], v[52:55]
  ds_read_b64_tr_b16 a[220:221], v235 offset:36864
  v_mfma_f32_16x16x32_bf16 v[48:51], a[188:191], a[48:51], v[48:51]
  ds_read_b64_tr_b16 a[222:223], v235 offset:38912
  v_mfma_f32_16x16x32_bf16 v[48:51], a[172:175], a[32:35], v[48:51]
  buffer_load_dwordx4 v251, s[20:23], s48 offen offset:3072 lds
  v_mfma_f32_16x16x32_bf16 v[0:3], a[192:195], a[224:227], v[0:3]
  s_waitcnt vmcnt(16)
  s_waitcnt lgkmcnt(6)
  s_add_u32 m0, s43, 36864
  ds_read_b64_tr_b16 a[160:161], v236 offset:0
  v_mfma_f32_16x16x32_bf16 v[0:3], a[208:211], a[240:243], v[0:3]
  s_add_u32 s48, s44, 1835008
  ds_read_b64_tr_b16 a[162:163], v236 offset:2048
  v_mfma_f32_16x16x32_bf16 v[4:7], a[208:211], a[244:247], v[4:7]
  s_and_b32 s48, s48, 0x3fffff
  ds_read_b64_tr_b16 a[164:165], v237 offset:0
  v_mfma_f32_16x16x32_bf16 v[4:7], a[192:195], a[228:231], v[4:7]
  s_waitcnt lgkmcnt(3)
  buffer_load_dwordx4 v248, s[20:23], s48 offen lds
  v_mfma_f32_16x16x32_bf16 v[8:11], a[192:195], a[232:235], v[8:11]
  ds_read_b64_tr_b16 a[166:167], v237 offset:2048
  v_mfma_f32_16x16x32_bf16 v[8:11], a[208:211], a[248:251], v[8:11]
  ds_read_b64_tr_b16 a[168:169], v238 offset:0
  v_mfma_f32_16x16x32_bf16 v[12:15], a[208:211], a[252:255], v[12:15]
  ds_read_b64_tr_b16 a[170:171], v238 offset:2048
  v_mfma_f32_16x16x32_bf16 v[12:15], a[192:195], a[236:239], v[12:15]
  buffer_load_dwordx4 v249, s[20:23], s48 offen offset:1024 lds
  v_mfma_f32_16x16x32_bf16 v[28:31], a[196:199], a[236:239], v[28:31]
  ds_read_b64_tr_b16 a[172:173], v239 offset:0
  v_mfma_f32_16x16x32_bf16 v[28:31], a[212:215], a[252:255], v[28:31]
  ds_read_b64_tr_b16 a[174:175], v239 offset:2048
  v_mfma_f32_16x16x32_bf16 v[24:27], a[212:215], a[248:251], v[24:27]
  v_mfma_f32_16x16x32_bf16 v[24:27], a[196:199], a[232:235], v[24:27]
  buffer_load_dwordx4 v250, s[20:23], s48 offen offset:2048 lds
  v_mfma_f32_16x16x32_bf16 v[20:23], a[196:199], a[228:231], v[20:23]
  v_mfma_f32_16x16x32_bf16 v[20:23], a[212:215], a[244:247], v[20:23]
  v_mfma_f32_16x16x32_bf16 v[16:19], a[212:215], a[240:243], v[16:19]
  v_mfma_f32_16x16x32_bf16 v[16:19], a[196:199], a[224:227], v[16:19]
  buffer_load_dwordx4 v251, s[20:23], s48 offen offset:3072 lds
  v_mfma_f32_16x16x32_bf16 v[32:35], a[200:203], a[224:227], v[32:35]
  s_waitcnt vmcnt(16)
  s_add_u32 m0, s43, 65536
  ds_read_b64_tr_b16 a[176:177], v236 offset:4096
  v_mfma_f32_16x16x32_bf16 v[32:35], a[216:219], a[240:243], v[32:35]
  s_add_u32 s48, s44, 2097152
  ds_read_b64_tr_b16 a[178:179], v236 offset:6144
  v_mfma_f32_16x16x32_bf16 v[36:39], a[216:219], a[244:247], v[36:39]
  s_and_b32 s48, s48, 0x3fffff
  ds_read_b64_tr_b16 a[180:181], v237 offset:4096
  v_mfma_f32_16x16x32_bf16 v[36:39], a[200:203], a[228:231], v[36:39]
  s_waitcnt lgkmcnt(3)
  buffer_load_dwordx4 v248, s[20:23], s48 offen lds
  v_mfma_f32_16x16x32_bf16 v[40:43], a[200:203], a[232:235], v[40:43]
  ds_read_b64_tr_b16 a[182:183], v237 offset:6144
  v_mfma_f32_16x16x32_bf16 v[40:43], a[216:219], a[248:251], v[40:43]
  ds_read_b64_tr_b16 a[184:185], v238 offset:4096
  v_mfma_f32_16x16x32_bf16 v[44:47], a[216:219], a[252:255], v[44:47]
  ds_read_b64_tr_b16 a[186:187], v238 offset:6144
  v_mfma_f32_16x16x32_bf16 v[44:47], a[200:203], a[236:239], v[44:47]
  buffer_load_dwordx4 v249, s[20:23], s48 offen offset:1024 lds
  v_mfma_f32_16x16x32_bf16 v[60:63], a[204:207], a[236:239], v[60:63]
  ds_read_b64_tr_b16 a[188:189], v239 offset:4096
  v_mfma_f32_16x16x32_bf16 v[60:63], a[220:223], a[252:255], v[60:63]
  ds_read_b64_tr_b16 a[190:191], v239 offset:6144
  v_mfma_f32_16x16x32_bf16 v[56:59], a[220:223], a[248:251], v[56:59]
  v_mfma_f32_16x16x32_bf16 v[56:59], a[204:207], a[232:235], v[56:59]
  buffer_load_dwordx4 v250, s[20:23], s48 offen offset:2048 lds
  v_mfma_f32_16x16x32_bf16 v[52:55], a[204:207], a[228:231], v[52:55]
  v_mfma_f32_16x16x32_bf16 v[52:55], a[220:223], a[244:247], v[52:55]
  v_mfma_f32_16x16x32_bf16 v[48:51], a[220:223], a[240:243], v[48:51]
  v_mfma_f32_16x16x32_bf16 v[48:51], a[204:207], a[224:227], v[48:51]
  buffer_load_dwordx4 v251, s[20:23], s48 offen offset:3072 lds
  s_waitcnt lgkmcnt(0)
  s_barrier
  v_mfma_f32_16x16x32_bf16 v[64:67], a[160:163], a[224:227], v[64:67]
  s_waitcnt vmcnt(16)
  s_add_u32 m0, s43, 69632
  ds_read_b64_tr_b16 a[192:193], v232 offset:0
  v_mfma_f32_16x16x32_bf16 v[64:67], a[176:179], a[240:243], v[64:67]
  s_add_u32 s48, s44, 2359296
  ds_read_b64_tr_b16 a[194:195], v232 offset:2048
  v_mfma_f32_16x16x32_bf16 v[68:71], a[176:179], a[244:247], v[68:71]
  s_and_b32 s48, s48, 0x3fffff
  ds_read_b64_tr_b16 a[196:197], v233 offset:0
  v_mfma_f32_16x16x32_bf16 v[68:71], a[160:163], a[228:231], v[68:71]
  buffer_load_dwordx4 v248, s[20:23], s48 offen lds
  v_mfma_f32_16x16x32_bf16 v[72:75], a[160:163], a[232:235], v[72:75]
  ds_read_b64_tr_b16 a[198:199], v233 offset:2048
  v_mfma_f32_16x16x32_bf16 v[72:75], a[176:179], a[248:251], v[72:75]
  ds_read_b64_tr_b16 a[200:201], v234 offset:0
  v_mfma_f32_16x16x32_bf16 v[76:79], a[176:179], a[252:255], v[76:79]
  ds_read_b64_tr_b16 a[202:203], v234 offset:2048
  v_mfma_f32_16x16x32_bf16 v[76:79], a[160:163], a[236:239], v[76:79]
  buffer_load_dwordx4 v249, s[20:23], s48 offen offset:1024 lds
  v_mfma_f32_16x16x32_bf16 v[92:95], a[164:167], a[236:239], v[92:95]
  ds_read_b64_tr_b16 a[204:205], v235 offset:0
  v_mfma_f32_16x16x32_bf16 v[92:95], a[180:183], a[252:255], v[92:95]
  ds_read_b64_tr_b16 a[206:207], v235 offset:2048
  v_mfma_f32_16x16x32_bf16 v[88:91], a[180:183], a[248:251], v[88:91]
  v_mfma_f32_16x16x32_bf16 v[88:91], a[164:167], a[232:235], v[88:91]
  buffer_load_dwordx4 v250, s[20:23], s48 offen offset:2048 lds
  v_mfma_f32_16x16x32_bf16 v[84:87], a[164:167], a[228:231], v[84:87]
  v_mfma_f32_16x16x32_bf16 v[84:87], a[180:183], a[244:247], v[84:87]
  v_mfma_f32_16x16x32_bf16 v[80:83], a[180:183], a[240:243], v[80:83]
  v_mfma_f32_16x16x32_bf16 v[80:83], a[164:167], a[224:227], v[80:83]
  buffer_load_dwordx4 v251, s[20:23], s48 offen offset:3072 lds
  v_mfma_f32_16x16x32_bf16 v[96:99], a[168:171], a[224:227], v[96:99]
  s_waitcnt vmcnt(16)
  s_add_u32 m0, s43, 0
  ds_read_b64_tr_b16 a[208:209], v232 offset:4096
  v_mfma_f32_16x16x32_bf16 v[96:99], a[184:187], a[240:243], v[96:99]
  s_add_u32 s48, s44, 128
  ds_read_b64_tr_b16 a[210:211], v232 offset:6144
  v_mfma_f32_16x16x32_bf16 v[100:103], a[184:187], a[244:247], v[100:103]
  s_and_b32 s48, s48, 0x3fffff
  ds_read_b64_tr_b16 a[212:213], v233 offset:4096
  v_mfma_f32_16x16x32_bf16 v[100:103], a[168:171], a[228:231], v[100:103]
  s_waitcnt lgkmcnt(3)
  buffer_load_dwordx4 v248, s[20:23], s48 offen lds
  v_mfma_f32_16x16x32_bf16 v[104:107], a[168:171], a[232:235], v[104:107]
  ds_read_b64_tr_b16 a[214:215], v233 offset:6144
  v_mfma_f32_16x16x32_bf16 v[104:107], a[184:187], a[248:251], v[104:107]
  ds_read_b64_tr_b16 a[216:217], v234 offset:4096
  v_mfma_f32_16x16x32_bf16 v[108:111], a[184:187], a[252:255], v[108:111]
  ds_read_b64_tr_b16 a[218:219], v234 offset:6144
  v_mfma_f32_16x16x32_bf16 v[108:111], a[168:171], a[236:239], v[108:111]
  buffer_load_dwordx4 v249, s[20:23], s48 offen offset:1024 lds
  v_mfma_f32_16x16x32_bf16 v[124:127], a[172:175], a[236:239], v[124:127]
  ds_read_b64_tr_b16 a[220:221], v235 offset:4096
  v_mfma_f32_16x16x32_bf16 v[124:127], a[188:191], a[252:255], v[124:127]
  ds_read_b64_tr_b16 a[222:223], v235 offset:6144
  v_mfma_f32_16x16x32_bf16 v[120:123], a[188:191], a[248:251], v[120:123]
  v_mfma_f32_16x16x32_bf16 v[120:123], a[172:175], a[232:235], v[120:123]
  buffer_load_dwordx4 v250, s[20:23], s48 offen offset:2048 lds
  v_mfma_f32_16x16x32_bf16 v[116:119], a[172:175], a[228:231], v[116:119]
  v_mfma_f32_16x16x32_bf16 v[116:119], a[188:191], a[244:247], v[116:119]
  v_mfma_f32_16x16x32_bf16 v[112:115], a[188:191], a[240:243], v[112:115]
  v_mfma_f32_16x16x32_bf16 v[112:115], a[172:175], a[224:227], v[112:115]
  buffer_load_dwordx4 v251, s[20:23], s48 offen offset:3072 lds
  v_mfma_f32_16x16x32_bf16 v[0:3], a[192:195], a[64:67], v[0:3]
  s_waitcnt vmcnt(16)
  s_waitcnt lgkmcnt(6)
  s_add_u32 m0, s43, 4096
  ds_read_b64_tr_b16 a[160:161], v232 offset:32768
  v_mfma_f32_16x16x32_bf16 v[0:3], a[208:211], a[80:83], v[0:3]
  s_add_u32 s48, s44, 262272
  ds_read_b64_tr_b16 a[162:163], v232 offset:34816
  v_mfma_f32_16x16x32_bf16 v[4:7], a[208:211], a[84:87], v[4:7]
  s_and_b32 s48, s48, 0x3fffff
  ds_read_b64_tr_b16 a[164:165], v233 offset:32768
  v_mfma_f32_16x16x32_bf16 v[4:7], a[192:195], a[68:71], v[4:7]
  s_waitcnt lgkmcnt(3)
  buffer_load_dwordx4 v248, s[20:23], s48 offen lds
  v_mfma_f32_16x16x32_bf16 v[8:11], a[192:195], a[72:75], v[8:11]
  ds_read_b64_tr_b16 a[166:167], v233 offset:34816
  v_mfma_f32_16x16x32_bf16 v[8:11], a[208:211], a[88:91], v[8:11]
  ds_read_b64_tr_b16 a[168:169], v234 offset:32768
  v_mfma_f32_16x16x32_bf16 v[12:15], a[208:211], a[92:95], v[12:15]
  ds_read_b64_tr_b16 a[170:171], v234 offset:34816
  v_mfma_f32_16x16x32_bf16 v[12:15], a[192:195], a[76:79], v[12:15]
  buffer_load_dwordx4 v249, s[20:23], s48 offen offset:1024 lds
  v_mfma_f32_16x16x32_bf16 v[28:31], a[196:199], a[76:79], v[28:31]
  ds_read_b64_tr_b16 a[172:173], v235 offset:32768
  v_mfma_f32_16x16x32_bf16 v[28:31], a[212:215], a[92:95], v[28:31]
  ds_read_b64_tr_b16 a[174:175], v235 offset:34816
  v_mfma_f32_16x16x32_bf16 v[24:27], a[212:215], a[88:91], v[24:27]
  v_mfma_f32_16x16x32_bf16 v[24:27], a[196:199], a[72:75], v[24:27]
  buffer_load_dwordx4 v250, s[20:23], s48 offen offset:2048 lds
  v_mfma_f32_16x16x32_bf16 v[20:23], a[196:199], a[68:71], v[20:23]
  v_mfma_f32_16x16x32_bf16 v[20:23], a[212:215], a[84:87], v[20:23]
  v_mfma_f32_16x16x32_bf16 v[16:19], a[212:215], a[80:83], v[16:19]
  v_mfma_f32_16x16x32_bf16 v[16:19], a[196:199], a[64:67], v[16:19]
  buffer_load_dwordx4 v251, s[20:23], s48 offen offset:3072 lds
  v_mfma_f32_16x16x32_bf16 v[32:35], a[200:203], a[64:67], v[32:35]
  s_waitcnt vmcnt(16)
  s_add_u32 m0, s43, 32768
  ds_read_b64_tr_b16 a[176:177], v232 offset:36864
  v_mfma_f32_16x16x32_bf16 v[32:35], a[216:219], a[80:83], v[32:35]
  s_add_u32 s48, s44, 524416
  ds_read_b64_tr_b16 a[178:179], v232 offset:38912
  v_mfma_f32_16x16x32_bf16 v[36:39], a[216:219], a[84:87], v[36:39]
  s_and_b32 s48, s48, 0x3fffff
  ds_read_b64_tr_b16 a[180:181], v233 offset:36864
  v_mfma_f32_16x16x32_bf16 v[36:39], a[200:203], a[68:71], v[36:39]
  s_waitcnt lgkmcnt(3)
  buffer_load_dwordx4 v248, s[20:23], s48 offen lds
  v_mfma_f32_16x16x32_bf16 v[40:43], a[200:203], a[72:75], v[40:43]
  ds_read_b64_tr_b16 a[182:183], v233 offset:38912
  v_mfma_f32_16x16x32_bf16 v[40:43], a[216:219], a[88:91], v[40:43]
  ds_read_b64_tr_b16 a[184:185], v234 offset:36864
  v_mfma_f32_16x16x32_bf16 v[44:47], a[216:219], a[92:95], v[44:47]
  ds_read_b64_tr_b16 a[186:187], v234 offset:38912
  v_mfma_f32_16x16x32_bf16 v[44:47], a[200:203], a[76:79], v[44:47]
  buffer_load_dwordx4 v249, s[20:23], s48 offen offset:1024 lds
  v_mfma_f32_16x16x32_bf16 v[60:63], a[204:207], a[76:79], v[60:63]
  ds_read_b64_tr_b16 a[188:189], v235 offset:36864
  v_mfma_f32_16x16x32_bf16 v[60:63], a[220:223], a[92:95], v[60:63]
  ds_read_b64_tr_b16 a[190:191], v235 offset:38912
  v_mfma_f32_16x16x32_bf16 v[56:59], a[220:223], a[88:91], v[56:59]
  v_mfma_f32_16x16x32_bf16 v[56:59], a[204:207], a[72:75], v[56:59]
  buffer_load_dwordx4 v250, s[20:23], s48 offen offset:2048 lds
  v_mfma_f32_16x16x32_bf16 v[52:55], a[204:207], a[68:71], v[52:55]
  v_mfma_f32_16x16x32_bf16 v[52:55], a[220:223], a[84:87], v[52:55]
  v_mfma_f32_16x16x32_bf16 v[48:51], a[220:223], a[80:83], v[48:51]
  v_mfma_f32_16x16x32_bf16 v[48:51], a[204:207], a[64:67], v[48:51]
  buffer_load_dwordx4 v251, s[20:23], s48 offen offset:3072 lds
  v_mfma_f32_16x16x32_bf16 v[0:3], a[160:163], a[96:99], v[0:3]
  s_waitcnt vmcnt(16)
  s_waitcnt lgkmcnt(6)
  s_add_u32 m0, s43, 36864
  ds_read_b64_tr_b16 a[192:193], v236 offset:0
  v_mfma_f32_16x16x32_bf16 v[0:3], a[176:179], a[112:115], v[0:3]
  s_add_u32 s48, s44, 786560
  ds_read_b64_tr_b16 a[194:195], v236 offset:2048
  v_mfma_f32_16x16x32_bf16 v[4:7], a[176:179], a[116:119], v[4:7]
  s_and_b32 s48, s48, 0x3fffff
  ds_read_b64_tr_b16 a[196:197], v237 offset:0
  v_mfma_f32_16x16x32_bf16 v[4:7], a[160:163], a[100:103], v[4:7]
  s_waitcnt lgkmcnt(3)
  buffer_load_dwordx4 v248, s[20:23], s48 offen lds
  v_mfma_f32_16x16x32_bf16 v[8:11], a[160:163], a[104:107], v[8:11]
  ds_read_b64_tr_b16 a[198:199], v237 offset:2048
  v_mfma_f32_16x16x32_bf16 v[8:11], a[176:179], a[120:123], v[8:11]
  ds_read_b64_tr_b16 a[200:201], v238 offset:0
  v_mfma_f32_16x16x32_bf16 v[12:15], a[176:179], a[124:127], v[12:15]
  ds_read_b64_tr_b16 a[202:203], v238 offset:2048
  v_mfma_f32_16x16x32_bf16 v[12:15], a[160:163], a[108:111], v[12:15]
  buffer_load_dwordx4 v249, s[20:23], s48 offen offset:1024 lds
  v_mfma_f32_16x16x32_bf16 v[28:31], a[164:167], a[108:111], v[28:31]
  ds_read_b64_tr_b16 a[204:205], v239 offset:0
  v_mfma_f32_16x16x32_bf16 v[28:31], a[180:183], a[124:127], v[28:31]
  ds_read_b64_tr_b16 a[206:207], v239 offset:2048
  v_mfma_f32_16x16x32_bf16 v[24:27], a[180:183], a[120:123], v[24:27]
  v_mfma_f32_16x16x32_bf16 v[24:27], a[164:167], a[104:107], v[24:27]
  buffer_load_dwordx4 v250, s[20:23], s48 offen offset:2048 lds
  v_mfma_f32_16x16x32_bf16 v[20:23], a[164:167], a[100:103], v[20:23]
  v_mfma_f32_16x16x32_bf16 v[20:23], a[180:183], a[116:119], v[20:23]
  v_mfma_f32_16x16x32_bf16 v[16:19], a[180:183], a[112:115], v[16:19]
  v_mfma_f32_16x16x32_bf16 v[16:19], a[164:167], a[96:99], v[16:19]
  buffer_load_dwordx4 v251, s[20:23], s48 offen offset:3072 lds
  v_mfma_f32_16x16x32_bf16 v[32:35], a[168:171], a[96:99], v[32:35]
  s_waitcnt vmcnt(16)
  s_add_u32 m0, s43, 65536
  ds_read_b64_tr_b16 a[208:209], v236 offset:4096
  v_mfma_f32_16x16x32_bf16 v[32:35], a[184:187], a[112:115], v[32:35]
  s_add_u32 s48, s44, 1048704
  ds_read_b64_tr_b16 a[210:211], v236 offset:6144
  v_mfma_f32_16x16x32_bf16 v[36:39], a[184:187], a[116:119], v[36:39]
  s_and_b32 s48, s48, 0x3fffff
  ds_read_b64_tr_b16 a[212:213], v237 offset:4096
  v_mfma_f32_16x16x32_bf16 v[36:39], a[168:171], a[100:103], v[36:39]
  s_waitcnt lgkmcnt(3)
  buffer_load_dwordx4 v248, s[20:23], s48 offen lds
  v_mfma_f32_16x16x32_bf16 v[40:43], a[168:171], a[104:107], v[40:43]
  ds_read_b64_tr_b16 a[214:215], v237 offset:6144
  v_mfma_f32_16x16x32_bf16 v[40:43], a[184:187], a[120:123], v[40:43]
  ds_read_b64_tr_b16 a[216:217], v238 offset:4096
  v_mfma_f32_16x16x32_bf16 v[44:47], a[184:187], a[124:127], v[44:47]
  ds_read_b64_tr_b16 a[218:219], v238 offset:6144
  v_mfma_f32_16x16x32_bf16 v[44:47], a[168:171], a[108:111], v[44:47]
  buffer_load_dwordx4 v249, s[20:23], s48 offen offset:1024 lds
  v_mfma_f32_16x16x32_bf16 v[60:63], a[172:175], a[108:111], v[60:63]
  ds_read_b64_tr_b16 a[220:221], v239 offset:4096
  v_mfma_f32_16x16x32_bf16 v[60:63], a[188:191], a[124:127], v[60:63]
  ds_read_b64_tr_b16 a[222:223], v239 offset:6144
  v_mfma_f32_16x16x32_bf16 v[56:59], a[188:191], a[120:123], v[56:59]
  v_mfma_f32_16x16x32_bf16 v[56:59], a[172:175], a[104:107], v[56:59]
  buffer_load_dwordx4 v250, s[20:23], s48 offen offset:2048 lds
  v_mfma_f32_16x16x32_bf16 v[52:55], a[172:175], a[100:103], v[52:55]
  v_mfma_f32_16x16x32_bf16 v[52:55], a[188:191], a[116:119], v[52:55]
  v_mfma_f32_16x16x32_bf16 v[48:51], a[188:191], a[112:115], v[48:51]
  v_mfma_f32_16x16x32_bf16 v[48:51], a[172:175], a[96:99], v[48:51]
  buffer_load_dwordx4 v251, s[20:23], s48 offen offset:3072 lds
  v_mfma_f32_16x16x32_bf16 v[0:3], a[192:195], a[128:131], v[0:3]
  s_waitcnt vmcnt(16)
  s_waitcnt lgkmcnt(6)
  s_add_u32 m0, s43, 69632
  ds_read_b64_tr_b16 a[160:161], v232 offset:0
  v_mfma_f32_16x16x32_bf16 v[0:3], a[208:211], a[144:147], v[0:3]
  s_add_u32 s48, s44, 1310848
  ds_read_b64_tr_b16 a[162:163], v232 offset:2048
  v_mfma_f32_16x16x32_bf16 v[4:7], a[208:211], a[148:151], v[4:7]
  s_and_b32 s48, s48, 0x3fffff
  ds_read_b64_tr_b16 a[164:165], v233 offset:0
  v_mfma_f32_16x16x32_bf16 v[4:7], a[192:195], a[132:135], v[4:7]
  s_waitcnt lgkmcnt(3)
  buffer_load_dwordx4 v248, s[20:23], s48 offen lds
  v_mfma_f32_16x16x32_bf16 v[8:11], a[192:195], a[136:139], v[8:11]
  ds_read_b64_tr_b16 a[166:167], v233 offset:2048
  v_mfma_f32_16x16x32_bf16 v[8:11], a[208:211], a[152:155], v[8:11]
  ds_read_b64_tr_b16 a[168:169], v234 offset:0
  v_mfma_f32_16x16x32_bf16 v[12:15], a[208:211], a[156:159], v[12:15]
  ds_read_b64_tr_b16 a[170:171], v234 offset:2048
  v_mfma_f32_16x16x32_bf16 v[12:15], a[192:195], a[140:143], v[12:15]
  buffer_load_dwordx4 v249, s[20:23], s48 offen offset:1024 lds
  v_mfma_f32_16x16x32_bf16 v[28:31], a[196:199], a[140:143], v[28:31]
  ds_read_b64_tr_b16 a[172:173], v235 offset:0
  v_mfma_f32_16x16x32_bf16 v[28:31], a[212:215], a[156:159], v[28:31]
  ds_read_b64_tr_b16 a[174:175], v235 offset:2048
  v_mfma_f32_16x16x32_bf16 v[24:27], a[212:215], a[152:155], v[24:27]
  v_mfma_f32_16x16x32_bf16 v[24:27], a[196:199], a[136:139], v[24:27]
  buffer_load_dwordx4 v250, s[20:23], s48 offen offset:2048 lds
  v_mfma_f32_16x16x32_bf16 v[20:23], a[196:199], a[132:135], v[20:23]
  v_mfma_f32_16x16x32_bf16 v[20:23], a[212:215], a[148:151], v[20:23]
  v_mfma_f32_16x16x32_bf16 v[16:19], a[212:215], a[144:147], v[16:19]
  v_mfma_f32_16x16x32_bf16 v[16:19], a[196:199], a[128:131], v[16:19]
  buffer_load_dwordx4 v251, s[20:23], s48 offen offset:3072 lds
  v_mfma_f32_16x16x32_bf16 v[32:35], a[200:203], a[128:131], v[32:35]
  s_waitcnt vmcnt(16)
  s_add_u32 m0, s43, 0
  ds_read_b64_tr_b16 a[176:177], v232 offset:4096
  v_mfma_f32_16x16x32_bf16 v[32:35], a[216:219], a[144:147], v[32:35]
  s_add_u32 s48, s44, 1572992
  ds_read_b64_tr_b16 a[178:179], v232 offset:6144
  v_mfma_f32_16x16x32_bf16 v[36:39], a[216:219], a[148:151], v[36:39]
  s_and_b32 s48, s48, 0x3fffff
  ds_read_b64_tr_b16 a[180:181], v233 offset:4096
  v_mfma_f32_16x16x32_bf16 v[36:39], a[200:203], a[132:135], v[36:39]
  s_waitcnt lgkmcnt(3)
  buffer_load_dwordx4 v248, s[20:23], s48 offen lds
  v_mfma_f32_16x16x32_bf16 v[40:43], a[200:203], a[136:139], v[40:43]
  ds_read_b64_tr_b16 a[182:183], v233 offset:6144
  v_mfma_f32_16x16x32_bf16 v[40:43], a[216:219], a[152:155], v[40:43]
  ds_read_b64_tr_b16 a[184:185], v234 offset:4096
  v_mfma_f32_16x16x32_bf16 v[44:47], a[216:219], a[156:159], v[44:47]
  ds_read_b64_tr_b16 a[186:187], v234 offset:6144
  v_mfma_f32_16x16x32_bf16 v[44:47], a[200:203], a[140:143], v[44:47]
  buffer_load_dwordx4 v249, s[20:23], s48 offen offset:1024 lds
  v_mfma_f32_16x16x32_bf16 v[60:63], a[204:207], a[140:143], v[60:63]
  ds_read_b64_tr_b16 a[188:189], v235 offset:4096
  v_mfma_f32_16x16x32_bf16 v[60:63], a[220:223], a[156:159], v[60:63]
  ds_read_b64_tr_b16 a[190:191], v235 offset:6144
  v_mfma_f32_16x16x32_bf16 v[56:59], a[220:223], a[152:155], v[56:59]
  v_mfma_f32_16x16x32_bf16 v[56:59], a[204:207], a[136:139], v[56:59]
  buffer_load_dwordx4 v250, s[20:23], s48 offen offset:2048 lds
  v_mfma_f32_16x16x32_bf16 v[52:55], a[204:207], a[132:135], v[52:55]
  v_mfma_f32_16x16x32_bf16 v[52:55], a[220:223], a[148:151], v[52:55]
  v_mfma_f32_16x16x32_bf16 v[48:51], a[220:223], a[144:147], v[48:51]
L_hop3:
  s_cbranch_execz L_hop7
  v_mfma_f32_16x16x32_bf16 v[48:51], a[204:207], a[128:131], v[48:51]
  buffer_load_dwordx4 v251, s[20:23], s48 offen offset:3072 lds
  v_mfma_f32_16x16x32_bf16 v[64:67], a[160:163], a[0:3], v[64:67]
  s_waitcnt vmcnt(16)
  s_waitcnt lgkmcnt(6)
  s_add_u32 m0, s43, 4096
  ds_read_b64_tr_b16 a[192:193], v232 offset:32768
  v_mfma_f32_16x16x32_bf16 v[64:67], a[176:179], a[16:19], v[64:67]
  s_add_u32 s48, s44, 1835136
  ds_read_b64_tr_b16 a[194:195], v232 offset:34816
  v_cvt_pk_bf16_f32 v0, v0, v1
  v_mfma_f32_16x16x32_bf16 v[68:71], a[176:179], a[20:23], v[68:71]
  s_and_b32 s48, s48, 0x3fffff
  ds_read_b64_tr_b16 a[196:197], v233 offset:32768
  v_cvt_pk_bf16_f32 v1, v2, v3
  v_cvt_pk_bf16_f32 v2, v16, v17
  v_mfma_f32_16x16x32_bf16 v[68:71], a[160:163], a[4:7], v[68:71]
  s_waitcnt lgkmcnt(3)
  buffer_load_dwordx4 v248, s[20:23], s48 offen lds
  v_mfma_f32_16x16x32_bf16 v[72:75], a[160:163], a[8:11], v[72:75]
  ds_read_b64_tr_b16 a[198:199], v233 offset:34816
  v_cvt_pk_bf16_f32 v3, v18, v19
  v_mfma_f32_16x16x32_bf16 v[72:75], a[176:179], a[24:27], v[72:75]
  ds_read_b64_tr_b16 a[200:201], v234 offset:32768
  v_mfma_f32_16x16x32_bf16 v[76:79], a[176:179], a[28:31], v[76:79]
  ds_read_b64_tr_b16 a[202:203], v234 offset:34816
  v_mfma_f32_16x16x32_bf16 v[76:79], a[160:163], a[12:15], v[76:79]
  buffer_load_dwordx4 v249, s[20:23], s48 offen offset:1024 lds
  v_mfma_f32_16x16x32_bf16 v[92:95], a[164:167], a[12:15], v[92:95]
  ds_read_b64_tr_b16 a[204:205], v235 offset:32768
  v_permlane32_swap_b32 v0, v2
  v_mfma_f32_16x16x32_bf16 v[92:95], a[180:183], a[28:31], v[92:95]
  ds_read_b64_tr_b16 a[206:207], v235 offset:34816
  v_mfma_f32_16x16x32_bf16 v[88:91], a[180:183], a[24:27], v[88:91]
  v_permlane32_swap_b32 v1, v3
  v_mfma_f32_16x16x32_bf16 v[88:91], a[164:167], a[8:11], v[88:91]
  buffer_load_dwordx4 v250, s[20:23], s48 offen offset:2048 lds
  v_mfma_f32_16x16x32_bf16 v[84:87], a[164:167], a[4:7], v[84:87]
  v_permlane16_swap_b32 v0, v2
  v_mfma_f32_16x16x32_bf16 v[84:87], a[180:183], a[20:23], v[84:87]
  v_permlane16_swap_b32 v1, v3
  v_cvt_pk_bf16_f32 v4, v4, v5
  v_mfma_f32_16x16x32_bf16 v[80:83], a[180:183], a[16:19], v[80:83]
  v_cvt_pk_bf16_f32 v5, v6, v7
  v_cvt_pk_bf16_f32 v6, v20, v21
  v_mfma_f32_16x16x32_bf16 v[80:83], a[164:167], a[0:3], v[80:83]
  buffer_load_dwordx4 v251, s[20:23], s48 offen offset:3072 lds
  v_mfma_f32_16x16x32_bf16 v[96:99], a[168:171], a[0:3], v[96:99]
  s_waitcnt vmcnt(16)
  s_add_u32 m0, s43, 32768
  ds_read_b64_tr_b16 a[208:209], v232 offset:36864
  v_mfma_f32_16x16x32_bf16 v[96:99], a[184:187], a[16:19], v[96:99]
  s_add_u32 s48, s44, 2097280
  ds_read_b64_tr_b16 a[210:211], v232 offset:38912
  v_cvt_pk_bf16_f32 v7, v22, v23
  v_mfma_f32_16x16x32_bf16 v[100:103], a[184:187], a[20:23], v[100:103]
  s_and_b32 s48, s48, 0x3fffff
  ds_read_b64_tr_b16 a[212:213], v233 offset:36864
  v_mfma_f32_16x16x32_bf16 v[100:103], a[168:171], a[4:7], v[100:103]
  s_waitcnt lgkmcnt(3)
  buffer_load_dwordx4 v248, s[20:23], s48 offen lds
  v_mfma_f32_16x16x32_bf16 v[104:107], a[168:171], a[8:11], v[104:107]
  ds_read_b64_tr_b16 a[214:215], v233 offset:38912
  v_mfma_f32_16x16x32_bf16 v[104:107], a[184:187], a[24:27], v[104:107]
  ds_read_b64_tr_b16 a[216:217], v234 offset:36864
  v_mfma_f32_16x16x32_bf16 v[108:111], a[184:187], a[28:31], v[108:111]
  ds_read_b64_tr_b16 a[218:219], v234 offset:38912
  v_permlane32_swap_b32 v4, v6
  v_mfma_f32_16x16x32_bf16 v[108:111], a[168:171], a[12:15], v[108:111]
  buffer_load_dwordx4 v249, s[20:23], s48 offen offset:1024 lds
  v_mfma_f32_16x16x32_bf16 v[124:127], a[172:175], a[12:15], v[124:127]
  ds_read_b64_tr_b16 a[220:221], v235 offset:36864
  v_mfma_f32_16x16x32_bf16 v[124:127], a[188:191], a[28:31], v[124:127]
  ds_read_b64_tr_b16 a[222:223], v235 offset:38912
  v_mfma_f32_16x16x32_bf16 v[120:123], a[188:191], a[24:27], v[120:123]
  v_permlane32_swap_b32 v5, v7
  v_mfma_f32_16x16x32_bf16 v[120:123], a[172:175], a[8:11], v[120:123]
  buffer_load_dwordx4 v250, s[20:23], s48 offen offset:2048 lds
  v_mfma_f32_16x16x32_bf16 v[116:119], a[172:175], a[4:7], v[116:119]
  v_permlane16_swap_b32 v4, v6
  v_mfma_f32_16x16x32_bf16 v[116:119], a[188:191], a[20:23], v[116:119]
  v_permlane16_swap_b32 v5, v7
  v_mfma_f32_16x16x32_bf16 v[112:115], a[188:191], a[16:19], v[112:115]
  v_cvt_pk_bf16_f32 v8, v8, v9
  v_cvt_pk_bf16_f32 v9, v10, v11
  v_mfma_f32_16x16x32_bf16 v[112:115], a[172:175], a[0:3], v[112:115]
  buffer_load_dwordx4 v251, s[20:23], s48 offen offset:3072 lds
  v_mfma_f32_16x16x32_bf16 v[64:67], a[192:195], a[32:35], v[64:67]
  s_waitcnt lgkmcnt(6)
  s_add_u32 m0, s43, 36864
  ds_read_b128 a[0:3], v242 offset:0
  v_cvt_pk_bf16_f32 v10, v24, v25
  v_cvt_pk_bf16_f32 v11, v26, v27
  v_mfma_f32_16x16x32_bf16 v[64:67], a[208:211], a[48:51], v[64:67]
  s_add_u32 s48, s44, 2359424
  ds_read_b128 a[4:7], v242 offset:1024
  v_mfma_f32_16x16x32_bf16 v[68:71], a[208:211], a[52:55], v[68:71]
  s_and_b32 s48, s48, 0x3fffff
  ds_read_b128 a[8:11], v242 offset:2048
  v_mfma_f32_16x16x32_bf16 v[68:71], a[192:195], a[36:39], v[68:71]
  s_waitcnt lgkmcnt(3)
  buffer_load_dwordx4 v248, s[20:23], s48 offen lds
  v_mfma_f32_16x16x32_bf16 v[72:75], a[192:195], a[40:43], v[72:75]
  ds_read_b128 a[12:15], v242 offset:3072
  v_mfma_f32_16x16x32_bf16 v[72:75], a[208:211], a[56:59], v[72:75]
  s_waitcnt vmcnt(17)
  ds_read_b64_tr_b16 a[160:161], v236 offset:0
  v_permlane32_swap_b32 v8, v10
  v_mfma_f32_16x16x32_bf16 v[76:79], a[208:211], a[60:63], v[76:79]
  ds_read_b64_tr_b16 a[162:163], v236 offset:2048
  v_mfma_f32_16x16x32_bf16 v[76:79], a[192:195], a[44:47], v[76:79]
  buffer_load_dwordx4 v249, s[20:23], s48 offen offset:1024 lds
  v_mfma_f32_16x16x32_bf16 v[92:95], a[196:199], a[44:47], v[92:95]
  ds_read_b64_tr_b16 a[164:165], v237 offset:0
  v_mfma_f32_16x16x32_bf16 v[92:95], a[212:215], a[60:63], v[92:95]
  ds_read_b64_tr_b16 a[166:167], v237 offset:2048
  v_permlane32_swap_b32 v9, v11
  v_mfma_f32_16x16x32_bf16 v[88:91], a[212:215], a[56:59], v[88:91]
  ds_read_b64_tr_b16 a[168:169], v238 offset:0
  v_mfma_f32_16x16x32_bf16 v[88:91], a[196:199], a[40:43], v[88:91]
  buffer_load_dwordx4 v250, s[20:23], s48 offen offset:2048 lds
  v_mfma_f32_16x16x32_bf16 v[84:87], a[196:199], a[36:39], v[84:87]
  ds_read_b64_tr_b16 a[170:171], v238 offset:2048
  v_mfma_f32_16x16x32_bf16 v[84:87], a[212:215], a[52:55], v[84:87]
  ds_read_b64_tr_b16 a[172:173], v239 offset:0
  v_mfma_f32_16x16x32_bf16 v[80:83], a[212:215], a[48:51], v[80:83]
  ds_read_b64_tr_b16 a[174:175], v239 offset:2048
  v_permlane16_swap_b32 v8, v10
  v_mfma_f32_16x16x32_bf16 v[80:83], a[196:199], a[32:35], v[80:83]
  buffer_load_dwordx4 v251, s[20:23], s48 offen offset:3072 lds
  v_mfma_f32_16x16x32_bf16 v[96:99], a[200:203], a[32:35], v[96:99]
  s_add_u32 m0, s43, 65536
  s_add_u32 s48, s46, 0
  ds_read_b128 a[16:19], v242 offset:4096
  v_mfma_f32_16x16x32_bf16 v[96:99], a[216:219], a[48:51], v[96:99]
  s_sub_u32 s51, s48, 229376
  ds_read_b128 a[20:23], v242 offset:5120
  v_mfma_f32_16x16x32_bf16 v[100:103], a[216:219], a[52:55], v[100:103]
  s_min_u32 s48, s48, s51
  ds_read_b128 a[24:27], v242 offset:6144
  v_permlane16_swap_b32 v9, v11
  v_mfma_f32_16x16x32_bf16 v[100:103], a[200:203], a[36:39], v[100:103]
  s_waitcnt lgkmcnt(3)
  buffer_load_dwordx4 v243, s[32:35], s48 offen lds
  v_mfma_f32_16x16x32_bf16 v[104:107], a[200:203], a[40:43], v[104:107]
  ds_read_b128 a[28:31], v242 offset:7168
  v_cvt_pk_bf16_f32 v12, v12, v13
  v_mfma_f32_16x16x32_bf16 v[104:107], a[216:219], a[56:59], v[104:107]
  s_waitcnt vmcnt(17)
  ds_read_b64_tr_b16 a[176:177], v236 offset:4096
  v_cvt_pk_bf16_f32 v13, v14, v15
  v_mfma_f32_16x16x32_bf16 v[108:111], a[216:219], a[60:63], v[108:111]
  ds_read_b64_tr_b16 a[178:179], v236 offset:6144
  v_cvt_pk_bf16_f32 v14, v28, v29
  v_mfma_f32_16x16x32_bf16 v[108:111], a[200:203], a[44:47], v[108:111]
  buffer_load_dwordx4 v244, s[32:35], s48 offen offset:1024 lds
  v_mfma_f32_16x16x32_bf16 v[124:127], a[204:207], a[44:47], v[124:127]
  ds_read_b64_tr_b16 a[180:181], v237 offset:4096
  v_cvt_pk_bf16_f32 v15, v30, v31
  v_mfma_f32_16x16x32_bf16 v[124:127], a[220:223], a[60:63], v[124:127]
  ds_read_b64_tr_b16 a[182:183], v237 offset:6144
  v_mfma_f32_16x16x32_bf16 v[120:123], a[220:223], a[56:59], v[120:123]
  ds_read_b64_tr_b16 a[184:185], v238 offset:4096
  v_mfma_f32_16x16x32_bf16 v[120:123], a[204:207], a[40:43], v[120:123]
  buffer_load_dwordx4 v245, s[32:35], s48 offen offset:2048 lds
  v_mfma_f32_16x16x32_bf16 v[116:119], a[204:207], a[36:39], v[116:119]
  ds_read_b64_tr_b16 a[186:187], v238 offset:6144
  v_mfma_f32_16x16x32_bf16 v[116:119], a[220:223], a[52:55], v[116:119]
  ds_read_b64_tr_b16 a[188:189], v239 offset:4096
  v_permlane32_swap_b32 v12, v14
  v_mfma_f32_16x16x32_bf16 v[112:115], a[220:223], a[48:51], v[112:115]
  ds_read_b64_tr_b16 a[190:191], v239 offset:6144
  v_mfma_f32_16x16x32_bf16 v[112:115], a[204:207], a[32:35], v[112:115]
  buffer_load_dwordx4 v246, s[32:35], s48 offen offset:3072 lds
  v_mfma_f32_16x16x32_bf16 v[64:67], a[160:163], a[64:67], v[64:67]
  s_waitcnt lgkmcnt(6)
  s_add_u32 m0, s43, 69632
  s_add_u32 s48, s46, 32768
  ds_read_b128 a[32:35], v242 offset:8192
  v_mfma_f32_16x16x32_bf16 v[64:67], a[176:179], a[80:83], v[64:67]
  s_sub_u32 s51, s48, 229376
  ds_read_b128 a[36:39], v242 offset:9216
  v_permlane32_swap_b32 v13, v15
  v_mfma_f32_16x16x32_bf16 v[68:71], a[176:179], a[84:87], v[68:71]
  s_min_u32 s48, s48, s51
  ds_read_b128 a[40:43], v242 offset:10240
  v_mfma_f32_16x16x32_bf16 v[68:71], a[160:163], a[68:71], v[68:71]
  s_waitcnt lgkmcnt(3)
  buffer_load_dwordx4 v243, s[32:35], s48 offen lds
  v_mfma_f32_16x16x32_bf16 v[72:75], a[160:163], a[72:75], v[72:75]
  ds_read_b128 a[44:47], v242 offset:11264
  v_mfma_f32_16x16x32_bf16 v[72:75], a[176:179], a[88:91], v[72:75]
  s_waitcnt vmcnt(17)
  ds_read_b64_tr_b16 a[192:193], v232 offset:0
  v_mfma_f32_16x16x32_bf16 v[76:79], a[176:179], a[92:95], v[76:79]
  ds_read_b64_tr_b16 a[194:195], v232 offset:2048
  v_permlane16_swap_b32 v12, v14
  v_mfma_f32_16x16x32_bf16 v[76:79], a[160:163], a[76:79], v[76:79]
  buffer_load_dwordx4 v244, s[32:35], s48 offen offset:1024 lds
  v_mfma_f32_16x16x32_bf16 v[92:95], a[164:167], a[76:79], v[92:95]
  ds_read_b64_tr_b16 a[196:197], v233 offset:0
  v_mfma_f32_16x16x32_bf16 v[92:95], a[180:183], a[92:95], v[92:95]
  ds_read_b64_tr_b16 a[198:199], v233 offset:2048
  v_mfma_f32_16x16x32_bf16 v[88:91], a[180:183], a[88:91], v[88:91]
  ds_read_b64_tr_b16 a[200:201], v234 offset:0
  v_permlane16_swap_b32 v13, v15
  v_mfma_f32_16x16x32_bf16 v[88:91], a[164:167], a[72:75], v[88:91]
  buffer_load_dwordx4 v245, s[32:35], s48 offen offset:2048 lds
  v_mfma_f32_16x16x32_bf16 v[84:87], a[164:167], a[68:71], v[84:87]
  ds_read_b64_tr_b16 a[202:203], v234 offset:2048
  v_cvt_pk_bf16_f32 v32, v32, v33
  v_mfma_f32_16x16x32_bf16 v[84:87], a[180:183], a[84:87], v[84:87]
  ds_read_b64_tr_b16 a[204:205], v235 offset:0
  v_cvt_pk_bf16_f32 v33, v34, v35
  v_mfma_f32_16x16x32_bf16 v[80:83], a[180:183], a[80:83], v[80:83]
  ds_read_b64_tr_b16 a[206:207], v235 offset:2048
  v_cvt_pk_bf16_f32 v34, v48, v49
  v_mfma_f32_16x16x32_bf16 v[80:83], a[164:167], a[64:67], v[80:83]
  buffer_load_dwordx4 v246, s[32:35], s48 offen offset:3072 lds
  v_mfma_f32_16x16x32_bf16 v[96:99], a[168:171], a[64:67], v[96:99]
  s_add_u32 m0, s43, 0
  s_add_u32 s48, s46, 65536
  ds_read_b128 a[48:51], v242 offset:12288
  v_cvt_pk_bf16_f32 v35, v50, v51
  v_mfma_f32_16x16x32_bf16 v[96:99], a[184:187], a[80:83], v[96:99]
  s_sub_u32 s51, s48, 229376
  ds_read_b128 a[52:55], v242 offset:13312
  v_mfma_f32_16x16x32_bf16 v[100:103], a[184:187], a[84:87], v[100:103]
  s_min_u32 s48, s48, s51
  ds_read_b128 a[56:59], v242 offset:14336
  v_mfma_f32_16x16x32_bf16 v[100:103], a[168:171], a[68:71], v[100:103]
  s_waitcnt lgkmcnt(3)
  buffer_load_dwordx4 v243, s[32:35], s48 offen lds
  v_mfma_f32_16x16x32_bf16 v[104:107], a[168:171], a[72:75], v[104:107]
  ds_read_b128 a[60:63], v242 offset:15360
  v_mfma_f32_16x16x32_bf16 v[104:107], a[184:187], a[88:91], v[104:107]
  s_waitcnt vmcnt(17)
  ds_read_b64_tr_b16 a[208:209], v232 offset:4096
  v_permlane32_swap_b32 v32, v34
  v_mfma_f32_16x16x32_bf16 v[108:111], a[184:187], a[92:95], v[108:111]
  ds_read_b64_tr_b16 a[210:211], v232 offset:6144
  v_mfma_f32_16x16x32_bf16 v[108:111], a[168:171], a[76:79], v[108:111]
  buffer_load_dwordx4 v244, s[32:35], s48 offen offset:1024 lds
  v_mfma_f32_16x16x32_bf16 v[124:127], a[172:175], a[76:79], v[124:127]
  ds_read_b64_tr_b16 a[212:213], v233 offset:4096
  v_mfma_f32_16x16x32_bf16 v[124:127], a[188:191], a[92:95], v[124:127]
  ds_read_b64_tr_b16 a[214:215], v233 offset:6144
  v_permlane32_swap_b32 v33, v35
  v_mfma_f32_16x16x32_bf16 v[120:123], a[188:191], a[88:91], v[120:123]
  ds_read_b64_tr_b16 a[216:217], v234 offset:4096
  v_mfma_f32_16x16x32_bf16 v[120:123], a[172:175], a[72:75], v[120:123]
  buffer_load_dwordx4 v245, s[32:35], s48 offen offset:2048 lds
  v_mfma_f32_16x16x32_bf16 v[116:119], a[172:175], a[68:71], v[116:119]
  ds_read_b64_tr_b16 a[218:219], v234 offset:6144
  v_mfma_f32_16x16x32_bf16 v[116:119], a[188:191], a[84:87], v[116:119]
  ds_read_b64_tr_b16 a[220:221], v235 offset:4096
  v_mfma_f32_16x16x32_bf16 v[112:115], a[188:191], a[80:83], v[112:115]
  ds_read_b64_tr_b16 a[222:223], v235 offset:6144
  v_permlane16_swap_b32 v32, v34
  v_mfma_f32_16x16x32_bf16 v[112:115], a[172:175], a[64:67], v[112:115]
  buffer_load_dwordx4 v246, s[32:35], s48 offen offset:3072 lds
  v_mfma_f32_16x16x32_bf16 v[64:67], a[192:195], a[96:99], v[64:67]
  s_waitcnt lgkmcnt(6)
  s_add_u32 m0, s43, 4096
  s_add_u32 s48, s46, 98304
  ds_read_b128 a[64:67], v242 offset:16384
  v_mfma_f32_16x16x32_bf16 v[64:67], a[208:211], a[112:115], v[64:67]
  s_sub_u32 s51, s48, 229376
  ds_read_b128 a[68:71], v242 offset:17408
  v_mfma_f32_16x16x32_bf16 v[68:71], a[208:211], a[116:119], v[68:71]
  s_min_u32 s48, s48, s51
  ds_read_b128 a[72:75], v242 offset:18432
  v_permlane16_swap_b32 v33, v35
  v_mfma_f32_16x16x32_bf16 v[68:71], a[192:195], a[100:103], v[68:71]
  s_waitcnt lgkmcnt(3)
  buffer_load_dwordx4 v243, s[32:35], s48 offen lds
  v_mfma_f32_16x16x32_bf16 v[72:75], a[192:195], a[104:107], v[72:75]
  ds_read_b128 a[76:79], v242 offset:19456
  v_cvt_pk_bf16_f32 v36, v36, v37
  v_mfma_f32_16x16x32_bf16 v[72:75], a[208:211], a[120:123], v[72:75]
  s_waitcnt vmcnt(17)
  ds_read_b64_tr_b16 a[160:161], v232 offset:32768
  v_cvt_pk_bf16_f32 v37, v38, v39
  v_mfma_f32_16x16x32_bf16 v[76:79], a[208:211], a[124:127], v[76:79]
  ds_read_b64_tr_b16 a[162:163], v232 offset:34816
  v_cvt_pk_bf16_f32 v38, v52, v53
  v_mfma_f32_16x16x32_bf16 v[76:79], a[192:195], a[108:111], v[76:79]
  buffer_load_dwordx4 v244, s[32:35], s48 offen offset:1024 lds
  v_mfma_f32_16x16x32_bf16 v[92:95], a[196:199], a[108:111], v[92:95]
  ds_read_b64_tr_b16 a[164:165], v233 offset:32768
  v_cvt_pk_bf16_f32 v39, v54, v55
  v_mfma_f32_16x16x32_bf16 v[92:95], a[212:215], a[124:127], v[92:95]
  ds_read_b64_tr_b16 a[166:167], v233 offset:34816
  v_mfma_f32_16x16x32_bf16 v[88:91], a[212:215], a[120:123], v[88:91]
  ds_read_b64_tr_b16 a[168:169], v234 offset:32768
  v_mfma_f32_16x16x32_bf16 v[88:91], a[196:199], a[104:107], v[88:91]
  buffer_load_dwordx4 v245, s[32:35], s48 offen offset:2048 lds
  v_mfma_f32_16x16x32_bf16 v[84:87], a[196:199], a[100:103], v[84:87]
  ds_read_b64_tr_b16 a[170:171], v234 offset:34816
  v_mfma_f32_16x16x32_bf16 v[84:87], a[212:215], a[116:119], v[84:87]
  ds_read_b64_tr_b16 a[172:173], v235 offset:32768
  v_permlane32_swap_b32 v36, v38
  v_mfma_f32_16x16x32_bf16 v[80:83], a[212:215], a[112:115], v[80:83]
  ds_read_b64_tr_b16 a[174:175], v235 offset:34816
  v_mfma_f32_16x16x32_bf16 v[80:83], a[196:199], a[96:99], v[80:83]
  buffer_load_dwordx4 v246, s[32:35], s48 offen offset:3072 lds
  v_mfma_f32_16x16x32_bf16 v[96:99], a[200:203], a[96:99], v[96:99]
  s_add_u32 m0, s43, 32768
  s_add_u32 s48, s46, 131072
  ds_read_b128 a[80:83], v242 offset:20480
  v_mfma_f32_16x16x32_bf16 v[96:99], a[216:219], a[112:115], v[96:99]
  s_sub_u32 s51, s48, 229376
  ds_read_b128 a[84:87], v242 offset:21504
  v_permlane32_swap_b32 v37, v39
  v_mfma_f32_16x16x32_bf16 v[100:103], a[216:219], a[116:119], v[100:103]
  s_min_u32 s48, s48, s51
  ds_read_b128 a[88:91], v242 offset:22528
  v_mfma_f32_16x16x32_bf16 v[100:103], a[200:203], a[100:103], v[100:103]
  s_waitcnt lgkmcnt(3)
  buffer_load_dwordx4 v243, s[32:35], s48 offen lds
  v_mfma_f32_16x16x32_bf16 v[104:107], a[200:203], a[104:107], v[104:107]
  ds_read_b128 a[92:95], v242 offset:23552
  v_mfma_f32_16x16x32_bf16 v[104:107], a[216:219], a[120:123], v[104:107]
  s_waitcnt vmcnt(17)
  ds_read_b64_tr_b16 a[176:177], v232 offset:36864
  v_mfma_f32_16x16x32_bf16 v[108:111], a[216:219], a[124:127], v[108:111]
  ds_read_b64_tr_b16 a[178:179], v232 offset:38912
  v_permlane16_swap_b32 v36, v38
  v_mfma_f32_16x16x32_bf16 v[108:111], a[200:203], a[108:111], v[108:111]
  buffer_load_dwordx4 v244, s[32:35], s48 offen offset:1024 lds
  v_mfma_f32_16x16x32_bf16 v[124:127], a[204:207], a[108:111], v[124:127]
  ds_read_b64_tr_b16 a[180:181], v233 offset:36864
  v_mfma_f32_16x16x32_bf16 v[124:127], a[220:223], a[124:127], v[124:127]
  ds_read_b64_tr_b16 a[182:183], v233 offset:38912
  v_mfma_f32_16x16x32_bf16 v[120:123], a[220:223], a[120:123], v[120:123]
  ds_read_b64_tr_b16 a[184:185], v234 offset:36864
  v_permlane16_swap_b32 v37, v39
  v_mfma_f32_16x16x32_bf16 v[120:123], a[204:207], a[104:107], v[120:123]
  buffer_load_dwordx4 v245, s[32:35], s48 offen offset:2048 lds
  v_mfma_f32_16x16x32_bf16 v[116:119], a[204:207], a[100:103], v[116:119]
  ds_read_b64_tr_b16 a[186:187], v234 offset:38912
  v_cvt_pk_bf16_f32 v40, v40, v41
  v_mfma_f32_16x16x32_bf16 v[116:119], a[220:223], a[116:119], v[116:119]
  ds_read_b64_tr_b16 a[188:189], v235 offset:36864
  v_cvt_pk_bf16_f32 v41, v42, v43
  v_mfma_f32_16x16x32_bf16 v[112:115], a[220:223], a[112:115], v[112:115]
  ds_read_b64_tr_b16 a[190:191], v235 offset:38912
  v_cvt_pk_bf16_f32 v42, v56, v57
  v_mfma_f32_16x16x32_bf16 v[112:115], a[204:207], a[96:99], v[112:115]
  buffer_load_dwordx4 v246, s[32:35], s48 offen offset:3072 lds
  v_mfma_f32_16x16x32_bf16 v[64:67], a[160:163], a[128:131], v[64:67]
  s_waitcnt lgkmcnt(6)
  s_add_u32 m0, s43, 36864
  s_add_u32 s48, s46, 163840
  ds_read_b128 a[96:99], v242 offset:24576
  v_cvt_pk_bf16_f32 v43, v58, v59
  v_mfma_f32_16x16x32_bf16 v[64:67], a[176:179], a[144:147], v[64:67]
  s_sub_u32 s51, s48, 229376
  ds_read_b128 a[100:103], v242 offset:25600
  v_mfma_f32_16x16x32_bf16 v[68:71], a[176:179], a[148:151], v[68:71]
  s_min_u32 s48, s48, s51
  ds_read_b128 a[104:107], v242 offset:26624
  v_mfma_f32_16x16x32_bf16 v[68:71], a[160:163], a[132:135], v[68:71]
  s_waitcnt lgkmcnt(3)
  buffer_load_dwordx4 v243, s[32:35], s48 offen lds
  v_mfma_f32_16x16x32_bf16 v[72:75], a[160:163], a[136:139], v[72:75]
  ds_read_b128 a[108:111], v242 offset:27648
  v_mfma_f32_16x16x32_bf16 v[72:75], a[176:179], a[152:155], v[72:75]
  s_waitcnt vmcnt(17)
  ds_read_b64_tr_b16 a[192:193], v236 offset:0
  v_permlane32_swap_b32 v40, v42
  v_mfma_f32_16x16x32_bf16 v[76:79], a[176:179], a[156:159], v[76:79]
  ds_read_b64_tr_b16 a[194:195], v236 offset:2048
  v_mfma_f32_16x16x32_bf16 v[76:79], a[160:163], a[140:143], v[76:79]
  buffer_load_dwordx4 v244, s[32:35], s48 offen offset:1024 lds
  v_mfma_f32_16x16x32_bf16 v[92:95], a[164:167], a[140:143], v[92:95]
  ds_read_b64_tr_b16 a[196:197], v237 offset:0
  v_mfma_f32_16x16x32_bf16 v[92:95], a[180:183], a[156:159], v[92:95]
  ds_read_b64_tr_b16 a[198:199], v237 offset:2048
  v_permlane32_swap_b32 v41, v43
  v_mfma_f32_16x16x32_bf16 v[88:91], a[180:183], a[152:155], v[88:91]
  ds_read_b64_tr_b16 a[200:201], v238 offset:0
  v_mfma_f32_16x16x32_bf16 v[88:91], a[164:167], a[136:139], v[88:91]
  buffer_load_dwordx4 v245, s[32:35], s48 offen offset:2048 lds
  v_mfma_f32_16x16x32_bf16 v[84:87], a[164:167], a[132:135], v[84:87]
  ds_read_b64_tr_b16 a[202:203], v238 offset:2048
  v_mfma_f32_16x16x32_bf16 v[84:87], a[180:183], a[148:151], v[84:87]
  ds_read_b64_tr_b16 a[204:205], v239 offset:0
  v_mfma_f32_16x16x32_bf16 v[80:83], a[180:183], a[144:147], v[80:83]
  ds_read_b64_tr_b16 a[206:207], v239 offset:2048
  v_permlane16_swap_b32 v40, v42
  v_mfma_f32_16x16x32_bf16 v[80:83], a[164:167], a[128:131], v[80:83]
  buffer_load_dwordx4 v246, s[32:35], s48 offen offset:3072 lds
  v_mfma_f32_16x16x32_bf16 v[96:99], a[168:171], a[128:131], v[96:99]
  s_waitcnt vmcnt(16)
  s_add_u32 m0, s43, 65536
  s_add_u32 s48, s46, 196608
  ds_read_b64_tr_b16 a[208:209], v236 offset:4096
  v_mfma_f32_16x16x32_bf16 v[96:99], a[184:187], a[144:147], v[96:99]
  s_sub_u32 s51, s48, 229376
  ds_read_b64_tr_b16 a[210:211], v236 offset:6144
  v_mfma_f32_16x16x32_bf16 v[100:103], a[184:187], a[148:151], v[100:103]
  s_min_u32 s48, s48, s51
  ds_read_b64_tr_b16 a[212:213], v237 offset:4096
  v_permlane16_swap_b32 v41, v43
  v_mfma_f32_16x16x32_bf16 v[100:103], a[168:171], a[132:135], v[100:103]
  s_waitcnt lgkmcnt(3)
  buffer_load_dwordx4 v243, s[32:35], s48 offen lds
  v_mfma_f32_16x16x32_bf16 v[104:107], a[168:171], a[136:139], v[104:107]
  ds_read_b64_tr_b16 a[214:215], v237 offset:6144
  v_cvt_pk_bf16_f32 v44, v44, v45
  v_mfma_f32_16x16x32_bf16 v[104:107], a[184:187], a[152:155], v[104:107]
  ds_read_b64_tr_b16 a[216:217], v238 offset:4096
  v_cvt_pk_bf16_f32 v45, v46, v47
  v_mfma_f32_16x16x32_bf16 v[108:111], a[184:187], a[156:159], v[108:111]
  ds_read_b64_tr_b16 a[218:219], v238 offset:6144
  v_cvt_pk_bf16_f32 v46, v60, v61
  v_mfma_f32_16x16x32_bf16 v[108:111], a[168:171], a[140:143], v[108:111]
  buffer_load_dwordx4 v244, s[32:35], s48 offen offset:1024 lds
  v_mfma_f32_16x16x32_bf16 v[124:127], a[172:175], a[140:143], v[124:127]
  ds_read_b64_tr_b16 a[220:221], v239 offset:4096
  v_cvt_pk_bf16_f32 v47, v62, v63
  v_mfma_f32_16x16x32_bf16 v[124:127], a[188:191], a[156:159], v[124:127]
  ds_read_b64_tr_b16 a[222:223], v239 offset:6144
  v_mfma_f32_16x16x32_bf16 v[120:123], a[188:191], a[152:155], v[120:123]
  v_permlane32_swap_b32 v44, v46
  v_mfma_f32_16x16x32_bf16 v[120:123], a[172:175], a[136:139], v[120:123]
  buffer_load_dwordx4 v245, s[32:35], s48 offen offset:2048 lds
  v_mfma_f32_16x16x32_bf16 v[116:119], a[172:175], a[132:135], v[116:119]
  v_permlane32_swap_b32 v45, v47
  v_mfma_f32_16x16x32_bf16 v[116:119], a[188:191], a[148:151], v[116:119]
  v_permlane16_swap_b32 v44, v46
  v_mfma_f32_16x16x32_bf16 v[112:115], a[188:191], a[144:147], v[112:115]
  v_permlane16_swap_b32 v45, v47
  v_mfma_f32_16x16x32_bf16 v[112:115], a[172:175], a[128:131], v[112:115]
  buffer_load_dwordx4 v246, s[32:35], s48 offen offset:3072 lds
  s_waitcnt lgkmcnt(0)
  s_barrier
  v_mfma_f32_16x16x32_bf16 v[128:131], a[192:195], a[0:3], 0
  s_waitcnt vmcnt(16)
  s_add_u32 m0, s43, 69632
  s_add_u32 s48, s46, 128
  ds_read_b64_tr_b16 a[224:225], v232 offset:0
  v_mfma_f32_16x16x32_bf16 v[128:131], a[208:211], a[16:19], v[128:131]
  s_sub_u32 s51, s48, 229376
  ds_read_b64_tr_b16 a[226:227], v232 offset:2048
  v_accvgpr_write_b32 a128, v0
  v_mfma_f32_16x16x32_bf16 v[132:135], a[208:211], a[20:23], 0
  s_min_u32 s48, s48, s51
  ds_read_b64_tr_b16 a[228:229], v233 offset:0
  v_accvgpr_write_b32 a129, v1
  v_mfma_f32_16x16x32_bf16 v[132:135], a[192:195], a[4:7], v[132:135]
  buffer_load_dwordx4 v243, s[32:35], s48 offen lds
  v_mfma_f32_16x16x32_bf16 v[136:139], a[192:195], a[8:11], 0
  ds_read_b64_tr_b16 a[230:231], v233 offset:2048
  v_accvgpr_write_b32 a130, v2
  v_mfma_f32_16x16x32_bf16 v[136:139], a[208:211], a[24:27], v[136:139]
  ds_read_b64_tr_b16 a[232:233], v234 offset:0
  v_accvgpr_write_b32 a131, v3
  v_mfma_f32_16x16x32_bf16 v[140:143], a[208:211], a[28:31], 0
  ds_read_b64_tr_b16 a[234:235], v234 offset:2048
  v_accvgpr_write_b32 a144, v4
  v_mfma_f32_16x16x32_bf16 v[140:143], a[192:195], a[12:15], v[140:143]
  buffer_load_dwordx4 v244, s[32:35], s48 offen offset:1024 lds
  v_mfma_f32_16x16x32_bf16 v[156:159], a[196:199], a[12:15], 0
  ds_read_b64_tr_b16 a[236:237], v235 offset:0
  v_accvgpr_write_b32 a145, v5
  v_accvgpr_write_b32 a146, v6
  v_mfma_f32_16x16x32_bf16 v[156:159], a[212:215], a[28:31], v[156:159]
  ds_read_b64_tr_b16 a[238:239], v235 offset:2048
  v_accvgpr_write_b32 a147, v7
  v_mfma_f32_16x16x32_bf16 v[152:155], a[212:215], a[24:27], 0
  v_accvgpr_write_b32 a160, v8
  v_accvgpr_write_b32 a161, v9
  v_mfma_f32_16x16x32_bf16 v[152:155], a[196:199], a[8:11], v[152:155]
  buffer_load_dwordx4 v245, s[32:35], s48 offen offset:2048 lds
  v_mfma_f32_16x16x32_bf16 v[148:151], a[196:199], a[4:7], 0
  v_accvgpr_write_b32 a162, v10
  v_accvgpr_write_b32 a163, v11
  v_mfma_f32_16x16x32_bf16 v[148:151], a[212:215], a[20:23], v[148:151]
  v_accvgpr_write_b32 a176, v12
  v_accvgpr_write_b32 a177, v13
  v_mfma_f32_16x16x32_bf16 v[144:147], a[212:215], a[16:19], 0
  v_accvgpr_write_b32 a178, v14
  v_accvgpr_write_b32 a179, v15
  v_mfma_f32_16x16x32_bf16 v[144:147], a[196:199], a[0:3], v[144:147]
  buffer_load_dwordx4 v246, s[32:35], s48 offen offset:3072 lds
  v_mfma_f32_16x16x32_bf16 v[160:163], a[200:203], a[0:3], 0
  s_waitcnt vmcnt(16)
  s_add_u32 m0, s43, 0
  s_add_u32 s48, s46, 32896
  ds_read_b64_tr_b16 a[240:241], v232 offset:4096
  v_mfma_f32_16x16x32_bf16 v[160:163], a[216:219], a[16:19], v[160:163]
  s_sub_u32 s51, s48, 229376
  ds_read_b64_tr_b16 a[242:243], v232 offset:6144
  v_accvgpr_write_b32 a132, v32
  v_mfma_f32_16x16x32_bf16 v[164:167], a[216:219], a[20:23], 0
  s_min_u32 s48, s48, s51
  ds_read_b64_tr_b16 a[244:245], v233 offset:4096
  v_accvgpr_write_b32 a133, v33
  v_mfma_f32_16x16x32_bf16 v[164:167], a[200:203], a[4:7], v[164:167]
  s_waitcnt lgkmcnt(3)
  buffer_load_dwordx4 v243, s[32:35], s48 offen lds
  v_mfma_f32_16x16x32_bf16 v[168:171], a[200:203], a[8:11], 0
  ds_read_b64_tr_b16 a[246:247], v233 offset:6144
  v_accvgpr_write_b32 a134, v34
  v_mfma_f32_16x16x32_bf16 v[168:171], a[216:219], a[24:27], v[168:171]
  ds_read_b64_tr_b16 a[248:249], v234 offset:4096
  v_accvgpr_write_b32 a135, v35
  v_mfma_f32_16x16x32_bf16 v[172:175], a[216:219], a[28:31], 0
  ds_read_b64_tr_b16 a[250:251], v234 offset:6144
  v_accvgpr_write_b32 a148, v36
  v_mfma_f32_16x16x32_bf16 v[172:175], a[200:203], a[12:15], v[172:175]
  buffer_load_dwordx4 v244, s[32:35], s48 offen offset:1024 lds
  v_mfma_f32_16x16x32_bf16 v[188:191], a[204:207], a[12:15], 0
  ds_read_b64_tr_b16 a[252:253], v235 offset:4096
  v_accvgpr_write_b32 a149, v37
  v_accvgpr_write_b32 a150, v38
  v_mfma_f32_16x16x32_bf16 v[188:191], a[220:223], a[28:31], v[188:191]
  ds_read_b64_tr_b16 a[254:255], v235 offset:6144
  v_accvgpr_write_b32 a151, v39
  v_mfma_f32_16x16x32_bf16 v[184:187], a[220:223], a[24:27], 0
  v_accvgpr_write_b32 a164, v40
  v_accvgpr_write_b32 a165, v41
  v_mfma_f32_16x16x32_bf16 v[184:187], a[204:207], a[8:11], v[184:187]
  buffer_load_dwordx4 v245, s[32:35], s48 offen offset:2048 lds
  v_mfma_f32_16x16x32_bf16 v[180:183], a[204:207], a[4:7], 0
  v_accvgpr_write_b32 a166, v42
  v_accvgpr_write_b32 a167, v43
  v_mfma_f32_16x16x32_bf16 v[180:183], a[220:223], a[20:23], v[180:183]
  v_accvgpr_write_b32 a180, v44
  v_accvgpr_write_b32 a181, v45
  v_mfma_f32_16x16x32_bf16 v[176:179], a[220:223], a[16:19], 0
  v_accvgpr_write_b32 a182, v46
  v_accvgpr_write_b32 a183, v47
  v_mfma_f32_16x16x32_bf16 v[176:179], a[204:207], a[0:3], v[176:179]
  buffer_load_dwordx4 v246, s[32:35], s48 offen offset:3072 lds
  v_mfma_f32_16x16x32_bf16 v[128:131], a[224:227], a[32:35], v[128:131]
  s_waitcnt vmcnt(16)
  s_waitcnt lgkmcnt(6)
  s_add_u32 m0, s43, 4096
  s_add_u32 s48, s46, 65664
  ds_read_b64_tr_b16 a[192:193], v232 offset:32768
  v_mfma_f32_16x16x32_bf16 v[128:131], a[240:243], a[48:51], v[128:131]
  s_sub_u32 s51, s48, 229376
  ds_read_b64_tr_b16 a[194:195], v232 offset:34816
  v_cvt_pk_bf16_f32 v64, v64, v65
  v_mfma_f32_16x16x32_bf16 v[132:135], a[240:243], a[52:55], v[132:135]
  s_min_u32 s48, s48, s51
  ds_read_b64_tr_b16 a[196:197], v233 offset:32768
  v_cvt_pk_bf16_f32 v65, v66, v67
  v_mfma_f32_16x16x32_bf16 v[132:135], a[224:227], a[36:39], v[132:135]
L_hop4:
  s_cbranch_execz L_hop8
  s_waitcnt lgkmcnt(3)
  buffer_load_dwordx4 v243, s[32:35], s48 offen lds
  v_mfma_f32_16x16x32_bf16 v[136:139], a[224:227], a[40:43], v[136:139]
  ds_read_b64_tr_b16 a[198:199], v233 offset:34816
  v_cvt_pk_bf16_f32 v66, v80, v81
  v_mfma_f32_16x16x32_bf16 v[136:139], a[240:243], a[56:59], v[136:139]
  ds_read_b64_tr_b16 a[200:201], v234 offset:32768
  v_cvt_pk_bf16_f32 v67, v82, v83
  v_mfma_f32_16x16x32_bf16 v[140:143], a[240:243], a[60:63], v[140:143]
  ds_read_b64_tr_b16 a[202:203], v234 offset:34816
  v_mfma_f32_16x16x32_bf16 v[140:143], a[224:227], a[44:47], v[140:143]
  buffer_load_dwordx4 v244, s[32:35], s48 offen offset:1024 lds
  v_mfma_f32_16x16x32_bf16 v[156:159], a[228:231], a[44:47], v[156:159]
  ds_read_b64_tr_b16 a[204:205], v235 offset:32768
  v_permlane32_swap_b32 v64, v66
  v_mfma_f32_16x16x32_bf16 v[156:159], a[244:247], a[60:63], v[156:159]
  ds_read_b64_tr_b16 a[206:207], v235 offset:34816
  v_mfma_f32_16x16x32_bf16 v[152:155], a[244:247], a[56:59], v[152:155]
  v_permlane32_swap_b32 v65, v67
  v_mfma_f32_16x16x32_bf16 v[152:155], a[228:231], a[40:43], v[152:155]
  buffer_load_dwordx4 v245, s[32:35], s48 offen offset:2048 lds
  v_mfma_f32_16x16x32_bf16 v[148:151], a[228:231], a[36:39], v[148:151]
  v_permlane16_swap_b32 v64, v66
  v_mfma_f32_16x16x32_bf16 v[148:151], a[244:247], a[52:55], v[148:151]
  v_permlane16_swap_b32 v65, v67
  v_mfma_f32_16x16x32_bf16 v[144:147], a[244:247], a[48:51], v[144:147]
  v_accvgpr_write_b32 a136, v64
  v_accvgpr_write_b32 a137, v65
  v_mfma_f32_16x16x32_bf16 v[144:147], a[228:231], a[32:35], v[144:147]
  buffer_load_dwordx4 v246, s[32:35], s48 offen offset:3072 lds
  v_mfma_f32_16x16x32_bf16 v[160:163], a[232:235], a[32:35], v[160:163]
  s_waitcnt vmcnt(16)
  s_add_u32 m0, s43, 32768
  s_add_u32 s48, s46, 98432
  ds_read_b64_tr_b16 a[208:209], v232 offset:36864
  v_mfma_f32_16x16x32_bf16 v[160:163], a[248:251], a[48:51], v[160:163]
  s_sub_u32 s51, s48, 229376
  ds_read_b64_tr_b16 a[210:211], v232 offset:38912
  v_accvgpr_write_b32 a138, v66
  v_mfma_f32_16x16x32_bf16 v[164:167], a[248:251], a[52:55], v[164:167]
  s_min_u32 s48, s48, s51
  ds_read_b64_tr_b16 a[212:213], v233 offset:36864
  v_accvgpr_write_b32 a139, v67
  v_mfma_f32_16x16x32_bf16 v[164:167], a[232:235], a[36:39], v[164:167]
  s_waitcnt lgkmcnt(3)
  buffer_load_dwordx4 v243, s[32:35], s48 offen lds
  v_mfma_f32_16x16x32_bf16 v[168:171], a[232:235], a[40:43], v[168:171]
  ds_read_b64_tr_b16 a[214:215], v233 offset:38912
  v_cvt_pk_bf16_f32 v68, v68, v69
  v_mfma_f32_16x16x32_bf16 v[168:171], a[248:251], a[56:59], v[168:171]
  ds_read_b64_tr_b16 a[216:217], v234 offset:36864
  v_cvt_pk_bf16_f32 v69, v70, v71
  v_mfma_f32_16x16x32_bf16 v[172:175], a[248:251], a[60:63], v[172:175]
  ds_read_b64_tr_b16 a[218:219], v234 offset:38912
  v_cvt_pk_bf16_f32 v70, v84, v85
  v_mfma_f32_16x16x32_bf16 v[172:175], a[232:235], a[44:47], v[172:175]
  buffer_load_dwordx4 v244, s[32:35], s48 offen offset:1024 lds
  v_mfma_f32_16x16x32_bf16 v[188:191], a[236:239], a[44:47], v[188:191]
  ds_read_b64_tr_b16 a[220:221], v235 offset:36864
  v_cvt_pk_bf16_f32 v71, v86, v87
  v_mfma_f32_16x16x32_bf16 v[188:191], a[252:255], a[60:63], v[188:191]
  ds_read_b64_tr_b16 a[222:223], v235 offset:38912
  v_mfma_f32_16x16x32_bf16 v[184:187], a[252:255], a[56:59], v[184:187]
  v_permlane32_swap_b32 v68, v70
  v_mfma_f32_16x16x32_bf16 v[184:187], a[236:239], a[40:43], v[184:187]
  buffer_load_dwordx4 v245, s[32:35], s48 offen offset:2048 lds
  v_mfma_f32_16x16x32_bf16 v[180:183], a[236:239], a[36:39], v[180:183]
  v_permlane32_swap_b32 v69, v71
  v_mfma_f32_16x16x32_bf16 v[180:183], a[252:255], a[52:55], v[180:183]
  v_permlane16_swap_b32 v68, v70
  v_mfma_f32_16x16x32_bf16 v[176:179], a[252:255], a[48:51], v[176:179]
  v_permlane16_swap_b32 v69, v71
  v_mfma_f32_16x16x32_bf16 v[176:179], a[236:239], a[32:35], v[176:179]
  buffer_load_dwordx4 v246, s[32:35], s48 offen offset:3072 lds
  v_mfma_f32_16x16x32_bf16 v[128:131], a[192:195], a[64:67], v[128:131]
  s_waitcnt vmcnt(16)
  s_waitcnt lgkmcnt(6)
  s_add_u32 m0, s43, 36864
  s_add_u32 s48, s46, 131200
  ds_read_b64_tr_b16 a[224:225], v236 offset:0
  v_mfma_f32_16x16x32_bf16 v[128:131], a[208:211], a[80:83], v[128:131]
  s_sub_u32 s51, s48, 229376
  ds_read_b64_tr_b16 a[226:227], v236 offset:2048
  v_accvgpr_write_b32 a152, v68
  v_mfma_f32_16x16x32_bf16 v[132:135], a[208:211], a[84:87], v[132:135]
  s_min_u32 s48, s48, s51
  ds_read_b64_tr_b16 a[228:229], v237 offset:0
  v_accvgpr_write_b32 a153, v69
  v_mfma_f32_16x16x32_bf16 v[132:135], a[192:195], a[68:71], v[132:135]
  s_waitcnt lgkmcnt(3)
  buffer_load_dwordx4 v243, s[32:35], s48 offen lds
  v_mfma_f32_16x16x32_bf16 v[136:139], a[192:195], a[72:75], v[136:139]
  ds_read_b64_tr_b16 a[230:231], v237 offset:2048
  v_accvgpr_write_b32 a154, v70
  v_mfma_f32_16x16x32_bf16 v[136:139], a[208:211], a[88:91], v[136:139]
  ds_read_b64_tr_b16 a[232:233], v238 offset:0
  v_accvgpr_write_b32 a155, v71
  v_mfma_f32_16x16x32_bf16 v[140:143], a[208:211], a[92:95], v[140:143]
  ds_read_b64_tr_b16 a[234:235], v238 offset:2048
  v_cvt_pk_bf16_f32 v72, v72, v73
  v_mfma_f32_16x16x32_bf16 v[140:143], a[192:195], a[76:79], v[140:143]
  buffer_load_dwordx4 v244, s[32:35], s48 offen offset:1024 lds
  v_mfma_f32_16x16x32_bf16 v[156:159], a[196:199], a[76:79], v[156:159]
  ds_read_b64_tr_b16 a[236:237], v239 offset:0
  v_cvt_pk_bf16_f32 v73, v74, v75
  v_cvt_pk_bf16_f32 v74, v88, v89
  v_mfma_f32_16x16x32_bf16 v[156:159], a[212:215], a[92:95], v[156:159]
  ds_read_b64_tr_b16 a[238:239], v239 offset:2048
  v_cvt_pk_bf16_f32 v75, v90, v91
  v_mfma_f32_16x16x32_bf16 v[152:155], a[212:215], a[88:91], v[152:155]
  v_permlane32_swap_b32 v72, v74
  v_mfma_f32_16x16x32_bf16 v[152:155], a[196:199], a[72:75], v[152:155]
  buffer_load_dwordx4 v245, s[32:35], s48 offen offset:2048 lds
  v_mfma_f32_16x16x32_bf16 v[148:151], a[196:199], a[68:71], v[148:151]
  v_permlane32_swap_b32 v73, v75
  v_mfma_f32_16x16x32_bf16 v[148:151], a[212:215], a[84:87], v[148:151]
  v_permlane16_swap_b32 v72, v74
  v_mfma_f32_16x16x32_bf16 v[144:147], a[212:215], a[80:83], v[144:147]
  v_permlane16_swap_b32 v73, v75
  v_mfma_f32_16x16x32_bf16 v[144:147], a[196:199], a[64:67], v[144:147]
  buffer_load_dwordx4 v246, s[32:35], s48 offen offset:3072 lds
  v_mfma_f32_16x16x32_bf16 v[160:163], a[200:203], a[64:67], v[160:163]
  s_waitcnt vmcnt(16)
  s_add_u32 m0, s43, 65536
  s_add_u32 s48, s46, 163968
  ds_read_b64_tr_b16 a[240:241], v236 offset:4096
  v_mfma_f32_16x16x32_bf16 v[160:163], a[216:219], a[80:83], v[160:163]
  s_sub_u32 s51, s48, 229376
  ds_read_b64_tr_b16 a[242:243], v236 offset:6144
  v_accvgpr_write_b32 a168, v72
  v_mfma_f32_16x16x32_bf16 v[164:167], a[216:219], a[84:87], v[164:167]
  s_min_u32 s48, s48, s51
  ds_read_b64_tr_b16 a[244:245], v237 offset:4096
  v_accvgpr_write_b32 a169, v73
  v_mfma_f32_16x16x32_bf16 v[164:167], a[200:203], a[68:71], v[164:167]
  s_waitcnt lgkmcnt(3)
  buffer_load_dwordx4 v243, s[32:35], s48 offen lds
  v_mfma_f32_16x16x32_bf16 v[168:171], a[200:203], a[72:75], v[168:171]
  ds_read_b64_tr_b16 a[246:247], v237 offset:6144
  v_accvgpr_write_b32 a170, v74
  v_mfma_f32_16x16x32_bf16 v[168:171], a[216:219], a[88:91], v[168:171]
  ds_read_b64_tr_b16 a[248:249], v238 offset:4096
  v_accvgpr_write_b32 a171, v75
  v_mfma_f32_16x16x32_bf16 v[172:175], a[216:219], a[92:95], v[172:175]
  ds_read_b64_tr_b16 a[250:251], v238 offset:6144
  v_cvt_pk_bf16_f32 v76, v76, v77
  v_mfma_f32_16x16x32_bf16 v[172:175], a[200:203], a[76:79], v[172:175]
  buffer_load_dwordx4 v244, s[32:35], s48 offen offset:1024 lds
  v_mfma_f32_16x16x32_bf16 v[188:191], a[204:207], a[76:79], v[188:191]
  ds_read_b64_tr_b16 a[252:253], v239 offset:4096
  v_cvt_pk_bf16_f32 v77, v78, v79
  v_cvt_pk_bf16_f32 v78, v92, v93
  v_mfma_f32_16x16x32_bf16 v[188:191], a[220:223], a[92:95], v[188:191]
  ds_read_b64_tr_b16 a[254:255], v239 offset:6144
  v_cvt_pk_bf16_f32 v79, v94, v95
  v_mfma_f32_16x16x32_bf16 v[184:187], a[220:223], a[88:91], v[184:187]
  v_permlane32_swap_b32 v76, v78
  v_mfma_f32_16x16x32_bf16 v[184:187], a[204:207], a[72:75], v[184:187]
  buffer_load_dwordx4 v245, s[32:35], s48 offen offset:2048 lds
  v_mfma_f32_16x16x32_bf16 v[180:183], a[204:207], a[68:71], v[180:183]
  v_permlane32_swap_b32 v77, v79
  v_mfma_f32_16x16x32_bf16 v[180:183], a[220:223], a[84:87], v[180:183]
  v_permlane16_swap_b32 v76, v78
  v_mfma_f32_16x16x32_bf16 v[176:179], a[220:223], a[80:83], v[176:179]
  v_permlane16_swap_b32 v77, v79
  v_mfma_f32_16x16x32_bf16 v[176:179], a[204:207], a[64:67], v[176:179]
  buffer_load_dwordx4 v246, s[32:35], s48 offen offset:3072 lds
  v_mfma_f32_16x16x32_bf16 v[128:131], a[224:227], a[96:99], v[128:131]
  s_waitcnt vmcnt(16)
  s_add_u32 m0, s43, 69632
  s_add_u32 s48, s46, 196736
  ds_read_b64_tr_b16 a[192:193], v232 offset:0
  v_mfma_f32_16x16x32_bf16 v[132:135], a[224:227], a[100:103], v[132:135]
  s_sub_u32 s51, s48, 229376
  ds_read_b64_tr_b16 a[194:195], v232 offset:2048
  v_accvgpr_write_b32 a184, v76
  v_mfma_f32_16x16x32_bf16 v[136:139], a[224:227], a[104:107], v[136:139]
  s_min_u32 s48, s48, s51
  ds_read_b64_tr_b16 a[196:197], v233 offset:0
  v_accvgpr_write_b32 a185, v77
  v_mfma_f32_16x16x32_bf16 v[140:143], a[224:227], a[108:111], v[140:143]
  s_waitcnt lgkmcnt(3)
  buffer_load_dwordx4 v243, s[32:35], s48 offen lds
  v_mfma_f32_16x16x32_bf16 v[156:159], a[228:231], a[108:111], v[156:159]
  ds_read_b64_tr_b16 a[198:199], v233 offset:2048
  v_accvgpr_write_b32 a186, v78
  v_mfma_f32_16x16x32_bf16 v[152:155], a[228:231], a[104:107], v[152:155]
  ds_read_b64_tr_b16 a[200:201], v234 offset:0
  v_accvgpr_write_b32 a187, v79
  v_mfma_f32_16x16x32_bf16 v[148:151], a[228:231], a[100:103], v[148:151]
  ds_read_b64_tr_b16 a[202:203], v234 offset:2048
  v_cvt_pk_bf16_f32 v96, v96, v97
  v_mfma_f32_16x16x32_bf16 v[144:147], a[228:231], a[96:99], v[144:147]
  buffer_load_dwordx4 v244, s[32:35], s48 offen offset:1024 lds
  v_mfma_f32_16x16x32_bf16 v[160:163], a[232:235], a[96:99], v[160:163]
  ds_read_b64_tr_b16 a[204:205], v235 offset:0
  v_cvt_pk_bf16_f32 v97, v98, v99
  v_cvt_pk_bf16_f32 v98, v112, v113
  v_mfma_f32_16x16x32_bf16 v[164:167], a[232:235], a[100:103], v[164:167]
  ds_read_b64_tr_b16 a[206:207], v235 offset:2048
  v_cvt_pk_bf16_f32 v99, v114, v115
  v_mfma_f32_16x16x32_bf16 v[168:171], a[232:235], a[104:107], v[168:171]
  v_permlane32_swap_b32 v96, v98
  v_mfma_f32_16x16x32_bf16 v[172:175], a[232:235], a[108:111], v[172:175]
  buffer_load_dwordx4 v245, s[32:35], s48 offen offset:2048 lds
  v_mfma_f32_16x16x32_bf16 v[188:191], a[236:239], a[108:111], v[188:191]
  v_permlane32_swap_b32 v97, v99
  v_mfma_f32_16x16x32_bf16 v[184:187], a[236:239], a[104:107], v[184:187]
  v_permlane16_swap_b32 v96, v98
  v_mfma_f32_16x16x32_bf16 v[180:183], a[236:239], a[100:103], v[180:183]
  v_permlane16_swap_b32 v97, v99
  v_mfma_f32_16x16x32_bf16 v[176:179], a[236:239], a[96:99], v[176:179]
  buffer_load_dwordx4 v246, s[32:35], s48 offen offset:3072 lds
  v_mfma_f32_16x16x32_bf16 v[0:3], a[240:243], a[0:3], 0
  s_waitcnt vmcnt(16)
  s_waitcnt lgkmcnt(6)
  ds_read_b64_tr_b16 a[208:209], v232 offset:4096
  v_accvgpr_write_b32 a140, v96
  v_mfma_f32_16x16x32_bf16 v[0:3], a[192:195], a[16:19], v[0:3]
  s_add_u32 m0, s53, 32768
  ds_read_b64_tr_b16 a[210:211], v232 offset:6144
  v_accvgpr_write_b32 a141, v97
  v_mfma_f32_16x16x32_bf16 v[4:7], a[192:195], a[20:23], 0
  s_add_u32 s48, s52, 0
  ds_read_b64_tr_b16 a[212:213], v233 offset:4096
  v_accvgpr_write_b32 a142, v98
  v_mfma_f32_16x16x32_bf16 v[4:7], a[240:243], a[4:7], v[4:7]
  buffer_load_dwordx4 v200, s[12:15], s48 offen lds
  v_mfma_f32_16x16x32_bf16 v[8:11], a[240:243], a[8:11], 0
  ds_read_b64_tr_b16 a[214:215], v233 offset:6144
  v_accvgpr_write_b32 a143, v99
  v_mfma_f32_16x16x32_bf16 v[8:11], a[192:195], a[24:27], v[8:11]
  ds_read_b64_tr_b16 a[216:217], v234 offset:4096
  v_cvt_pk_bf16_f32 v100, v100, v101
  v_mfma_f32_16x16x32_bf16 v[12:15], a[192:195], a[28:31], 0
  ds_read_b64_tr_b16 a[218:219], v234 offset:6144
  v_cvt_pk_bf16_f32 v101, v102, v103
  v_mfma_f32_16x16x32_bf16 v[12:15], a[240:243], a[12:15], v[12:15]
  buffer_load_dwordx4 v201, s[12:15], s48 offen offset:1024 lds
  v_mfma_f32_16x16x32_bf16 v[28:31], a[244:247], a[12:15], 0
  s_waitcnt lgkmcnt(10)
  ds_read_b64_tr_b16 a[220:221], v235 offset:4096
  v_cvt_pk_bf16_f32 v102, v116, v117
  v_cvt_pk_bf16_f32 v103, v118, v119
  v_mfma_f32_16x16x32_bf16 v[28:31], a[196:199], a[28:31], v[28:31]
  ds_read_b64_tr_b16 a[222:223], v235 offset:6144
  v_mfma_f32_16x16x32_bf16 v[24:27], a[196:199], a[24:27], 0
  v_permlane32_swap_b32 v100, v102
  v_mfma_f32_16x16x32_bf16 v[24:27], a[244:247], a[8:11], v[24:27]
  buffer_load_dwordx4 v202, s[12:15], s48 offen offset:2048 lds
  v_mfma_f32_16x16x32_bf16 v[20:23], a[244:247], a[4:7], 0
  v_permlane32_swap_b32 v101, v103
  v_mfma_f32_16x16x32_bf16 v[20:23], a[196:199], a[20:23], v[20:23]
  v_permlane16_swap_b32 v100, v102
  v_mfma_f32_16x16x32_bf16 v[16:19], a[196:199], a[16:19], 0
  v_permlane16_swap_b32 v101, v103
  v_mfma_f32_16x16x32_bf16 v[16:19], a[244:247], a[0:3], v[16:19]
  buffer_load_dwordx4 v203, s[12:15], s48 offen offset:3072 lds
  v_mfma_f32_16x16x32_bf16 v[32:35], a[248:251], a[0:3], 0
  s_waitcnt vmcnt(16)
  s_waitcnt lgkmcnt(10)
  ds_read_b64_tr_b16 a[224:225], v232 offset:32768
  v_accvgpr_write_b32 a156, v100
  v_mfma_f32_16x16x32_bf16 v[32:35], a[200:203], a[16:19], v[32:35]
  s_add_u32 m0, s53, 36864
  ds_read_b64_tr_b16 a[226:227], v232 offset:34816
  v_accvgpr_write_b32 a157, v101
  v_mfma_f32_16x16x32_bf16 v[36:39], a[200:203], a[20:23], 0
  s_add_u32 s48, s52, 4096
  ds_read_b64_tr_b16 a[228:229], v233 offset:32768
  v_accvgpr_write_b32 a158, v102
  v_mfma_f32_16x16x32_bf16 v[36:39], a[248:251], a[4:7], v[36:39]
  buffer_load_dwordx4 v200, s[12:15], s48 offen lds
  v_mfma_f32_16x16x32_bf16 v[40:43], a[248:251], a[8:11], 0
  ds_read_b64_tr_b16 a[230:231], v233 offset:34816
  v_accvgpr_write_b32 a159, v103
  v_mfma_f32_16x16x32_bf16 v[40:43], a[200:203], a[24:27], v[40:43]
  ds_read_b64_tr_b16 a[232:233], v234 offset:32768
  v_cvt_pk_bf16_f32 v104, v104, v105
  v_mfma_f32_16x16x32_bf16 v[44:47], a[200:203], a[28:31], 0
  ds_read_b64_tr_b16 a[234:235], v234 offset:34816
  v_cvt_pk_bf16_f32 v105, v106, v107
  v_mfma_f32_16x16x32_bf16 v[44:47], a[248:251], a[12:15], v[44:47]
  buffer_load_dwordx4 v201, s[12:15], s48 offen offset:1024 lds
  v_mfma_f32_16x16x32_bf16 v[60:63], a[252:255], a[12:15], 0
  s_waitcnt lgkmcnt(14)
  ds_read_b64_tr_b16 a[236:237], v235 offset:32768
  v_cvt_pk_bf16_f32 v106, v120, v121
  v_cvt_pk_bf16_f32 v107, v122, v123
  v_mfma_f32_16x16x32_bf16 v[60:63], a[204:207], a[28:31], v[60:63]
  ds_read_b64_tr_b16 a[238:239], v235 offset:34816
  v_mfma_f32_16x16x32_bf16 v[56:59], a[204:207], a[24:27], 0
  v_permlane32_swap_b32 v104, v106
  v_mfma_f32_16x16x32_bf16 v[56:59], a[252:255], a[8:11], v[56:59]
  buffer_load_dwordx4 v202, s[12:15], s48 offen offset:2048 lds
  v_mfma_f32_16x16x32_bf16 v[52:55], a[252:255], a[4:7], 0
  v_permlane32_swap_b32 v105, v107
  v_mfma_f32_16x16x32_bf16 v[52:55], a[204:207], a[20:23], v[52:55]
  v_permlane16_swap_b32 v104, v106
  v_mfma_f32_16x16x32_bf16 v[48:51], a[204:207], a[16:19], 0
  v_permlane16_swap_b32 v105, v107
  v_mfma_f32_16x16x32_bf16 v[48:51], a[252:255], a[0:3], v[48:51]
  s_waitcnt lgkmcnt(14)
  buffer_load_dwordx4 v203, s[12:15], s48 offen offset:3072 lds
  v_mfma_f32_16x16x32_bf16 v[0:3], a[208:211], a[32:35], v[0:3]
  s_waitcnt vmcnt(16)
  s_waitcnt lgkmcnt(6)
  ds_read_b64_tr_b16 a[240:241], v232 offset:36864
  v_accvgpr_write_b32 a172, v104
  v_mfma_f32_16x16x32_bf16 v[0:3], a[224:227], a[48:51], v[0:3]
  s_add_u32 m0, s53, 0
  ds_read_b64_tr_b16 a[242:243], v232 offset:38912
  v_accvgpr_write_b32 a173, v105
  v_mfma_f32_16x16x32_bf16 v[4:7], a[224:227], a[52:55], v[4:7]
  s_add_u32 s48, s52, 32768
  ds_read_b64_tr_b16 a[244:245], v233 offset:36864
  v_accvgpr_write_b32 a174, v106
  v_mfma_f32_16x16x32_bf16 v[4:7], a[208:211], a[36:39], v[4:7]
  buffer_load_dwordx4 v200, s[12:15], s48 offen lds
  v_mfma_f32_16x16x32_bf16 v[8:11], a[208:211], a[40:43], v[8:11]
  ds_read_b64_tr_b16 a[246:247], v233 offset:38912
  v_accvgpr_write_b32 a175, v107
  v_mfma_f32_16x16x32_bf16 v[8:11], a[224:227], a[56:59], v[8:11]
  ds_read_b64_tr_b16 a[248:249], v234 offset:36864
  v_cvt_pk_bf16_f32 v108, v108, v109
  v_mfma_f32_16x16x32_bf16 v[12:15], a[224:227], a[60:63], v[12:15]
  ds_read_b64_tr_b16 a[250:251], v234 offset:38912
  v_cvt_pk_bf16_f32 v109, v110, v111
  v_mfma_f32_16x16x32_bf16 v[12:15], a[208:211], a[44:47], v[12:15]
  buffer_load_dwordx4 v201, s[12:15], s48 offen offset:1024 lds
  v_mfma_f32_16x16x32_bf16 v[28:31], a[212:215], a[44:47], v[28:31]
  s_waitcnt lgkmcnt(10)
  ds_read_b64_tr_b16 a[252:253], v235 offset:36864
  v_cvt_pk_bf16_f32 v110, v124, v125
  v_cvt_pk_bf16_f32 v111, v126, v127
  v_mfma_f32_16x16x32_bf16 v[28:31], a[228:231], a[60:63], v[28:31]
  ds_read_b64_tr_b16 a[254:255], v235 offset:38912
  v_mfma_f32_16x16x32_bf16 v[24:27], a[228:231], a[56:59], v[24:27]
  v_permlane32_swap_b32 v108, v110
  v_mfma_f32_16x16x32_bf16 v[24:27], a[212:215], a[40:43], v[24:27]
  buffer_load_dwordx4 v202, s[12:15], s48 offen offset:2048 lds
  v_mfma_f32_16x16x32_bf16 v[20:23], a[212:215], a[36:39], v[20:23]
  v_permlane32_swap_b32 v109, v111
  v_mfma_f32_16x16x32_bf16 v[20:23], a[228:231], a[52:55], v[20:23]
  v_permlane16_swap_b32 v108, v110
  v_mfma_f32_16x16x32_bf16 v[16:19], a[228:231], a[48:51], v[16:19]
  v_permlane16_swap_b32 v109, v111
  v_mfma_f32_16x16x32_bf16 v[16:19], a[212:215], a[32:35], v[16:19]
  buffer_load_dwordx4 v203, s[12:15], s48 offen offset:3072 lds
  v_mfma_f32_16x16x32_bf16 v[32:35], a[216:219], a[32:35], v[32:35]
  s_waitcnt vmcnt(16)
  s_waitcnt lgkmcnt(10)
  ds_read_b64_tr_b16 a[192:193], v236 offset:0
  v_accvgpr_write_b32 a188, v108
  v_mfma_f32_16x16x32_bf16 v[32:35], a[232:235], a[48:51], v[32:35]
  s_add_u32 m0, s53, 4096
  ds_read_b64_tr_b16 a[194:195], v236 offset:2048
  v_accvgpr_write_b32 a189, v109
  v_mfma_f32_16x16x32_bf16 v[36:39], a[232:235], a[52:55], v[36:39]
  s_add_u32 s48, s52, 36864
  ds_read_b64_tr_b16 a[196:197], v237 offset:0
  v_accvgpr_write_b32 a190, v110
  v_mfma_f32_16x16x32_bf16 v[36:39], a[216:219], a[36:39], v[36:39]
  buffer_load_dwordx4 v200, s[12:15], s48 offen lds
  v_mfma_f32_16x16x32_bf16 v[40:43], a[216:219], a[40:43], v[40:43]
  ds_read_b64_tr_b16 a[198:199], v237 offset:2048
  v_accvgpr_write_b32 a191, v111
  v_mfma_f32_16x16x32_bf16 v[40:43], a[232:235], a[56:59], v[40:43]
  ds_read_b64_tr_b16 a[200:201], v238 offset:0
  v_cvt_pk_bf16_f32 v80, v128, v129
  v_mfma_f32_16x16x32_bf16 v[44:47], a[232:235], a[60:63], v[44:47]
  ds_read_b64_tr_b16 a[202:203], v238 offset:2048
  v_cvt_pk_bf16_f32 v81, v130, v131
  v_mfma_f32_16x16x32_bf16 v[44:47], a[216:219], a[44:47], v[44:47]
  buffer_load_dwordx4 v201, s[12:15], s48 offen offset:1024 lds
  v_mfma_f32_16x16x32_bf16 v[60:63], a[220:223], a[44:47], v[60:63]
  s_waitcnt lgkmcnt(14)
  ds_read_b64_tr_b16 a[204:205], v239 offset:0
  v_cvt_pk_bf16_f32 v82, v144, v145
  v_mfma_f32_16x16x32_bf16 v[60:63], a[236:239], a[60:63], v[60:63]
  ds_read_b64_tr_b16 a[206:207], v239 offset:2048
  v_cvt_pk_bf16_f32 v83, v146, v147
  v_mfma_f32_16x16x32_bf16 v[56:59], a[236:239], a[56:59], v[56:59]
  v_cvt_pk_bf16_f32 v84, v132, v133
  v_cvt_pk_bf16_f32 v85, v134, v135
  v_mfma_f32_16x16x32_bf16 v[56:59], a[220:223], a[40:43], v[56:59]
  buffer_load_dwordx4 v202, s[12:15], s48 offen offset:2048 lds
  v_mfma_f32_16x16x32_bf16 v[52:55], a[220:223], a[36:39], v[52:55]
  v_cvt_pk_bf16_f32 v86, v148, v149
  v_cvt_pk_bf16_f32 v87, v150, v151
  v_mfma_f32_16x16x32_bf16 v[52:55], a[236:239], a[52:55], v[52:55]
  v_cvt_pk_bf16_f32 v88, v136, v137
  v_cvt_pk_bf16_f32 v89, v138, v139
  v_mfma_f32_16x16x32_bf16 v[48:51], a[236:239], a[48:51], v[48:51]
  v_cvt_pk_bf16_f32 v90, v152, v153
  v_cvt_pk_bf16_f32 v91, v154, v155
  v_mfma_f32_16x16x32_bf16 v[48:51], a[220:223], a[32:35], v[48:51]
  s_waitcnt lgkmcnt(14)
  buffer_load_dwordx4 v203, s[12:15], s48 offen offset:3072 lds
  v_mfma_f32_16x16x32_bf16 v[0:3], a[240:243], a[64:67], v[0:3]
  s_waitcnt vmcnt(16)
  s_waitcnt lgkmcnt(6)
  ds_read_b64_tr_b16 a[208:209], v236 offset:4096
  v_cvt_pk_bf16_f32 v92, v140, v141
  v_mfma_f32_16x16x32_bf16 v[0:3], a[192:195], a[80:83], v[0:3]
  s_add_u32 m0, s43, 0
  ds_read_b64_tr_b16 a[210:211], v236 offset:6144
  v_cvt_pk_bf16_f32 v93, v142, v143
  v_mfma_f32_16x16x32_bf16 v[4:7], a[192:195], a[84:87], v[4:7]
  s_add_u32 s48, s47, 0
  ds_read_b64_tr_b16 a[212:213], v237 offset:4096
  v_cvt_pk_bf16_f32 v94, v156, v157
  v_mfma_f32_16x16x32_bf16 v[4:7], a[240:243], a[68:71], v[4:7]
  buffer_load_dwordx4 v243, s[24:27], s48 offen lds
  v_mfma_f32_16x16x32_bf16 v[8:11], a[240:243], a[72:75], v[8:11]
  ds_read_b64_tr_b16 a[214:215], v237 offset:6144
  v_cvt_pk_bf16_f32 v95, v158, v159
  v_mfma_f32_16x16x32_bf16 v[8:11], a[192:195], a[88:91], v[8:11]
  ds_read_b64_tr_b16 a[216:217], v238 offset:4096
  v_cvt_pk_bf16_f32 v112, v160, v161
  v_mfma_f32_16x16x32_bf16 v[12:15], a[192:195], a[92:95], v[12:15]
  ds_read_b64_tr_b16 a[218:219], v238 offset:6144
  v_cvt_pk_bf16_f32 v113, v162, v163
  v_mfma_f32_16x16x32_bf16 v[12:15], a[240:243], a[76:79], v[12:15]
  buffer_load_dwordx4 v244, s[24:27], s48 offen offset:1024 lds
  v_mfma_f32_16x16x32_bf16 v[28:31], a[244:247], a[76:79], v[28:31]
  s_waitcnt lgkmcnt(10)
  ds_read_b64_tr_b16 a[220:221], v239 offset:4096
  v_cvt_pk_bf16_f32 v114, v176, v177
  v_mfma_f32_16x16x32_bf16 v[28:31], a[196:199], a[92:95], v[28:31]
  ds_read_b64_tr_b16 a[222:223], v239 offset:6144
  v_cvt_pk_bf16_f32 v115, v178, v179
  v_mfma_f32_16x16x32_bf16 v[24:27], a[196:199], a[88:91], v[24:27]
  v_cvt_pk_bf16_f32 v116, v164, v165
  v_cvt_pk_bf16_f32 v117, v166, v167
  v_mfma_f32_16x16x32_bf16 v[24:27], a[244:247], a[72:75], v[24:27]
  buffer_load_dwordx4 v245, s[24:27], s48 offen offset:2048 lds
  v_mfma_f32_16x16x32_bf16 v[20:23], a[244:247], a[68:71], v[20:23]
  v_cvt_pk_bf16_f32 v118, v180, v181
  v_cvt_pk_bf16_f32 v119, v182, v183
  v_mfma_f32_16x16x32_bf16 v[20:23], a[196:199], a[84:87], v[20:23]
  v_cvt_pk_bf16_f32 v120, v168, v169
  v_cvt_pk_bf16_f32 v121, v170, v171
  v_mfma_f32_16x16x32_bf16 v[16:19], a[196:199], a[80:83], v[16:19]
  v_cvt_pk_bf16_f32 v122, v184, v185
  v_cvt_pk_bf16_f32 v123, v186, v187
  v_mfma_f32_16x16x32_bf16 v[16:19], a[244:247], a[64:67], v[16:19]
  buffer_load_dwordx4 v246, s[24:27], s48 offen offset:3072 lds
  v_mfma_f32_16x16x32_bf16 v[32:35], a[248:251], a[64:67], v[32:35]
  s_waitcnt lgkmcnt(10)
  v_cvt_pk_bf16_f32 v124, v172, v173
  v_cvt_pk_bf16_f32 v125, v174, v175
  v_mfma_f32_16x16x32_bf16 v[32:35], a[200:203], a[80:83], v[32:35]
  s_add_u32 m0, s43, 4096
  v_cvt_pk_bf16_f32 v126, v188, v189
  v_cvt_pk_bf16_f32 v127, v190, v191
  v_mfma_f32_16x16x32_bf16 v[36:39], a[200:203], a[84:87], v[36:39]
  s_add_u32 s48, s47, 32768
  v_accvgpr_write_b32 a112, 0
  v_accvgpr_write_b32 a113, 0
  v_mfma_f32_16x16x32_bf16 v[36:39], a[248:251], a[68:71], v[36:39]
  buffer_load_dwordx4 v243, s[24:27], s48 offen lds
  v_mfma_f32_16x16x32_bf16 v[40:43], a[248:251], a[72:75], v[40:43]
  v_accvgpr_write_b32 a114, 0
  v_accvgpr_write_b32 a115, 0
  v_mfma_f32_16x16x32_bf16 v[40:43], a[200:203], a[88:91], v[40:43]
  v_accvgpr_write_b32 a116, 0
  v_accvgpr_write_b32 a117, 0
  v_mfma_f32_16x16x32_bf16 v[44:47], a[200:203], a[92:95], v[44:47]
  v_accvgpr_write_b32 a118, 0
  v_accvgpr_write_b32 a119, 0
  v_mfma_f32_16x16x32_bf16 v[44:47], a[248:251], a[76:79], v[44:47]
  buffer_load_dwordx4 v244, s[24:27], s48 offen offset:1024 lds
  v_mfma_f32_16x16x32_bf16 v[60:63], a[252:255], a[76:79], v[60:63]
  s_waitcnt lgkmcnt(8)
  v_accvgpr_write_b32 a120, 0
  v_accvgpr_write_b32 a121, 0
  v_mfma_f32_16x16x32_bf16 v[60:63], a[204:207], a[92:95], v[60:63]
  v_accvgpr_write_b32 a122, 0
  v_accvgpr_write_b32 a123, 0
  v_mfma_f32_16x16x32_bf16 v[56:59], a[204:207], a[88:91], v[56:59]
  v_accvgpr_write_b32 a124, 0
  v_accvgpr_write_b32 a125, 0
  v_mfma_f32_16x16x32_bf16 v[56:59], a[252:255], a[72:75], v[56:59]
  buffer_load_dwordx4 v245, s[24:27], s48 offen offset:2048 lds
  v_mfma_f32_16x16x32_bf16 v[52:55], a[252:255], a[68:71], v[52:55]
  v_accvgpr_write_b32 a126, 0
  v_accvgpr_write_b32 a127, 0
  v_mfma_f32_16x16x32_bf16 v[52:55], a[204:207], a[84:87], v[52:55]
  v_mfma_f32_16x16x32_bf16 v[48:51], a[204:207], a[80:83], v[48:51]
  v_mfma_f32_16x16x32_bf16 v[48:51], a[252:255], a[64:67], v[48:51]
  s_waitcnt lgkmcnt(6)
  buffer_load_dwordx4 v246, s[24:27], s48 offen offset:3072 lds
  v_mfma_f32_16x16x32_bf16 v[0:3], a[208:211], a[96:99], v[0:3]
  v_mfma_f32_16x16x32_bf16 v[4:7], a[208:211], a[100:103], v[4:7]
  v_mfma_f32_16x16x32_bf16 v[8:11], a[208:211], a[104:107], v[8:11]
  v_mfma_f32_16x16x32_bf16 v[12:15], a[208:211], a[108:111], v[12:15]
  s_waitcnt lgkmcnt(4)
  v_mfma_f32_16x16x32_bf16 v[28:31], a[212:215], a[108:111], v[28:31]
  v_mfma_f32_16x16x32_bf16 v[24:27], a[212:215], a[104:107], v[24:27]
  v_mfma_f32_16x16x32_bf16 v[20:23], a[212:215], a[100:103], v[20:23]
  v_mfma_f32_16x16x32_bf16 v[16:19], a[212:215], a[96:99], v[16:19]
  s_waitcnt lgkmcnt(2)
  v_mfma_f32_16x16x32_bf16 v[32:35], a[216:219], a[96:99], v[32:35]
  v_mfma_f32_16x16x32_bf16 v[36:39], a[216:219], a[100:103], v[36:39]
  v_mfma_f32_16x16x32_bf16 v[40:43], a[216:219], a[104:107], v[40:43]
  v_mfma_f32_16x16x32_bf16 v[44:47], a[216:219], a[108:111], v[44:47]
  s_waitcnt lgkmcnt(0)
  v_mfma_f32_16x16x32_bf16 v[60:63], a[220:223], a[108:111], v[60:63]
  v_mfma_f32_16x16x32_bf16 v[56:59], a[220:223], a[104:107], v[56:59]
  v_mfma_f32_16x16x32_bf16 v[52:55], a[220:223], a[100:103], v[52:55]
  v_mfma_f32_16x16x32_bf16 v[48:51], a[220:223], a[96:99], v[48:51]
  s_waitcnt vmcnt(16)
  s_barrier
  ds_read_b128 a[192:195], v192 offset:32768
  ds_read_b128 a[196:199], v193 offset:32768
  ds_read_b128 a[200:203], v194 offset:32768
  ds_read_b128 a[204:207], v195 offset:32768
  buffer_store_dwordx4 v[80:83], v229, s[36:39], s64 offen sc1
  buffer_load_dwordx4 v[248:251], v230, s[8:11], s75 offen
  buffer_load_dwordx4 v[252:255], v230, s[8:11], s75 offen offset:128
  v_cvt_pk_bf16_f32 v19, v18, v19
  v_cvt_pk_bf16_f32 v18, v16, v17
  v_cvt_pk_bf16_f32 v16, v0, v1
  v_cvt_pk_bf16_f32 v17, v2, v3
  v_cvt_pk_bf16_f32 v23, v22, v23
  v_cvt_pk_bf16_f32 v22, v20, v21
  v_cvt_pk_bf16_f32 v20, v4, v5
  v_cvt_pk_bf16_f32 v21, v6, v7
  s_waitcnt lgkmcnt(3)
  v_mfma_f32_16x16x32_bf16 v[128:131], a[192:195], a[128:131], 0
  s_waitcnt lgkmcnt(2)
  v_cvt_pk_bf16_f32 v27, v26, v27
  v_cvt_pk_bf16_f32 v26, v24, v25
  v_mfma_f32_16x16x32_bf16 v[128:131], a[196:199], a[132:135], v[128:131]
  s_waitcnt lgkmcnt(1)
  v_cvt_pk_bf16_f32 v24, v8, v9
  v_cvt_pk_bf16_f32 v25, v10, v11
  v_mfma_f32_16x16x32_bf16 v[128:131], a[200:203], a[136:139], v[128:131]
  s_waitcnt lgkmcnt(0)
  v_cvt_pk_bf16_f32 v31, v30, v31
  v_cvt_pk_bf16_f32 v30, v28, v29
  v_mfma_f32_16x16x32_bf16 v[128:131], a[204:207], a[140:143], v[128:131]
  v_cvt_pk_bf16_f32 v28, v12, v13
  v_cvt_pk_bf16_f32 v29, v14, v15
  v_mfma_f32_16x16x32_bf16 v[132:135], a[204:207], a[156:159], 0
  v_cvt_pk_bf16_f32 v51, v50, v51
  v_cvt_pk_bf16_f32 v50, v48, v49
  v_mfma_f32_16x16x32_bf16 v[132:135], a[200:203], a[152:155], v[132:135]
L_hop5:
  s_cbranch_execz L_hop9
  v_cvt_pk_bf16_f32 v48, v32, v33
  v_cvt_pk_bf16_f32 v49, v34, v35
  v_mfma_f32_16x16x32_bf16 v[132:135], a[196:199], a[148:151], v[132:135]
  v_cvt_pk_bf16_f32 v55, v54, v55
  v_cvt_pk_bf16_f32 v54, v52, v53
  v_mfma_f32_16x16x32_bf16 v[132:135], a[192:195], a[144:147], v[132:135]
  v_cvt_pk_bf16_f32 v52, v36, v37
  v_cvt_pk_bf16_f32 v53, v38, v39
  v_mfma_f32_16x16x32_bf16 v[136:139], a[192:195], a[160:163], 0
  v_cvt_pk_bf16_f32 v59, v58, v59
  v_cvt_pk_bf16_f32 v58, v56, v57
  v_mfma_f32_16x16x32_bf16 v[136:139], a[196:199], a[164:167], v[136:139]
  v_cvt_pk_bf16_f32 v56, v40, v41
  v_cvt_pk_bf16_f32 v57, v42, v43
  v_mfma_f32_16x16x32_bf16 v[136:139], a[200:203], a[168:171], v[136:139]
  v_cvt_pk_bf16_f32 v63, v62, v63
  v_cvt_pk_bf16_f32 v62, v60, v61
  v_mfma_f32_16x16x32_bf16 v[136:139], a[204:207], a[172:175], v[136:139]
  v_cvt_pk_bf16_f32 v60, v44, v45
  v_cvt_pk_bf16_f32 v61, v46, v47
  v_mfma_f32_16x16x32_bf16 v[140:143], a[204:207], a[188:191], 0
  v_max3_f32 v216, v128, v129, v130
  v_max_f32 v216, v216, v131
  v_mfma_f32_16x16x32_bf16 v[140:143], a[200:203], a[184:187], v[140:143]
  v_mfma_f32_16x16x32_bf16 v[140:143], a[196:199], a[180:183], v[140:143]
  v_max3_f32 v217, v132, v133, v134
  v_max_f32 v217, v217, v135
  v_mfma_f32_16x16x32_bf16 v[140:143], a[192:195], a[176:179], v[140:143]
  buffer_store_dwordx4 v[16:19], v229, s[36:39], s66 offen sc1
  v_max3_f32 v218, v136, v137, v138
  v_max_f32 v218, v218, v139
  s_nop 4
  v_max3_f32 v219, v140, v141, v142
  v_max_f32 v219, v219, v143
  v_mov_b32 v220, v216
  v_mov_b32 v221, v217
  v_mov_b32 v222, v218
  v_mov_b32 v223, v219
  v_permlane32_swap_b32 v216, v220
  v_permlane32_swap_b32 v217, v221
  v_permlane32_swap_b32 v218, v222
  v_permlane32_swap_b32 v219, v223
  v_max_f32 v216, v216, v220
  v_max_f32 v217, v217, v221
  v_max_f32 v218, v218, v222
  v_max_f32 v219, v219, v223
  v_mov_b32 v220, v216
  v_mov_b32 v221, v217
  v_mov_b32 v222, v218
  v_mov_b32 v223, v219
  v_permlane16_swap_b32 v216, v220
  v_permlane16_swap_b32 v217, v221
  v_permlane16_swap_b32 v218, v222
  v_permlane16_swap_b32 v219, v223
  v_max_f32 v216, v216, v220
  v_max_f32 v217, v217, v221
  v_max_f32 v218, v218, v222
  v_max_f32 v219, v219, v223
  v_sub_f32 v160, 0, v216
  v_sub_f32 v161, 0, v216
  v_sub_f32 v162, 0, v216
  v_sub_f32 v163, 0, v216
  v_sub_f32 v164, 0, v217
  v_sub_f32 v165, 0, v217
  v_sub_f32 v166, 0, v217
  v_sub_f32 v167, 0, v217
  v_sub_f32 v168, 0, v218
  v_sub_f32 v169, 0, v218
  v_sub_f32 v170, 0, v218
  v_sub_f32 v171, 0, v218
  v_sub_f32 v172, 0, v219
  v_sub_f32 v173, 0, v219
  v_sub_f32 v174, 0, v219
  v_sub_f32 v175, 0, v219
L_attn:
  v_mfma_f32_16x16x32_bf16 v[128:131], a[192:195], a[128:131], v[160:163]
  ds_read_b128 a[240:243], v192 offset:36864
  v_lshlrev_b32 v226, 5, v247
  v_mfma_f32_16x16x32_bf16 v[128:131], a[196:199], a[132:135], v[128:131]
  v_mov_b32 v225, 1
  v_mov_b32 v176, 0
  v_mfma_f32_16x16x32_bf16 v[128:131], a[200:203], a[136:139], v[128:131]
  ds_read_b128 a[244:247], v193 offset:36864
  v_mov_b32 v177, 0
  v_mfma_f32_16x16x32_bf16 v[128:131], a[204:207], a[140:143], v[128:131]
  s_add_u32 m0, s53, 98304
  v_mov_b32 v178, 0
  v_mov_b32 v179, 0
  v_mfma_f32_16x16x32_bf16 v[132:135], a[204:207], a[156:159], v[164:167]
  s_add_u32 s48, s52, 0
  ds_read_b128 a[248:251], v194 offset:36864
  v_mov_b32 v180, 0
  v_mfma_f32_16x16x32_bf16 v[132:135], a[200:203], a[152:155], v[132:135]
  buffer_load_dwordx4 v204, s[16:19], s48 offen lds
  v_mfma_f32_16x16x32_bf16 v[132:135], a[196:199], a[148:151], v[132:135]
  ds_read_b128 a[252:255], v195 offset:36864
  v_mov_b32 v181, 0
  v_mfma_f32_16x16x32_bf16 v[132:135], a[192:195], a[144:147], v[132:135]
  v_mov_b32 v182, 0
  v_mov_b32 v183, 0
  v_mfma_f32_16x16x32_bf16 v[136:139], a[192:195], a[160:163], v[168:171]
  v_and_b32 v184, 1, v247
  v_mul_u32_u24 v184, 0xaaaa, v184
  v_mfma_f32_16x16x32_bf16 v[136:139], a[196:199], a[164:167], v[136:139]
  buffer_load_dwordx4 v205, s[16:19], s48 offen offset:1024 lds
  v_mfma_f32_16x16x32_bf16 v[136:139], a[200:203], a[168:171], v[136:139]
  v_add_u32 v184, 0x4444, v184
  v_lshl_or_b32 v184, v184, 16, v184
  v_mfma_f32_16x16x32_bf16 v[136:139], a[204:207], a[172:175], v[136:139]
  buffer_load_dwordx4 v204, s[16:19], s48 offen offset:2048 lds
  v_mfma_f32_16x16x32_bf16 v[140:143], a[204:207], a[188:191], v[172:175]
  v_mfma_f32_16x16x32_bf16 v[140:143], a[200:203], a[184:187], v[140:143]
  buffer_load_dwordx4 v205, s[16:19], s48 offen offset:3072 lds
  v_mfma_f32_16x16x32_bf16 v[140:143], a[196:199], a[180:183], v[140:143]
  v_mfma_f32_16x16x32_bf16 v[140:143], a[192:195], a[176:179], v[140:143]
  s_waitcnt lgkmcnt(0)
  buffer_store_dwordx4 v[20:23], v229, s[36:39], s66 offen offset:1024 sc1
  v_mfma_f32_16x16x32_bf16 v[144:147], a[240:243], a[128:131], v[160:163]
  ds_read_b128 a[192:195], v192 offset:40960
  v_exp_f32 v128, v128
  v_mfma_f32_16x16x32_bf16 v[144:147], a[244:247], a[132:135], v[144:147]
  v_exp_f32 v129, v129
  v_mfma_f32_16x16x32_bf16 v[144:147], a[248:251], a[136:139], v[144:147]
  ds_read_b128 a[196:199], v193 offset:40960
  v_cvt_pk_bf16_f32 v0, v128, v129
  v_exp_f32 v130, v130
  v_mfma_f32_16x16x32_bf16 v[144:147], a[252:255], a[140:143], v[144:147]
  s_add_u32 m0, s53, 102400
  v_exp_f32 v131, v131
  v_mfma_f32_16x16x32_bf16 v[148:151], a[252:255], a[156:159], v[164:167]
  s_add_u32 s48, s52, 4096
  ds_read_b128 a[200:203], v194 offset:40960
  v_cvt_pk_bf16_f32 v1, v130, v131
  v_exp_f32 v132, v132
  v_mfma_f32_16x16x32_bf16 v[148:151], a[248:251], a[152:155], v[148:151]
  buffer_load_dwordx4 v204, s[16:19], s48 offen lds
  v_exp_f32 v133, v133
  v_mfma_f32_16x16x32_bf16 v[148:151], a[244:247], a[148:151], v[148:151]
  ds_read_b128 a[204:207], v195 offset:40960
  v_cvt_pk_bf16_f32 v4, v132, v133
  v_exp_f32 v134, v134
  v_mfma_f32_16x16x32_bf16 v[148:151], a[240:243], a[144:147], v[148:151]
  v_exp_f32 v135, v135
  v_mfma_f32_16x16x32_bf16 v[152:155], a[240:243], a[160:163], v[168:171]
  v_cvt_pk_bf16_f32 v5, v134, v135
  v_exp_f32 v136, v136
  v_mfma_f32_16x16x32_bf16 v[152:155], a[244:247], a[164:167], v[152:155]
  buffer_load_dwordx4 v205, s[16:19], s48 offen offset:1024 lds
  v_exp_f32 v137, v137
  v_mfma_f32_16x16x32_bf16 v[152:155], a[248:251], a[168:171], v[152:155]
  v_cvt_pk_bf16_f32 v8, v136, v137
  v_exp_f32 v138, v138
  v_mfma_f32_16x16x32_bf16 v[152:155], a[252:255], a[172:175], v[152:155]
  buffer_load_dwordx4 v204, s[16:19], s48 offen offset:2048 lds
  v_exp_f32 v139, v139
  v_mfma_f32_16x16x32_bf16 v[156:159], a[252:255], a[188:191], v[172:175]
  v_cvt_pk_bf16_f32 v9, v138, v139
  v_exp_f32 v140, v140
  v_mfma_f32_16x16x32_bf16 v[156:159], a[248:251], a[184:187], v[156:159]
  buffer_load_dwordx4 v205, s[16:19], s48 offen offset:3072 lds
  v_exp_f32 v141, v141
  v_mfma_f32_16x16x32_bf16 v[156:159], a[244:247], a[180:183], v[156:159]
  v_cvt_pk_bf16_f32 v12, v140, v141
  v_exp_f32 v142, v142
  v_mfma_f32_16x16x32_bf16 v[156:159], a[240:243], a[176:179], v[156:159]
  s_waitcnt lgkmcnt(0)
  buffer_store_dwordx4 v[24:27], v229, s[36:39], s66 offen offset:2048 sc1
  v_exp_f32 v143, v143
  v_mfma_f32_16x16x32_bf16 v[128:131], a[192:195], a[128:131], v[160:163]
  ds_read_b128 a[240:243], v192 offset:45056
  v_cvt_pk_bf16_f32 v13, v142, v143
  v_exp_f32 v144, v144
  v_mfma_f32_16x16x32_bf16 v[128:131], a[196:199], a[132:135], v[128:131]
  v_exp_f32 v145, v145
  v_mfma_f32_16x16x32_bf16 v[128:131], a[200:203], a[136:139], v[128:131]
  ds_read_b128 a[244:247], v193 offset:45056
  v_cvt_pk_bf16_f32 v2, v144, v145
  v_exp_f32 v146, v146
  v_mfma_f32_16x16x32_bf16 v[128:131], a[204:207], a[140:143], v[128:131]
  v_exp_f32 v147, v147
  v_mfma_f32_16x16x32_bf16 v[132:135], a[204:207], a[156:159], v[164:167]
  ds_read_b128 a[248:251], v194 offset:45056
  v_cvt_pk_bf16_f32 v3, v146, v147
  v_exp_f32 v148, v148
  v_mfma_f32_16x16x32_bf16 v[132:135], a[200:203], a[152:155], v[132:135]
  v_exp_f32 v149, v149
  v_mfma_f32_16x16x32_bf16 v[132:135], a[196:199], a[148:151], v[132:135]
  ds_read_b128 a[252:255], v195 offset:45056
  v_cvt_pk_bf16_f32 v6, v148, v149
  v_exp_f32 v150, v150
  v_mfma_f32_16x16x32_bf16 v[132:135], a[192:195], a[144:147], v[132:135]
  v_exp_f32 v151, v151
  v_mfma_f32_16x16x32_bf16 v[136:139], a[192:195], a[160:163], v[168:171]
  v_cvt_pk_bf16_f32 v7, v150, v151
  v_exp_f32 v152, v152
  v_mfma_f32_16x16x32_bf16 v[136:139], a[196:199], a[164:167], v[136:139]
  buffer_store_dwordx4 v[28:31], v229, s[36:39], s66 offen offset:3072 sc1
  v_exp_f32 v153, v153
  v_mfma_f32_16x16x32_bf16 v[136:139], a[200:203], a[168:171], v[136:139]
  v_cvt_pk_bf16_f32 v10, v152, v153
  v_exp_f32 v154, v154
  v_mfma_f32_16x16x32_bf16 v[136:139], a[204:207], a[172:175], v[136:139]
  v_exp_f32 v155, v155
  v_mfma_f32_16x16x32_bf16 v[140:143], a[204:207], a[188:191], v[172:175]
  v_cvt_pk_bf16_f32 v11, v154, v155
  v_exp_f32 v156, v156
  v_mfma_f32_16x16x32_bf16 v[140:143], a[200:203], a[184:187], v[140:143]
  v_exp_f32 v157, v157
  v_mfma_f32_16x16x32_bf16 v[140:143], a[196:199], a[180:183], v[140:143]
  v_cvt_pk_bf16_f32 v14, v156, v157
  v_exp_f32 v158, v158
  v_mfma_f32_16x16x32_bf16 v[140:143], a[192:195], a[176:179], v[140:143]
  s_waitcnt lgkmcnt(0)
  v_exp_f32 v159, v159
  v_mfma_f32_16x16x32_bf16 v[144:147], a[240:243], a[128:131], v[160:163]
  ds_read_b128 a[192:195], v192 offset:49152
  v_cvt_pk_bf16_f32 v15, v158, v159
  v_exp_f32 v128, v128
  v_mfma_f32_16x16x32_bf16 v[144:147], a[244:247], a[132:135], v[144:147]
  v_exp_f32 v129, v129
  v_mfma_f32_16x16x32_bf16 v[144:147], a[248:251], a[136:139], v[144:147]
  ds_read_b128 a[196:199], v193 offset:49152
  v_cvt_pk_bf16_f32 v16, v128, v129
  v_exp_f32 v130, v130
  v_mfma_f32_16x16x32_bf16 v[144:147], a[252:255], a[140:143], v[144:147]
  v_exp_f32 v131, v131
  v_mfma_f32_16x16x32_bf16 v[148:151], a[252:255], a[156:159], v[164:167]
  ds_read_b128 a[200:203], v194 offset:49152
  v_cvt_pk_bf16_f32 v17, v130, v131
  v_exp_f32 v132, v132
  v_mfma_f32_16x16x32_bf16 v[148:151], a[248:251], a[152:155], v[148:151]
  v_exp_f32 v133, v133
  v_mfma_f32_16x16x32_bf16 v[148:151], a[244:247], a[148:151], v[148:151]
  ds_read_b128 a[204:207], v195 offset:49152
  v_cvt_pk_bf16_f32 v20, v132, v133
  v_exp_f32 v134, v134
  v_mfma_f32_16x16x32_bf16 v[148:151], a[240:243], a[144:147], v[148:151]
  v_exp_f32 v135, v135
  v_mfma_f32_16x16x32_bf16 v[152:155], a[240:243], a[160:163], v[168:171]
  v_cvt_pk_bf16_f32 v21, v134, v135
  v_exp_f32 v136, v136
  v_mfma_f32_16x16x32_bf16 v[152:155], a[244:247], a[164:167], v[152:155]
  buffer_store_dwordx4 v[48:51], v229, s[36:39], s67 offen sc1
  v_exp_f32 v137, v137
  v_mfma_f32_16x16x32_bf16 v[152:155], a[248:251], a[168:171], v[152:155]
  v_cvt_pk_bf16_f32 v24, v136, v137
  v_exp_f32 v138, v138
  v_mfma_f32_16x16x32_bf16 v[152:155], a[252:255], a[172:175], v[152:155]
  v_exp_f32 v139, v139
  v_mfma_f32_16x16x32_bf16 v[156:159], a[252:255], a[188:191], v[172:175]
  v_cvt_pk_bf16_f32 v25, v138, v139
  v_exp_f32 v140, v140
  v_mfma_f32_16x16x32_bf16 v[156:159], a[248:251], a[184:187], v[156:159]
  v_exp_f32 v141, v141
  v_mfma_f32_16x16x32_bf16 v[156:159], a[244:247], a[180:183], v[156:159]
  v_cvt_pk_bf16_f32 v28, v140, v141
  v_exp_f32 v142, v142
  v_mfma_f32_16x16x32_bf16 v[156:159], a[240:243], a[176:179], v[156:159]
  s_waitcnt lgkmcnt(0)
  v_exp_f32 v143, v143
  v_mfma_f32_16x16x32_bf16 v[128:131], a[192:195], a[128:131], v[160:163]
  ds_read_b128 a[240:243], v192 offset:53248
  v_cvt_pk_bf16_f32 v29, v142, v143
  v_exp_f32 v144, v144
  v_mfma_f32_16x16x32_bf16 v[128:131], a[196:199], a[132:135], v[128:131]
  v_exp_f32 v145, v145
  v_mfma_f32_16x16x32_bf16 v[128:131], a[200:203], a[136:139], v[128:131]
  ds_read_b128 a[244:247], v193 offset:53248
  v_cvt_pk_bf16_f32 v18, v144, v145
  v_exp_f32 v146, v146
  v_mfma_f32_16x16x32_bf16 v[128:131], a[204:207], a[140:143], v[128:131]
  v_exp_f32 v147, v147
  v_mfma_f32_16x16x32_bf16 v[132:135], a[204:207], a[156:159], v[164:167]
  ds_read_b128 a[248:251], v194 offset:53248
  v_cvt_pk_bf16_f32 v19, v146, v147
  v_exp_f32 v148, v148
  v_mfma_f32_16x16x32_bf16 v[132:135], a[200:203], a[152:155], v[132:135]
  v_exp_f32 v149, v149
  v_mfma_f32_16x16x32_bf16 v[132:135], a[196:199], a[148:151], v[132:135]
  ds_read_b128 a[252:255], v195 offset:53248
  v_cvt_pk_bf16_f32 v22, v148, v149
  v_exp_f32 v150, v150
  v_mfma_f32_16x16x32_bf16 v[132:135], a[192:195], a[144:147], v[132:135]
  v_exp_f32 v151, v151
  v_mfma_f32_16x16x32_bf16 v[136:139], a[192:195], a[160:163], v[168:171]
  v_cvt_pk_bf16_f32 v23, v150, v151
  v_exp_f32 v152, v152
  v_mfma_f32_16x16x32_bf16 v[136:139], a[196:199], a[164:167], v[136:139]
  buffer_store_dwordx4 v[52:55], v229, s[36:39], s67 offen offset:1024 sc1
  v_exp_f32 v153, v153
  v_mfma_f32_16x16x32_bf16 v[136:139], a[200:203], a[168:171], v[136:139]
  v_cvt_pk_bf16_f32 v26, v152, v153
  v_exp_f32 v154, v154
  v_mfma_f32_16x16x32_bf16 v[136:139], a[204:207], a[172:175], v[136:139]
  v_exp_f32 v155, v155
  v_mfma_f32_16x16x32_bf16 v[140:143], a[204:207], a[188:191], v[172:175]
  v_cvt_pk_bf16_f32 v27, v154, v155
  v_exp_f32 v156, v156
  v_mfma_f32_16x16x32_bf16 v[140:143], a[200:203], a[184:187], v[140:143]
  v_exp_f32 v157, v157
  v_mfma_f32_16x16x32_bf16 v[140:143], a[196:199], a[180:183], v[140:143]
  v_cvt_pk_bf16_f32 v30, v156, v157
  v_exp_f32 v158, v158
  v_mfma_f32_16x16x32_bf16 v[140:143], a[192:195], a[176:179], v[140:143]
  s_waitcnt lgkmcnt(0)
  v_exp_f32 v159, v159
  v_mfma_f32_16x16x32_bf16 v[144:147], a[240:243], a[128:131], v[160:163]
  ds_read_b128 a[192:195], v192 offset:57344
  v_cvt_pk_bf16_f32 v31, v158, v159
  v_exp_f32 v128, v128
  v_mfma_f32_16x16x32_bf16 v[144:147], a[244:247], a[132:135], v[144:147]
  v_exp_f32 v129, v129
  v_mfma_f32_16x16x32_bf16 v[144:147], a[248:251], a[136:139], v[144:147]
  ds_read_b128 a[196:199], v193 offset:57344
  v_cvt_pk_bf16_f32 v32, v128, v129
  v_exp_f32 v130, v130
  v_mfma_f32_16x16x32_bf16 v[144:147], a[252:255], a[140:143], v[144:147]
  v_exp_f32 v131, v131
  v_mfma_f32_16x16x32_bf16 v[148:151], a[252:255], a[156:159], v[164:167]
  ds_read_b128 a[200:203], v194 offset:57344
  v_cvt_pk_bf16_f32 v33, v130, v131
  v_exp_f32 v132, v132
  v_mfma_f32_16x16x32_bf16 v[148:151], a[248:251], a[152:155], v[148:151]
  v_exp_f32 v133, v133
  v_mfma_f32_16x16x32_bf16 v[148:151], a[244:247], a[148:151], v[148:151]
  ds_read_b128 a[204:207], v195 offset:57344
  v_cvt_pk_bf16_f32 v36, v132, v133
  v_exp_f32 v134, v134
  v_mfma_f32_16x16x32_bf16 v[148:151], a[240:243], a[144:147], v[148:151]
  v_exp_f32 v135, v135
  v_mfma_f32_16x16x32_bf16 v[152:155], a[240:243], a[160:163], v[168:171]
  v_cvt_pk_bf16_f32 v37, v134, v135
  v_exp_f32 v136, v136
  v_mfma_f32_16x16x32_bf16 v[152:155], a[244:247], a[164:167], v[152:155]
  buffer_store_dwordx4 v[56:59], v229, s[36:39], s67 offen offset:2048 sc1
  v_exp_f32 v137, v137
  v_mfma_f32_16x16x32_bf16 v[152:155], a[248:251], a[168:171], v[152:155]
  v_cvt_pk_bf16_f32 v40, v136, v137
  v_exp_f32 v138, v138
  v_mfma_f32_16x16x32_bf16 v[152:155], a[252:255], a[172:175], v[152:155]
  v_exp_f32 v139, v139
  v_mfma_f32_16x16x32_bf16 v[156:159], a[252:255], a[188:191], v[172:175]
  v_cvt_pk_bf16_f32 v41, v138, v139
  v_exp_f32 v140, v140
  v_mfma_f32_16x16x32_bf16 v[156:159], a[248:251], a[184:187], v[156:159]
  v_exp_f32 v141, v141
  v_mfma_f32_16x16x32_bf16 v[156:159], a[244:247], a[180:183], v[156:159]
  v_cvt_pk_bf16_f32 v44, v140, v141
  v_exp_f32 v142, v142
  v_mfma_f32_16x16x32_bf16 v[156:159], a[240:243], a[176:179], v[156:159]
  s_waitcnt lgkmcnt(0)
  v_exp_f32 v143, v143
  v_mfma_f32_16x16x32_bf16 v[128:131], a[192:195], a[128:131], v[160:163]
  ds_read_b128 a[240:243], v192 offset:61440
  v_cvt_pk_bf16_f32 v45, v142, v143
  v_exp_f32 v144, v144
  v_mfma_f32_16x16x32_bf16 v[128:131], a[196:199], a[132:135], v[128:131]
  v_exp_f32 v145, v145
  v_mfma_f32_16x16x32_bf16 v[128:131], a[200:203], a[136:139], v[128:131]
  ds_read_b128 a[244:247], v193 offset:61440
  v_cvt_pk_bf16_f32 v34, v144, v145
  v_exp_f32 v146, v146
  v_mfma_f32_16x16x32_bf16 v[128:131], a[204:207], a[140:143], v[128:131]
  v_exp_f32 v147, v147
  v_mfma_f32_16x16x32_bf16 v[132:135], a[204:207], a[156:159], v[164:167]
  ds_read_b128 a[248:251], v194 offset:61440
  v_cvt_pk_bf16_f32 v35, v146, v147
  v_exp_f32 v148, v148
  v_mfma_f32_16x16x32_bf16 v[132:135], a[200:203], a[152:155], v[132:135]
  v_exp_f32 v149, v149
  v_mfma_f32_16x16x32_bf16 v[132:135], a[196:199], a[148:151], v[132:135]
  ds_read_b128 a[252:255], v195 offset:61440
  v_cvt_pk_bf16_f32 v38, v148, v149
  v_exp_f32 v150, v150
  v_mfma_f32_16x16x32_bf16 v[132:135], a[192:195], a[144:147], v[132:135]
  v_exp_f32 v151, v151
  v_mfma_f32_16x16x32_bf16 v[136:139], a[192:195], a[160:163], v[168:171]
  v_cvt_pk_bf16_f32 v39, v150, v151
  v_exp_f32 v152, v152
  v_mfma_f32_16x16x32_bf16 v[136:139], a[196:199], a[164:167], v[136:139]
  buffer_store_dwordx4 v[60:63], v229, s[36:39], s67 offen offset:3072 sc1
  v_exp_f32 v153, v153
  v_mfma_f32_16x16x32_bf16 v[136:139], a[200:203], a[168:171], v[136:139]
  v_cvt_pk_bf16_f32 v42, v152, v153
  v_exp_f32 v154, v154
  v_mfma_f32_16x16x32_bf16 v[136:139], a[204:207], a[172:175], v[136:139]
  v_exp_f32 v155, v155
  v_mfma_f32_16x16x32_bf16 v[140:143], a[204:207], a[188:191], v[172:175]
  v_cvt_pk_bf16_f32 v43, v154, v155
  v_exp_f32 v156, v156
  v_mfma_f32_16x16x32_bf16 v[140:143], a[200:203], a[184:187], v[140:143]
  v_exp_f32 v157, v157
  v_mfma_f32_16x16x32_bf16 v[140:143], a[196:199], a[180:183], v[140:143]
  v_cvt_pk_bf16_f32 v46, v156, v157
  v_exp_f32 v158, v158
  v_mfma_f32_16x16x32_bf16 v[140:143], a[192:195], a[176:179], v[140:143]
  s_waitcnt lgkmcnt(0)
  v_exp_f32 v159, v159
  s_waitcnt vmcnt(6)
  s_waitcnt lgkmcnt(0)
  s_barrier
  v_mfma_f32_16x16x32_bf16 v[144:147], a[240:243], a[128:131], v[160:163]
  ds_read_b128 a[192:195], v192 offset:0
  v_cvt_pk_bf16_f32 v47, v158, v159
  v_exp_f32 v128, v128
  v_mfma_f32_16x16x32_bf16 v[144:147], a[244:247], a[132:135], v[144:147]
  s_add_u32 m0, s53, 32768
  v_exp_f32 v129, v129
  v_mfma_f32_16x16x32_bf16 v[144:147], a[248:251], a[136:139], v[144:147]
  ds_read_b128 a[196:199], v193 offset:0
  v_cvt_pk_bf16_f32 v48, v128, v129
  v_exp_f32 v130, v130
  v_mfma_f32_16x16x32_bf16 v[144:147], a[252:255], a[140:143], v[144:147]
  s_add_u32 s48, s52, 65536
  v_exp_f32 v131, v131
  v_mfma_f32_16x16x32_bf16 v[148:151], a[252:255], a[156:159], v[164:167]
  buffer_load_dwordx4 v200, s[12:15], s48 offen lds
  v_cvt_pk_bf16_f32 v49, v130, v131
  v_exp_f32 v132, v132
  v_mfma_f32_16x16x32_bf16 v[148:151], a[248:251], a[152:155], v[148:151]
  v_exp_f32 v133, v133
  v_mfma_f32_16x16x32_bf16 v[148:151], a[244:247], a[148:151], v[148:151]
  ds_read_b128 a[200:203], v194 offset:0
  v_cvt_pk_bf16_f32 v52, v132, v133
  v_exp_f32 v134, v134
  v_mfma_f32_16x16x32_bf16 v[148:151], a[240:243], a[144:147], v[148:151]
  v_exp_f32 v135, v135
  v_mfma_f32_16x16x32_bf16 v[152:155], a[240:243], a[160:163], v[168:171]
  ds_read_b128 a[204:207], v195 offset:0
  v_cvt_pk_bf16_f32 v53, v134, v135
  v_exp_f32 v136, v136
  v_mfma_f32_16x16x32_bf16 v[152:155], a[244:247], a[164:167], v[152:155]
  v_exp_f32 v137, v137
  v_mfma_f32_16x16x32_bf16 v[152:155], a[248:251], a[168:171], v[152:155]
  ds_read_b64_tr_b16 a[208:209], v196 offset:0
  v_cvt_pk_bf16_f32 v56, v136, v137
  v_exp_f32 v138, v138
  v_mfma_f32_16x16x32_bf16 v[152:155], a[252:255], a[172:175], v[152:155]
  v_exp_f32 v139, v139
  v_mfma_f32_16x16x32_bf16 v[156:159], a[252:255], a[188:191], v[172:175]
  ds_read_b64_tr_b16 a[210:211], v196 offset:4096
  v_cvt_pk_bf16_f32 v57, v138, v139
  v_exp_f32 v140, v140
  v_mfma_f32_16x16x32_bf16 v[156:159], a[248:251], a[184:187], v[156:159]
  v_exp_f32 v141, v141
  v_mfma_f32_16x16x32_bf16 v[156:159], a[244:247], a[180:183], v[156:159]
  ds_read_b64_tr_b16 a[212:213], v196 offset:8192
  v_cvt_pk_bf16_f32 v60, v140, v141
  v_exp_f32 v142, v142
  v_mfma_f32_16x16x32_bf16 v[156:159], a[240:243], a[176:179], v[156:159]
  s_waitcnt lgkmcnt(3)
  v_exp_f32 v143, v143
  v_mfma_f32_16x16x32_bf16 v[128:131], a[192:195], a[128:131], v[160:163]
  buffer_load_dwordx4 v201, s[12:15], s48 offen offset:1024 lds
  v_cvt_pk_bf16_f32 v61, v142, v143
  v_exp_f32 v144, v144
  v_mfma_f32_16x16x32_bf16 v[128:131], a[196:199], a[132:135], v[128:131]
  v_exp_f32 v145, v145
  v_mfma_f32_16x16x32_bf16 v[128:131], a[200:203], a[136:139], v[128:131]
  ds_read_b64_tr_b16 a[214:215], v196 offset:12288
  v_cvt_pk_bf16_f32 v50, v144, v145
  v_exp_f32 v146, v146
  v_mfma_f32_16x16x32_bf16 v[128:131], a[204:207], a[140:143], v[128:131]
  v_exp_f32 v147, v147
  v_mfma_f32_16x16x32_bf16 v[132:135], a[204:207], a[156:159], v[164:167]
  ds_read_b64_tr_b16 a[216:217], v196 offset:16384
  v_cvt_pk_bf16_f32 v51, v146, v147
  v_exp_f32 v148, v148
  v_mfma_f32_16x16x32_bf16 v[132:135], a[200:203], a[152:155], v[132:135]
  v_exp_f32 v149, v149
  v_mfma_f32_16x16x32_bf16 v[132:135], a[196:199], a[148:151], v[132:135]
  ds_read_b64_tr_b16 a[218:219], v196 offset:20480
  v_cvt_pk_bf16_f32 v54, v148, v149
  v_exp_f32 v150, v150
  v_mfma_f32_16x16x32_bf16 v[132:135], a[192:195], a[144:147], v[132:135]
  v_exp_f32 v151, v151
  v_mfma_f32_16x16x32_bf16 v[136:139], a[192:195], a[160:163], v[168:171]
  ds_read_b64_tr_b16 a[220:221], v196 offset:24576
  v_cvt_pk_bf16_f32 v55, v150, v151
  v_exp_f32 v152, v152
  v_mfma_f32_16x16x32_bf16 v[136:139], a[196:199], a[164:167], v[136:139]
  v_exp_f32 v153, v153
  v_mfma_f32_16x16x32_bf16 v[136:139], a[200:203], a[168:171], v[136:139]
  ds_read_b64_tr_b16 a[222:223], v196 offset:28672
  v_cvt_pk_bf16_f32 v58, v152, v153
  v_exp_f32 v154, v154
  v_mfma_f32_16x16x32_bf16 v[136:139], a[204:207], a[172:175], v[136:139]
  v_exp_f32 v155, v155
  v_mfma_f32_16x16x32_bf16 v[140:143], a[204:207], a[188:191], v[172:175]
  buffer_load_dwordx4 v202, s[12:15], s48 offen offset:2048 lds
  v_cvt_pk_bf16_f32 v59, v154, v155
  v_exp_f32 v156, v156
  v_mfma_f32_16x16x32_bf16 v[140:143], a[200:203], a[184:187], v[140:143]
  v_exp_f32 v157, v157
  v_mfma_f32_16x16x32_bf16 v[140:143], a[196:199], a[180:183], v[140:143]
  buffer_store_dwordx4 v[84:87], v229, s[36:39], s64 offen offset:1024 sc1
  v_cvt_pk_bf16_f32 v62, v156, v157
  v_exp_f32 v158, v158
  v_mfma_f32_16x16x32_bf16 v[140:143], a[192:195], a[176:179], v[140:143]
  s_waitcnt lgkmcnt(0)
  v_exp_f32 v159, v159
  v_mfma_f32_16x16x32_bf16 a[0:3], a[208:211], v[0:3], 0
  ds_read_b128 a[192:195], v192 offset:4096
  v_cvt_pk_bf16_f32 v63, v158, v159
  v_mfma_f32_16x16x32_bf16 a[0:3], a[212:215], v[16:19], a[0:3]
  v_exp_f32 v128, v128
  v_mfma_f32_16x16x32_bf16 a[0:3], a[216:219], v[32:35], a[0:3]
  ds_read_b128 a[196:199], v193 offset:4096
  v_mfma_f32_16x16x32_bf16 a[0:3], a[220:223], v[48:51], a[0:3]
  v_exp_f32 v129, v129
  v_mfma_f32_16x16x32_bf16 a[4:7], a[220:223], v[52:55], 0
  buffer_load_dwordx4 v203, s[12:15], s48 offen offset:3072 lds
  v_mfma_f32_16x16x32_bf16 a[4:7], a[216:219], v[36:39], a[4:7]
  v_exp_f32 v130, v130
  v_mfma_f32_16x16x32_bf16 a[4:7], a[212:215], v[20:23], a[4:7]
  ds_read_b128 a[200:203], v194 offset:4096
  v_cvt_pk_bf16_f32 v64, v128, v129
  v_mfma_f32_16x16x32_bf16 a[4:7], a[208:211], v[4:7], a[4:7]
  v_exp_f32 v131, v131
  v_mfma_f32_16x16x32_bf16 a[8:11], a[208:211], v[8:11], 0
  ds_read_b128 a[204:207], v195 offset:4096
  v_cvt_pk_bf16_f32 v65, v130, v131
  v_mfma_f32_16x16x32_bf16 a[8:11], a[212:215], v[24:27], a[8:11]
  v_exp_f32 v132, v132
  v_mfma_f32_16x16x32_bf16 a[8:11], a[216:219], v[40:43], a[8:11]
  ds_read_b64_tr_b16 a[224:225], v197 offset:0
  v_mfma_f32_16x16x32_bf16 a[8:11], a[220:223], v[56:59], a[8:11]
  v_exp_f32 v133, v133
  v_mfma_f32_16x16x32_bf16 a[12:15], a[220:223], v[60:63], 0
  ds_read_b64_tr_b16 a[226:227], v197 offset:4096
  v_cvt_pk_bf16_f32 v68, v132, v133
  v_mfma_f32_16x16x32_bf16 a[12:15], a[216:219], v[44:47], a[12:15]
  s_add_u32 m0, s53, 36864
  v_exp_f32 v134, v134
  v_mfma_f32_16x16x32_bf16 a[12:15], a[212:215], v[28:31], a[12:15]
  ds_read_b64_tr_b16 a[228:229], v197 offset:8192
  v_mfma_f32_16x16x32_bf16 a[12:15], a[208:211], v[12:15], a[12:15]
  s_waitcnt lgkmcnt(3)
  s_add_u32 s48, s52, 69632
  v_exp_f32 v135, v135
  v_mfma_f32_16x16x32_bf16 v[144:147], a[192:195], a[128:131], v[160:163]
  buffer_load_dwordx4 v200, s[12:15], s48 offen lds
  v_mfma_f32_16x16x32_bf16 v[144:147], a[196:199], a[132:135], v[144:147]
  v_exp_f32 v136, v136
  v_mfma_f32_16x16x32_bf16 v[144:147], a[200:203], a[136:139], v[144:147]
  ds_read_b64_tr_b16 a[230:231], v197 offset:12288
  v_cvt_pk_bf16_f32 v69, v134, v135
  v_mfma_f32_16x16x32_bf16 v[144:147], a[204:207], a[140:143], v[144:147]
  v_exp_f32 v137, v137
  v_mfma_f32_16x16x32_bf16 v[148:151], a[204:207], a[156:159], v[164:167]
  ds_read_b64_tr_b16 a[232:233], v197 offset:16384
  v_cvt_pk_bf16_f32 v72, v136, v137
  v_mfma_f32_16x16x32_bf16 v[148:151], a[200:203], a[152:155], v[148:151]
  v_exp_f32 v138, v138
  v_mfma_f32_16x16x32_bf16 v[148:151], a[196:199], a[148:151], v[148:151]
  ds_read_b64_tr_b16 a[234:235], v197 offset:20480
  v_mfma_f32_16x16x32_bf16 v[148:151], a[192:195], a[144:147], v[148:151]
  v_exp_f32 v139, v139
  v_mfma_f32_16x16x32_bf16 v[152:155], a[192:195], a[160:163], v[168:171]
  ds_read_b64_tr_b16 a[236:237], v197 offset:24576
  v_cvt_pk_bf16_f32 v73, v138, v139
  v_mfma_f32_16x16x32_bf16 v[152:155], a[196:199], a[164:167], v[152:155]
  v_exp_f32 v140, v140
  v_mfma_f32_16x16x32_bf16 v[152:155], a[200:203], a[168:171], v[152:155]
  ds_read_b64_tr_b16 a[238:239], v197 offset:28672
  v_mfma_f32_16x16x32_bf16 v[152:155], a[204:207], a[172:175], v[152:155]
  v_exp_f32 v141, v141
  v_mfma_f32_16x16x32_bf16 v[156:159], a[204:207], a[188:191], v[172:175]
  buffer_load_dwordx4 v201, s[12:15], s48 offen offset:1024 lds
  v_mfma_f32_16x16x32_bf16 v[156:159], a[200:203], a[184:187], v[156:159]
  v_exp_f32 v142, v142
  v_mfma_f32_16x16x32_bf16 v[156:159], a[196:199], a[180:183], v[156:159]
  buffer_store_dwordx4 v[88:91], v229, s[36:39], s64 offen offset:2048 sc1
  v_cvt_pk_bf16_f32 v76, v140, v141
  v_mfma_f32_16x16x32_bf16 v[156:159], a[192:195], a[176:179], v[156:159]
  s_waitcnt lgkmcnt(0)
  v_exp_f32 v143, v143
  v_smfmac_f32_16x16x64_bf16 v[176:179], v[212:215], v[0:7], v184
  buffer_load_dwordx4 v202, s[12:15], s48 offen offset:2048 lds
  v_mfma_f32_16x16x32_bf16 a[16:19], a[224:227], v[0:3], 0
  ds_read_b128 a[192:195], v192 offset:8192
  v_cvt_pk_bf16_f32 v77, v142, v143
  v_mfma_f32_16x16x32_bf16 a[16:19], a[228:231], v[16:19], a[16:19]
  v_exp_f32 v144, v144
  v_mfma_f32_16x16x32_bf16 a[16:19], a[232:235], v[32:35], a[16:19]
  ds_read_b128 a[196:199], v193 offset:8192
  v_mfma_f32_16x16x32_bf16 a[16:19], a[236:239], v[48:51], a[16:19]
  v_exp_f32 v145, v145
  v_mfma_f32_16x16x32_bf16 a[20:23], a[236:239], v[52:55], 0
  buffer_load_dwordx4 v203, s[12:15], s48 offen offset:3072 lds
  v_mfma_f32_16x16x32_bf16 a[20:23], a[232:235], v[36:39], a[20:23]
  v_exp_f32 v146, v146
  v_mfma_f32_16x16x32_bf16 a[20:23], a[228:231], v[20:23], a[20:23]
  ds_read_b128 a[200:203], v194 offset:8192
  v_cvt_pk_bf16_f32 v66, v144, v145
  v_mfma_f32_16x16x32_bf16 a[20:23], a[224:227], v[4:7], a[20:23]
  v_exp_f32 v147, v147
  v_mfma_f32_16x16x32_bf16 a[24:27], a[224:227], v[8:11], 0
  ds_read_b128 a[204:207], v195 offset:8192
  v_cvt_pk_bf16_f32 v67, v146, v147
  v_mfma_f32_16x16x32_bf16 a[24:27], a[228:231], v[24:27], a[24:27]
  v_exp_f32 v148, v148
  v_mfma_f32_16x16x32_bf16 a[24:27], a[232:235], v[40:43], a[24:27]
  ds_read_b64_tr_b16 a[208:209], v198 offset:0
  v_mfma_f32_16x16x32_bf16 a[24:27], a[236:239], v[56:59], a[24:27]
  v_exp_f32 v149, v149
  v_mfma_f32_16x16x32_bf16 a[28:31], a[236:239], v[60:63], 0
  ds_read_b64_tr_b16 a[210:211], v198 offset:4096
  v_cvt_pk_bf16_f32 v70, v148, v149
  v_mfma_f32_16x16x32_bf16 a[28:31], a[232:235], v[44:47], a[28:31]
  s_add_u32 m0, s53, 131072
  v_exp_f32 v150, v150
  v_mfma_f32_16x16x32_bf16 a[28:31], a[228:231], v[28:31], a[28:31]
  ds_read_b64_tr_b16 a[212:213], v198 offset:8192
  v_mfma_f32_16x16x32_bf16 a[28:31], a[224:227], v[12:15], a[28:31]
  s_waitcnt lgkmcnt(3)
  s_add_u32 s48, s52, 32768
  v_exp_f32 v151, v151
  v_mfma_f32_16x16x32_bf16 v[128:131], a[192:195], a[128:131], v[160:163]
  buffer_load_dwordx4 v204, s[16:19], s48 offen lds
  v_mfma_f32_16x16x32_bf16 v[128:131], a[196:199], a[132:135], v[128:131]
  v_exp_f32 v152, v152
  v_mfma_f32_16x16x32_bf16 v[128:131], a[200:203], a[136:139], v[128:131]
  ds_read_b64_tr_b16 a[214:215], v198 offset:12288
  v_cvt_pk_bf16_f32 v71, v150, v151
  v_mfma_f32_16x16x32_bf16 v[128:131], a[204:207], a[140:143], v[128:131]
L_hop6:
  s_cbranch_execz L_hop10
  v_exp_f32 v153, v153
  v_mfma_f32_16x16x32_bf16 v[132:135], a[204:207], a[156:159], v[164:167]
  ds_read_b64_tr_b16 a[216:217], v198 offset:16384
  v_cvt_pk_bf16_f32 v74, v152, v153
  v_mfma_f32_16x16x32_bf16 v[132:135], a[200:203], a[152:155], v[132:135]
  v_exp_f32 v154, v154
  v_mfma_f32_16x16x32_bf16 v[132:135], a[196:199], a[148:151], v[132:135]
  ds_read_b64_tr_b16 a[218:219], v198 offset:20480
  v_mfma_f32_16x16x32_bf16 v[132:135], a[192:195], a[144:147], v[132:135]
  v_exp_f32 v155, v155
  v_mfma_f32_16x16x32_bf16 v[136:139], a[192:195], a[160:163], v[168:171]
  ds_read_b64_tr_b16 a[220:221], v198 offset:24576
  v_cvt_pk_bf16_f32 v75, v154, v155
  v_mfma_f32_16x16x32_bf16 v[136:139], a[196:199], a[164:167], v[136:139]
  v_exp_f32 v156, v156
  v_mfma_f32_16x16x32_bf16 v[136:139], a[200:203], a[168:171], v[136:139]
  ds_read_b64_tr_b16 a[222:223], v198 offset:28672
  v_mfma_f32_16x16x32_bf16 v[136:139], a[204:207], a[172:175], v[136:139]
  v_exp_f32 v157, v157
  v_mfma_f32_16x16x32_bf16 v[140:143], a[204:207], a[188:191], v[172:175]
  buffer_load_dwordx4 v205, s[16:19], s48 offen offset:1024 lds
  v_mfma_f32_16x16x32_bf16 v[140:143], a[200:203], a[184:187], v[140:143]
  v_exp_f32 v158, v158
  v_mfma_f32_16x16x32_bf16 v[140:143], a[196:199], a[180:183], v[140:143]
  buffer_store_dwordx4 v[92:95], v229, s[36:39], s64 offen offset:3072 sc1
  v_cvt_pk_bf16_f32 v78, v156, v157
  v_mfma_f32_16x16x32_bf16 v[140:143], a[192:195], a[176:179], v[140:143]
  s_waitcnt lgkmcnt(0)
  v_exp_f32 v159, v159
  v_smfmac_f32_16x16x64_bf16 v[176:179], v[212:215], v[16:23], v184
  buffer_load_dwordx4 v204, s[16:19], s48 offen offset:2048 lds
  v_mfma_f32_16x16x32_bf16 a[32:35], a[208:211], v[0:3], 0
  ds_read_b128 a[192:195], v192 offset:12288
  v_cvt_pk_bf16_f32 v79, v158, v159
  v_mfma_f32_16x16x32_bf16 a[32:35], a[212:215], v[16:19], a[32:35]
  v_exp_f32 v128, v128
  v_mfma_f32_16x16x32_bf16 a[32:35], a[216:219], v[32:35], a[32:35]
  ds_read_b128 a[196:199], v193 offset:12288
  v_mfma_f32_16x16x32_bf16 a[32:35], a[220:223], v[48:51], a[32:35]
  v_exp_f32 v129, v129
  v_mfma_f32_16x16x32_bf16 a[36:39], a[220:223], v[52:55], 0
  buffer_load_dwordx4 v205, s[16:19], s48 offen offset:3072 lds
  v_mfma_f32_16x16x32_bf16 a[36:39], a[216:219], v[36:39], a[36:39]
  v_exp_f32 v130, v130
  v_mfma_f32_16x16x32_bf16 a[36:39], a[212:215], v[20:23], a[36:39]
  ds_read_b128 a[200:203], v194 offset:12288
  v_cvt_pk_bf16_f32 v80, v128, v129
  v_mfma_f32_16x16x32_bf16 a[36:39], a[208:211], v[4:7], a[36:39]
  v_exp_f32 v131, v131
  v_mfma_f32_16x16x32_bf16 a[40:43], a[208:211], v[8:11], 0
  ds_read_b128 a[204:207], v195 offset:12288
  v_cvt_pk_bf16_f32 v81, v130, v131
  v_mfma_f32_16x16x32_bf16 a[40:43], a[212:215], v[24:27], a[40:43]
  v_exp_f32 v132, v132
  v_mfma_f32_16x16x32_bf16 a[40:43], a[216:219], v[40:43], a[40:43]
  ds_read_b64_tr_b16 a[224:225], v199 offset:0
  v_mfma_f32_16x16x32_bf16 a[40:43], a[220:223], v[56:59], a[40:43]
  v_exp_f32 v133, v133
  v_mfma_f32_16x16x32_bf16 a[44:47], a[220:223], v[60:63], 0
  ds_read_b64_tr_b16 a[226:227], v199 offset:4096
  v_cvt_pk_bf16_f32 v84, v132, v133
  v_mfma_f32_16x16x32_bf16 a[44:47], a[216:219], v[44:47], a[44:47]
  s_add_u32 m0, s53, 135168
  v_exp_f32 v134, v134
  v_mfma_f32_16x16x32_bf16 a[44:47], a[212:215], v[28:31], a[44:47]
  ds_read_b64_tr_b16 a[228:229], v199 offset:8192
  v_mfma_f32_16x16x32_bf16 a[44:47], a[208:211], v[12:15], a[44:47]
  s_waitcnt lgkmcnt(3)
  s_add_u32 s48, s52, 36864
  v_exp_f32 v135, v135
  v_mfma_f32_16x16x32_bf16 v[144:147], a[192:195], a[128:131], v[160:163]
  buffer_load_dwordx4 v204, s[16:19], s48 offen lds
  v_mfma_f32_16x16x32_bf16 v[144:147], a[196:199], a[132:135], v[144:147]
  v_exp_f32 v136, v136
  v_mfma_f32_16x16x32_bf16 v[144:147], a[200:203], a[136:139], v[144:147]
  ds_read_b64_tr_b16 a[230:231], v199 offset:12288
  v_cvt_pk_bf16_f32 v85, v134, v135
  v_mfma_f32_16x16x32_bf16 v[144:147], a[204:207], a[140:143], v[144:147]
  v_exp_f32 v137, v137
  v_mfma_f32_16x16x32_bf16 v[148:151], a[204:207], a[156:159], v[164:167]
  ds_read_b64_tr_b16 a[232:233], v199 offset:16384
  v_cvt_pk_bf16_f32 v88, v136, v137
  v_mfma_f32_16x16x32_bf16 v[148:151], a[200:203], a[152:155], v[148:151]
  v_exp_f32 v138, v138
  v_mfma_f32_16x16x32_bf16 v[148:151], a[196:199], a[148:151], v[148:151]
  ds_read_b64_tr_b16 a[234:235], v199 offset:20480
  v_mfma_f32_16x16x32_bf16 v[148:151], a[192:195], a[144:147], v[148:151]
  v_exp_f32 v139, v139
  v_mfma_f32_16x16x32_bf16 v[152:155], a[192:195], a[160:163], v[168:171]
  ds_read_b64_tr_b16 a[236:237], v199 offset:24576
  v_cvt_pk_bf16_f32 v89, v138, v139
  v_mfma_f32_16x16x32_bf16 v[152:155], a[196:199], a[164:167], v[152:155]
  v_exp_f32 v140, v140
  v_mfma_f32_16x16x32_bf16 v[152:155], a[200:203], a[168:171], v[152:155]
  ds_read_b64_tr_b16 a[238:239], v199 offset:28672
  v_mfma_f32_16x16x32_bf16 v[152:155], a[204:207], a[172:175], v[152:155]
  v_exp_f32 v141, v141
  v_mfma_f32_16x16x32_bf16 v[156:159], a[204:207], a[188:191], v[172:175]
  buffer_load_dwordx4 v205, s[16:19], s48 offen offset:1024 lds
  v_mfma_f32_16x16x32_bf16 v[156:159], a[200:203], a[184:187], v[156:159]
  v_exp_f32 v142, v142
  v_mfma_f32_16x16x32_bf16 v[156:159], a[196:199], a[180:183], v[156:159]
  buffer_store_dwordx4 v[112:115], v229, s[36:39], s65 offen sc1
  v_cvt_pk_bf16_f32 v92, v140, v141
  v_mfma_f32_16x16x32_bf16 v[156:159], a[192:195], a[176:179], v[156:159]
  s_waitcnt lgkmcnt(0)
  v_exp_f32 v143, v143
  v_smfmac_f32_16x16x64_bf16 v[176:179], v[212:215], v[32:39], v184
  buffer_load_dwordx4 v204, s[16:19], s48 offen offset:2048 lds
  v_mfma_f32_16x16x32_bf16 a[48:51], a[224:227], v[0:3], 0
  ds_read_b128 a[192:195], v192 offset:16384
  v_cvt_pk_bf16_f32 v93, v142, v143
  v_mfma_f32_16x16x32_bf16 a[48:51], a[228:231], v[16:19], a[48:51]
  v_exp_f32 v144, v144
  v_mfma_f32_16x16x32_bf16 a[48:51], a[232:235], v[32:35], a[48:51]
  ds_read_b128 a[196:199], v193 offset:16384
  v_mfma_f32_16x16x32_bf16 a[48:51], a[236:239], v[48:51], a[48:51]
  v_exp_f32 v145, v145
  v_mfma_f32_16x16x32_bf16 a[52:55], a[236:239], v[52:55], 0
  buffer_load_dwordx4 v205, s[16:19], s48 offen offset:3072 lds
  v_mfma_f32_16x16x32_bf16 a[52:55], a[232:235], v[36:39], a[52:55]
  v_exp_f32 v146, v146
  v_mfma_f32_16x16x32_bf16 a[52:55], a[228:231], v[20:23], a[52:55]
  ds_read_b128 a[200:203], v194 offset:16384
  v_cvt_pk_bf16_f32 v82, v144, v145
  v_mfma_f32_16x16x32_bf16 a[52:55], a[224:227], v[4:7], a[52:55]
  v_exp_f32 v147, v147
  v_mfma_f32_16x16x32_bf16 a[56:59], a[224:227], v[8:11], 0
  ds_read_b128 a[204:207], v195 offset:16384
  v_cvt_pk_bf16_f32 v83, v146, v147
  v_mfma_f32_16x16x32_bf16 a[56:59], a[228:231], v[24:27], a[56:59]
  v_exp_f32 v148, v148
  v_mfma_f32_16x16x32_bf16 a[56:59], a[232:235], v[40:43], a[56:59]
  ds_read_b64_tr_b16 a[208:209], v196 offset:512
  v_mfma_f32_16x16x32_bf16 a[56:59], a[236:239], v[56:59], a[56:59]
  v_exp_f32 v149, v149
  v_mfma_f32_16x16x32_bf16 a[60:63], a[236:239], v[60:63], 0
  ds_read_b64_tr_b16 a[210:211], v196 offset:4608
  v_cvt_pk_bf16_f32 v86, v148, v149
  v_mfma_f32_16x16x32_bf16 a[60:63], a[232:235], v[44:47], a[60:63]
  v_exp_f32 v150, v150
  v_mfma_f32_16x16x32_bf16 a[60:63], a[228:231], v[28:31], a[60:63]
  ds_read_b64_tr_b16 a[212:213], v196 offset:8704
  v_mfma_f32_16x16x32_bf16 a[60:63], a[224:227], v[12:15], a[60:63]
  s_waitcnt lgkmcnt(3)
  v_exp_f32 v151, v151
  v_mfma_f32_16x16x32_bf16 v[128:131], a[192:195], a[128:131], v[160:163]
  buffer_store_dwordx4 v[116:119], v229, s[36:39], s65 offen offset:1024 sc1
  v_mfma_f32_16x16x32_bf16 v[128:131], a[196:199], a[132:135], v[128:131]
  v_exp_f32 v152, v152
  v_mfma_f32_16x16x32_bf16 v[128:131], a[200:203], a[136:139], v[128:131]
  ds_read_b64_tr_b16 a[214:215], v196 offset:12800
  v_cvt_pk_bf16_f32 v87, v150, v151
  v_mfma_f32_16x16x32_bf16 v[128:131], a[204:207], a[140:143], v[128:131]
  v_exp_f32 v153, v153
  v_mfma_f32_16x16x32_bf16 v[132:135], a[204:207], a[156:159], v[164:167]
  ds_read_b64_tr_b16 a[216:217], v196 offset:16896
  v_cvt_pk_bf16_f32 v90, v152, v153
  v_mfma_f32_16x16x32_bf16 v[132:135], a[200:203], a[152:155], v[132:135]
  v_exp_f32 v154, v154
  v_mfma_f32_16x16x32_bf16 v[132:135], a[196:199], a[148:151], v[132:135]
  ds_read_b64_tr_b16 a[218:219], v196 offset:20992
  v_mfma_f32_16x16x32_bf16 v[132:135], a[192:195], a[144:147], v[132:135]
  v_exp_f32 v155, v155
  v_mfma_f32_16x16x32_bf16 v[136:139], a[192:195], a[160:163], v[168:171]
  ds_read_b64_tr_b16 a[220:221], v196 offset:25088
  v_cvt_pk_bf16_f32 v91, v154, v155
  v_mfma_f32_16x16x32_bf16 v[136:139], a[196:199], a[164:167], v[136:139]
  v_exp_f32 v156, v156
  v_mfma_f32_16x16x32_bf16 v[136:139], a[200:203], a[168:171], v[136:139]
  ds_read_b64_tr_b16 a[222:223], v196 offset:29184
  v_mfma_f32_16x16x32_bf16 v[136:139], a[204:207], a[172:175], v[136:139]
  v_exp_f32 v157, v157
  v_mfma_f32_16x16x32_bf16 v[140:143], a[204:207], a[188:191], v[172:175]
  v_mfma_f32_16x16x32_bf16 v[140:143], a[200:203], a[184:187], v[140:143]
  v_exp_f32 v158, v158
  v_mfma_f32_16x16x32_bf16 v[140:143], a[196:199], a[180:183], v[140:143]
  v_cvt_pk_bf16_f32 v94, v156, v157
  v_mfma_f32_16x16x32_bf16 v[140:143], a[192:195], a[176:179], v[140:143]
  s_waitcnt lgkmcnt(0)
  v_exp_f32 v159, v159
  v_smfmac_f32_16x16x64_bf16 v[176:179], v[212:215], v[48:55], v184
  buffer_store_dwordx4 v[120:123], v229, s[36:39], s65 offen offset:2048 sc1
  v_mfma_f32_16x16x32_bf16 a[64:67], a[208:211], v[0:3], 0
  ds_read_b128 a[192:195], v192 offset:20480
  v_cvt_pk_bf16_f32 v95, v158, v159
  v_mfma_f32_16x16x32_bf16 a[64:67], a[212:215], v[16:19], a[64:67]
  v_exp_f32 v128, v128
  v_mfma_f32_16x16x32_bf16 a[64:67], a[216:219], v[32:35], a[64:67]
  ds_read_b128 a[196:199], v193 offset:20480
  v_mfma_f32_16x16x32_bf16 a[64:67], a[220:223], v[48:51], a[64:67]
  v_exp_f32 v129, v129
  v_mfma_f32_16x16x32_bf16 a[68:71], a[220:223], v[52:55], 0
  v_mfma_f32_16x16x32_bf16 a[68:71], a[216:219], v[36:39], a[68:71]
  s_add_u32 s44, s52, s72
  v_exp_f32 v130, v130
  v_mfma_f32_16x16x32_bf16 a[68:71], a[212:215], v[20:23], a[68:71]
  ds_read_b128 a[200:203], v194 offset:20480
  v_cvt_pk_bf16_f32 v96, v128, v129
  v_mfma_f32_16x16x32_bf16 a[68:71], a[208:211], v[4:7], a[68:71]
  v_exp_f32 v131, v131
  v_mfma_f32_16x16x32_bf16 a[72:75], a[208:211], v[8:11], 0
  ds_read_b128 a[204:207], v195 offset:20480
  v_cvt_pk_bf16_f32 v97, v130, v131
  v_mfma_f32_16x16x32_bf16 a[72:75], a[212:215], v[24:27], a[72:75]
  v_exp_f32 v132, v132
  v_mfma_f32_16x16x32_bf16 a[72:75], a[216:219], v[40:43], a[72:75]
  ds_read_b64_tr_b16 a[224:225], v197 offset:512
  v_mfma_f32_16x16x32_bf16 a[72:75], a[220:223], v[56:59], a[72:75]
  v_exp_f32 v133, v133
  v_mfma_f32_16x16x32_bf16 a[76:79], a[220:223], v[60:63], 0
  ds_read_b64_tr_b16 a[226:227], v197 offset:4608
  v_cvt_pk_bf16_f32 v100, v132, v133
  v_mfma_f32_16x16x32_bf16 a[76:79], a[216:219], v[44:47], a[76:79]
  v_exp_f32 v134, v134
  v_mfma_f32_16x16x32_bf16 a[76:79], a[212:215], v[28:31], a[76:79]
  ds_read_b64_tr_b16 a[228:229], v197 offset:8704
  v_mfma_f32_16x16x32_bf16 a[76:79], a[208:211], v[12:15], a[76:79]
  s_waitcnt lgkmcnt(3)
  v_exp_f32 v135, v135
  v_mfma_f32_16x16x32_bf16 v[144:147], a[192:195], a[128:131], v[160:163]
  buffer_store_dwordx4 v[124:127], v229, s[36:39], s65 offen offset:3072 sc1
  v_mfma_f32_16x16x32_bf16 v[144:147], a[196:199], a[132:135], v[144:147]
  v_exp_f32 v136, v136
  v_mfma_f32_16x16x32_bf16 v[144:147], a[200:203], a[136:139], v[144:147]
  ds_read_b64_tr_b16 a[230:231], v197 offset:12800
  v_cvt_pk_bf16_f32 v101, v134, v135
  v_mfma_f32_16x16x32_bf16 v[144:147], a[204:207], a[140:143], v[144:147]
  v_exp_f32 v137, v137
  v_mfma_f32_16x16x32_bf16 v[148:151], a[204:207], a[156:159], v[164:167]
  ds_read_b64_tr_b16 a[232:233], v197 offset:16896
  v_cvt_pk_bf16_f32 v104, v136, v137
  v_mfma_f32_16x16x32_bf16 v[148:151], a[200:203], a[152:155], v[148:151]
  v_exp_f32 v138, v138
  v_mfma_f32_16x16x32_bf16 v[148:151], a[196:199], a[148:151], v[148:151]
  ds_read_b64_tr_b16 a[234:235], v197 offset:20992
  v_mfma_f32_16x16x32_bf16 v[148:151], a[192:195], a[144:147], v[148:151]
  v_exp_f32 v139, v139
  v_mfma_f32_16x16x32_bf16 v[152:155], a[192:195], a[160:163], v[168:171]
  ds_read_b64_tr_b16 a[236:237], v197 offset:25088
  v_cvt_pk_bf16_f32 v105, v138, v139
  v_mfma_f32_16x16x32_bf16 v[152:155], a[196:199], a[164:167], v[152:155]
  v_exp_f32 v140, v140
  v_mfma_f32_16x16x32_bf16 v[152:155], a[200:203], a[168:171], v[152:155]
  ds_read_b64_tr_b16 a[238:239], v197 offset:29184
  v_mfma_f32_16x16x32_bf16 v[152:155], a[204:207], a[172:175], v[152:155]
  v_exp_f32 v141, v141
  v_mfma_f32_16x16x32_bf16 v[156:159], a[204:207], a[188:191], v[172:175]
  buffer_load_dword v240, v226, s[68:71], s44 offen
  v_mfma_f32_16x16x32_bf16 v[156:159], a[200:203], a[184:187], v[156:159]
  v_exp_f32 v142, v142
  v_mfma_f32_16x16x32_bf16 v[156:159], a[196:199], a[180:183], v[156:159]
  v_cvt_pk_bf16_f32 v108, v140, v141
  v_mfma_f32_16x16x32_bf16 v[156:159], a[192:195], a[176:179], v[156:159]
  s_waitcnt lgkmcnt(0)
  v_exp_f32 v143, v143
  v_smfmac_f32_16x16x64_bf16 v[180:183], v[212:215], v[8:15], v184
  v_mfma_f32_16x16x32_bf16 a[80:83], a[224:227], v[0:3], 0
  ds_read_b128 a[192:195], v192 offset:24576
  v_cvt_pk_bf16_f32 v109, v142, v143
  v_mfma_f32_16x16x32_bf16 a[80:83], a[228:231], v[16:19], a[80:83]
  v_exp_f32 v144, v144
  v_mfma_f32_16x16x32_bf16 a[80:83], a[232:235], v[32:35], a[80:83]
  ds_read_b128 a[196:199], v193 offset:24576
  v_mfma_f32_16x16x32_bf16 a[80:83], a[236:239], v[48:51], a[80:83]
  v_exp_f32 v145, v145
  v_mfma_f32_16x16x32_bf16 a[84:87], a[236:239], v[52:55], 0
  v_accvgpr_write_b32 a240, -1
  v_accvgpr_write_b32 a241, -1
  v_mfma_f32_16x16x32_bf16 a[84:87], a[232:235], v[36:39], a[84:87]
  v_exp_f32 v146, v146
  v_mfma_f32_16x16x32_bf16 a[84:87], a[228:231], v[20:23], a[84:87]
  ds_read_b128 a[200:203], v194 offset:24576
  v_cvt_pk_bf16_f32 v98, v144, v145
  v_mfma_f32_16x16x32_bf16 a[84:87], a[224:227], v[4:7], a[84:87]
  v_exp_f32 v147, v147
  v_mfma_f32_16x16x32_bf16 a[88:91], a[224:227], v[8:11], 0
  ds_read_b128 a[204:207], v195 offset:24576
  v_cvt_pk_bf16_f32 v99, v146, v147
  v_mfma_f32_16x16x32_bf16 a[88:91], a[228:231], v[24:27], a[88:91]
  v_exp_f32 v148, v148
  v_mfma_f32_16x16x32_bf16 a[88:91], a[232:235], v[40:43], a[88:91]
  ds_read_b64_tr_b16 a[208:209], v198 offset:512
  v_mfma_f32_16x16x32_bf16 a[88:91], a[236:239], v[56:59], a[88:91]
  v_exp_f32 v149, v149
  v_mfma_f32_16x16x32_bf16 a[92:95], a[236:239], v[60:63], 0
  ds_read_b64_tr_b16 a[210:211], v198 offset:4608
  v_cvt_pk_bf16_f32 v102, v148, v149
  v_mfma_f32_16x16x32_bf16 a[92:95], a[232:235], v[44:47], a[92:95]
  v_exp_f32 v150, v150
  v_mfma_f32_16x16x32_bf16 a[92:95], a[228:231], v[28:31], a[92:95]
  ds_read_b64_tr_b16 a[212:213], v198 offset:8704
  v_mfma_f32_16x16x32_bf16 a[92:95], a[224:227], v[12:15], a[92:95]
  s_waitcnt lgkmcnt(3)
  v_exp_f32 v151, v151
  v_mfma_f32_16x16x32_bf16 v[128:131], a[192:195], a[128:131], v[160:163]
  v_accvgpr_write_b32 a242, -1
  v_accvgpr_write_b32 a243, -1
  v_mfma_f32_16x16x32_bf16 v[128:131], a[196:199], a[132:135], v[128:131]
  v_exp_f32 v152, v152
  v_mfma_f32_16x16x32_bf16 v[128:131], a[200:203], a[136:139], v[128:131]
  ds_read_b64_tr_b16 a[214:215], v198 offset:12800
  v_cvt_pk_bf16_f32 v103, v150, v151
  v_mfma_f32_16x16x32_bf16 v[128:131], a[204:207], a[140:143], v[128:131]
  v_exp_f32 v153, v153
  v_mfma_f32_16x16x32_bf16 v[132:135], a[204:207], a[156:159], v[164:167]
  ds_read_b64_tr_b16 a[216:217], v198 offset:16896
  v_cvt_pk_bf16_f32 v106, v152, v153
  v_mfma_f32_16x16x32_bf16 v[132:135], a[200:203], a[152:155], v[132:135]
  v_exp_f32 v154, v154
  v_mfma_f32_16x16x32_bf16 v[132:135], a[196:199], a[148:151], v[132:135]
  ds_read_b64_tr_b16 a[218:219], v198 offset:20992
  v_mfma_f32_16x16x32_bf16 v[132:135], a[192:195], a[144:147], v[132:135]
  v_exp_f32 v155, v155
  v_mfma_f32_16x16x32_bf16 v[136:139], a[192:195], a[160:163], v[168:171]
  ds_read_b64_tr_b16 a[220:221], v198 offset:25088
  v_cvt_pk_bf16_f32 v107, v154, v155
  v_mfma_f32_16x16x32_bf16 v[136:139], a[196:199], a[164:167], v[136:139]
  v_exp_f32 v156, v156
  v_mfma_f32_16x16x32_bf16 v[136:139], a[200:203], a[168:171], v[136:139]
  ds_read_b64_tr_b16 a[222:223], v198 offset:29184
  v_mfma_f32_16x16x32_bf16 v[136:139], a[204:207], a[172:175], v[136:139]
  v_exp_f32 v157, v157
  v_mfma_f32_16x16x32_bf16 v[140:143], a[204:207], a[188:191], v[172:175]
  v_mfma_f32_16x16x32_bf16 v[140:143], a[200:203], a[184:187], v[140:143]
  v_exp_f32 v158, v158
  v_mfma_f32_16x16x32_bf16 v[140:143], a[196:199], a[180:183], v[140:143]
  v_cvt_pk_bf16_f32 v110, v156, v157
  v_mfma_f32_16x16x32_bf16 v[140:143], a[192:195], a[176:179], v[140:143]
  s_waitcnt lgkmcnt(0)
  v_exp_f32 v159, v159
  v_smfmac_f32_16x16x64_bf16 v[180:183], v[212:215], v[24:31], v184
  v_mfma_f32_16x16x32_bf16 a[96:99], a[208:211], v[0:3], 0
  ds_read_b128 a[192:195], v192 offset:28672
  v_cvt_pk_bf16_f32 v111, v158, v159
  v_mfma_f32_16x16x32_bf16 a[96:99], a[212:215], v[16:19], a[96:99]
  v_exp_f32 v128, v128
  v_mfma_f32_16x16x32_bf16 a[96:99], a[216:219], v[32:35], a[96:99]
  ds_read_b128 a[196:199], v193 offset:28672
  v_mfma_f32_16x16x32_bf16 a[96:99], a[220:223], v[48:51], a[96:99]
  v_exp_f32 v129, v129
  v_mfma_f32_16x16x32_bf16 a[100:103], a[220:223], v[52:55], 0
  v_mfma_f32_16x16x32_bf16 a[100:103], a[216:219], v[36:39], a[100:103]
  v_exp_f32 v130, v130
  v_mfma_f32_16x16x32_bf16 a[100:103], a[212:215], v[20:23], a[100:103]
  ds_read_b128 a[200:203], v194 offset:28672
  v_cvt_pk_bf16_f32 v112, v128, v129
  v_mfma_f32_16x16x32_bf16 a[100:103], a[208:211], v[4:7], a[100:103]
  v_exp_f32 v131, v131
  v_mfma_f32_16x16x32_bf16 a[104:107], a[208:211], v[8:11], 0
  ds_read_b128 a[204:207], v195 offset:28672
  v_cvt_pk_bf16_f32 v113, v130, v131
  v_mfma_f32_16x16x32_bf16 a[104:107], a[212:215], v[24:27], a[104:107]
  v_exp_f32 v132, v132
  v_mfma_f32_16x16x32_bf16 a[104:107], a[216:219], v[40:43], a[104:107]
  ds_read_b64_tr_b16 a[224:225], v199 offset:512
  v_mfma_f32_16x16x32_bf16 a[104:107], a[220:223], v[56:59], a[104:107]
  v_exp_f32 v133, v133
  v_mfma_f32_16x16x32_bf16 a[108:111], a[220:223], v[60:63], 0
  ds_read_b64_tr_b16 a[226:227], v199 offset:4608
  v_cvt_pk_bf16_f32 v116, v132, v133
  v_mfma_f32_16x16x32_bf16 a[108:111], a[216:219], v[44:47], a[108:111]
  v_exp_f32 v134, v134
  v_mfma_f32_16x16x32_bf16 a[108:111], a[212:215], v[28:31], a[108:111]
  ds_read_b64_tr_b16 a[228:229], v199 offset:8704
  v_mfma_f32_16x16x32_bf16 a[108:111], a[208:211], v[12:15], a[108:111]
  s_waitcnt lgkmcnt(3)
  v_exp_f32 v135, v135
  v_mfma_f32_16x16x32_bf16 v[144:147], a[192:195], a[128:131], v[160:163]
  v_mfma_f32_16x16x32_bf16 v[144:147], a[196:199], a[132:135], v[144:147]
  v_exp_f32 v136, v136
  v_mfma_f32_16x16x32_bf16 v[144:147], a[200:203], a[136:139], v[144:147]
  ds_read_b64_tr_b16 a[230:231], v199 offset:12800
  v_cvt_pk_bf16_f32 v117, v134, v135
  v_mfma_f32_16x16x32_bf16 v[144:147], a[204:207], a[140:143], v[144:147]
  v_exp_f32 v137, v137
  v_mfma_f32_16x16x32_bf16 v[148:151], a[204:207], a[156:159], v[164:167]
  ds_read_b64_tr_b16 a[232:233], v199 offset:16896
  v_cvt_pk_bf16_f32 v120, v136, v137
  v_mfma_f32_16x16x32_bf16 v[148:151], a[200:203], a[152:155], v[148:151]
  v_exp_f32 v138, v138
  v_mfma_f32_16x16x32_bf16 v[148:151], a[196:199], a[148:151], v[148:151]
  ds_read_b64_tr_b16 a[234:235], v199 offset:20992
  v_mfma_f32_16x16x32_bf16 v[148:151], a[192:195], a[144:147], v[148:151]
  v_exp_f32 v139, v139
  v_mfma_f32_16x16x32_bf16 v[152:155], a[192:195], a[160:163], v[168:171]
  ds_read_b64_tr_b16 a[236:237], v199 offset:25088
  v_cvt_pk_bf16_f32 v121, v138, v139
  v_mfma_f32_16x16x32_bf16 v[152:155], a[196:199], a[164:167], v[152:155]
  v_exp_f32 v140, v140
  v_mfma_f32_16x16x32_bf16 v[152:155], a[200:203], a[168:171], v[152:155]
  ds_read_b64_tr_b16 a[238:239], v199 offset:29184
  v_mfma_f32_16x16x32_bf16 v[152:155], a[204:207], a[172:175], v[152:155]
  s_add_u32 s52, s52, 32768
  v_exp_f32 v141, v141
  v_mfma_f32_16x16x32_bf16 v[156:159], a[204:207], a[188:191], v[172:175]
  v_mfma_f32_16x16x32_bf16 v[156:159], a[200:203], a[184:187], v[156:159]
  v_exp_f32 v142, v142
  v_mfma_f32_16x16x32_bf16 v[156:159], a[196:199], a[180:183], v[156:159]
  v_cvt_pk_bf16_f32 v124, v140, v141
  v_mfma_f32_16x16x32_bf16 v[156:159], a[192:195], a[176:179], v[156:159]
  v_exp_f32 v143, v143
  v_smfmac_f32_16x16x64_bf16 v[180:183], v[212:215], v[40:47], v184
  s_mov_b32 s54, 7
  s_waitcnt vmcnt(1) lgkmcnt(0)
L_loop:
  s_barrier
  v_mfma_f32_16x16x32_bf16 a[112:115], a[224:227], v[0:3], a[112:115]
  ds_read_b128 a[192:195], v192 offset:32768
  v_cvt_pk_bf16_f32 v125, v142, v143
  v_mfma_f32_16x16x32_bf16 a[112:115], a[228:231], v[16:19], a[112:115]
  s_add_u32 m0, s53, 0
  v_exp_f32 v144, v144
  v_mfma_f32_16x16x32_bf16 a[112:115], a[232:235], v[32:35], a[112:115]
  ds_read_b128 a[196:199], v193 offset:32768
  v_mfma_f32_16x16x32_bf16 a[112:115], a[236:239], v[48:51], a[112:115]
  s_add_u32 s48, s52, 65536
  v_exp_f32 v145, v145
  v_mfma_f32_16x16x32_bf16 a[116:119], a[236:239], v[52:55], a[116:119]
  buffer_load_dwordx4 v200, s[12:15], s48 offen lds
  v_mfma_f32_16x16x32_bf16 a[116:119], a[232:235], v[36:39], a[116:119]
  v_exp_f32 v146, v146
  v_mfma_f32_16x16x32_bf16 a[116:119], a[228:231], v[20:23], a[116:119]
  ds_read_b128 a[200:203], v194 offset:32768
  v_cvt_pk_bf16_f32 v114, v144, v145
  v_mfma_f32_16x16x32_bf16 a[116:119], a[224:227], v[4:7], a[116:119]
  v_exp_f32 v147, v147
  v_mfma_f32_16x16x32_bf16 a[120:123], a[224:227], v[8:11], a[120:123]
  ds_read_b128 a[204:207], v195 offset:32768
  v_cvt_pk_bf16_f32 v115, v146, v147
  v_mfma_f32_16x16x32_bf16 a[120:123], a[228:231], v[24:27], a[120:123]
  v_exp_f32 v148, v148
  v_mfma_f32_16x16x32_bf16 a[120:123], a[232:235], v[40:43], a[120:123]
  ds_read_b64_tr_b16 a[208:209], v196 offset:32768
  v_mfma_f32_16x16x32_bf16 a[120:123], a[236:239], v[56:59], a[120:123]
  v_exp_f32 v149, v149
  v_mfma_f32_16x16x32_bf16 a[124:127], a[236:239], v[60:63], a[124:127]
  ds_read_b64_tr_b16 a[210:211], v196 offset:36864
  v_cvt_pk_bf16_f32 v118, v148, v149
  v_mfma_f32_16x16x32_bf16 a[124:127], a[232:235], v[44:47], a[124:127]
  v_exp_f32 v150, v150
  v_mfma_f32_16x16x32_bf16 a[124:127], a[228:231], v[28:31], a[124:127]
  ds_read_b64_tr_b16 a[212:213], v196 offset:40960
  v_mfma_f32_16x16x32_bf16 a[124:127], a[224:227], v[12:15], a[124:127]
  s_waitcnt lgkmcnt(3)
  v_exp_f32 v151, v151
  v_mfma_f32_16x16x32_bf16 v[128:131], a[192:195], a[128:131], v[160:163]
  buffer_load_dwordx4 v201, s[12:15], s48 offen offset:1024 lds
  v_mfma_f32_16x16x32_bf16 v[128:131], a[196:199], a[132:135], v[128:131]
  v_exp_f32 v152, v152
  v_mfma_f32_16x16x32_bf16 v[128:131], a[200:203], a[136:139], v[128:131]
  ds_read_b64_tr_b16 a[214:215], v196 offset:45056
  v_cvt_pk_bf16_f32 v119, v150, v151
  v_mfma_f32_16x16x32_bf16 v[128:131], a[204:207], a[140:143], v[128:131]
  v_exp_f32 v153, v153
  v_mfma_f32_16x16x32_bf16 v[132:135], a[204:207], a[156:159], v[164:167]
  ds_read_b64_tr_b16 a[216:217], v196 offset:49152
  v_cvt_pk_bf16_f32 v122, v152, v153
  v_mfma_f32_16x16x32_bf16 v[132:135], a[200:203], a[152:155], v[132:135]
  v_exp_f32 v154, v154
  v_mfma_f32_16x16x32_bf16 v[132:135], a[196:199], a[148:151], v[132:135]
  ds_read_b64_tr_b16 a[218:219], v196 offset:53248
  v_mfma_f32_16x16x32_bf16 v[132:135], a[192:195], a[144:147], v[132:135]
  v_exp_f32 v155, v155
  v_mfma_f32_16x16x32_bf16 v[136:139], a[192:195], a[160:163], v[168:171]
  ds_read_b64_tr_b16 a[220:221], v196 offset:57344
  v_cvt_pk_bf16_f32 v123, v154, v155
  v_mfma_f32_16x16x32_bf16 v[136:139], a[196:199], a[164:167], v[136:139]
  v_exp_f32 v156, v156
  v_mfma_f32_16x16x32_bf16 v[136:139], a[200:203], a[168:171], v[136:139]
  ds_read_b64_tr_b16 a[222:223], v196 offset:61440
  v_mfma_f32_16x16x32_bf16 v[136:139], a[204:207], a[172:175], v[136:139]
  v_exp_f32 v157, v157
  v_mfma_f32_16x16x32_bf16 v[140:143], a[204:207], a[188:191], v[172:175]
  buffer_load_dwordx4 v202, s[12:15], s48 offen offset:2048 lds
  v_mfma_f32_16x16x32_bf16 v[140:143], a[200:203], a[184:187], v[140:143]
  v_exp_f32 v158, v158
  v_mfma_f32_16x16x32_bf16 v[140:143], a[196:199], a[180:183], v[140:143]
  v_cvt_pk_bf16_f32 v126, v156, v157
  v_mfma_f32_16x16x32_bf16 v[140:143], a[192:195], a[176:179], v[140:143]
  s_waitcnt lgkmcnt(0)
  v_exp_f32 v159, v159
  v_smfmac_f32_16x16x64_bf16 v[180:183], v[212:215], v[56:63], v184
  buffer_load_dwordx4 v203, s[12:15], s48 offen offset:3072 lds
  v_mfma_f32_16x16x32_bf16 a[0:3], a[208:211], v[64:67], a[0:3]
  ds_read_b128 a[192:195], v192 offset:36864
  v_cvt_pk_bf16_f32 v127, v158, v159
  v_mfma_f32_16x16x32_bf16 a[0:3], a[212:215], v[80:83], a[0:3]
  s_add_u32 m0, s53, 4096
  v_exp_f32 v128, v128
  v_mfma_f32_16x16x32_bf16 a[0:3], a[216:219], v[96:99], a[0:3]
  ds_read_b128 a[196:199], v193 offset:36864
  v_mfma_f32_16x16x32_bf16 a[0:3], a[220:223], v[112:115], a[0:3]
  s_add_u32 s48, s52, 69632
  v_exp_f32 v129, v129
  v_mfma_f32_16x16x32_bf16 a[4:7], a[220:223], v[116:119], a[4:7]
  buffer_load_dwordx4 v200, s[12:15], s48 offen lds
  v_mfma_f32_16x16x32_bf16 a[4:7], a[216:219], v[100:103], a[4:7]
  v_exp_f32 v130, v130
  v_mfma_f32_16x16x32_bf16 a[4:7], a[212:215], v[84:87], a[4:7]
  ds_read_b128 a[200:203], v194 offset:36864
  v_cvt_pk_bf16_f32 v0, v128, v129
  v_mfma_f32_16x16x32_bf16 a[4:7], a[208:211], v[68:71], a[4:7]
  v_exp_f32 v131, v131
  v_mfma_f32_16x16x32_bf16 a[8:11], a[208:211], v[72:75], a[8:11]
  ds_read_b128 a[204:207], v195 offset:36864
  v_cvt_pk_bf16_f32 v1, v130, v131
  v_mfma_f32_16x16x32_bf16 a[8:11], a[212:215], v[88:91], a[8:11]
  v_exp_f32 v132, v132
  v_mfma_f32_16x16x32_bf16 a[8:11], a[216:219], v[104:107], a[8:11]
  ds_read_b64_tr_b16 a[224:225], v197 offset:32768
  v_mfma_f32_16x16x32_bf16 a[8:11], a[220:223], v[120:123], a[8:11]
  v_exp_f32 v133, v133
  v_mfma_f32_16x16x32_bf16 a[12:15], a[220:223], v[124:127], a[12:15]
  ds_read_b64_tr_b16 a[226:227], v197 offset:36864
  v_cvt_pk_bf16_f32 v4, v132, v133
  v_mfma_f32_16x16x32_bf16 a[12:15], a[216:219], v[108:111], a[12:15]
  v_exp_f32 v134, v134
  v_mfma_f32_16x16x32_bf16 a[12:15], a[212:215], v[92:95], a[12:15]
  ds_read_b64_tr_b16 a[228:229], v197 offset:40960
  v_mfma_f32_16x16x32_bf16 a[12:15], a[208:211], v[76:79], a[12:15]
  s_waitcnt lgkmcnt(3)
  v_exp_f32 v135, v135
  v_mfma_f32_16x16x32_bf16 v[144:147], a[192:195], a[128:131], v[160:163]
  buffer_load_dwordx4 v201, s[12:15], s48 offen offset:1024 lds
  v_mfma_f32_16x16x32_bf16 v[144:147], a[196:199], a[132:135], v[144:147]
  v_exp_f32 v136, v136
  v_mfma_f32_16x16x32_bf16 v[144:147], a[200:203], a[136:139], v[144:147]
  ds_read_b64_tr_b16 a[230:231], v197 offset:45056
  v_cvt_pk_bf16_f32 v5, v134, v135
  v_mfma_f32_16x16x32_bf16 v[144:147], a[204:207], a[140:143], v[144:147]
  v_exp_f32 v137, v137
  v_mfma_f32_16x16x32_bf16 v[148:151], a[204:207], a[156:159], v[164:167]
  ds_read_b64_tr_b16 a[232:233], v197 offset:49152
  v_cvt_pk_bf16_f32 v8, v136, v137
  v_mfma_f32_16x16x32_bf16 v[148:151], a[200:203], a[152:155], v[148:151]
  v_exp_f32 v138, v138
  v_mfma_f32_16x16x32_bf16 v[148:151], a[196:199], a[148:151], v[148:151]
  ds_read_b64_tr_b16 a[234:235], v197 offset:53248
  v_mfma_f32_16x16x32_bf16 v[148:151], a[192:195], a[144:147], v[148:151]
  v_exp_f32 v139, v139
  v_mfma_f32_16x16x32_bf16 v[152:155], a[192:195], a[160:163], v[168:171]
  ds_read_b64_tr_b16 a[236:237], v197 offset:57344
  v_cvt_pk_bf16_f32 v9, v138, v139
  v_mfma_f32_16x16x32_bf16 v[152:155], a[196:199], a[164:167], v[152:155]
  v_exp_f32 v140, v140
  v_mfma_f32_16x16x32_bf16 v[152:155], a[200:203], a[168:171], v[152:155]
  ds_read_b64_tr_b16 a[238:239], v197 offset:61440
  v_mfma_f32_16x16x32_bf16 v[152:155], a[204:207], a[172:175], v[152:155]
  v_exp_f32 v141, v141
  v_mfma_f32_16x16x32_bf16 v[156:159], a[204:207], a[188:191], v[172:175]
  buffer_load_dwordx4 v202, s[12:15], s48 offen offset:2048 lds
  v_mfma_f32_16x16x32_bf16 v[156:159], a[200:203], a[184:187], v[156:159]
  v_exp_f32 v142, v142
  v_mfma_f32_16x16x32_bf16 v[156:159], a[196:199], a[180:183], v[156:159]
  v_cvt_pk_bf16_f32 v12, v140, v141
  v_mfma_f32_16x16x32_bf16 v[156:159], a[192:195], a[176:179], v[156:159]
  s_waitcnt lgkmcnt(0)
  v_exp_f32 v143, v143
  v_smfmac_f32_16x16x64_bf16 v[176:179], v[212:215], v[64:71], v184
  buffer_load_dwordx4 v203, s[12:15], s48 offen offset:3072 lds
  v_mfma_f32_16x16x32_bf16 a[16:19], a[224:227], v[64:67], a[16:19]
  ds_read_b128 a[192:195], v192 offset:40960
  v_cvt_pk_bf16_f32 v13, v142, v143
  v_mfma_f32_16x16x32_bf16 a[16:19], a[228:231], v[80:83], a[16:19]
  s_add_u32 m0, s53, 98304
  v_exp_f32 v144, v144
  v_mfma_f32_16x16x32_bf16 a[16:19], a[232:235], v[96:99], a[16:19]
  ds_read_b128 a[196:199], v193 offset:40960
  v_mfma_f32_16x16x32_bf16 a[16:19], a[236:239], v[112:115], a[16:19]
  s_add_u32 s48, s52, 32768
  v_exp_f32 v145, v145
  v_mfma_f32_16x16x32_bf16 a[20:23], a[236:239], v[116:119], a[20:23]
  buffer_load_dwordx4 v204, s[16:19], s48 offen lds
  v_mfma_f32_16x16x32_bf16 a[20:23], a[232:235], v[100:103], a[20:23]
  v_exp_f32 v146, v146
  v_mfma_f32_16x16x32_bf16 a[20:23], a[228:231], v[84:87], a[20:23]
  ds_read_b128 a[200:203], v194 offset:40960
  v_cvt_pk_bf16_f32 v2, v144, v145
  v_mfma_f32_16x16x32_bf16 a[20:23], a[224:227], v[68:71], a[20:23]
  v_exp_f32 v147, v147
  v_mfma_f32_16x16x32_bf16 a[24:27], a[224:227], v[72:75], a[24:27]
L_hop7:
  s_cbranch_execz L_hop11
  ds_read_b128 a[204:207], v195 offset:40960
  v_cvt_pk_bf16_f32 v3, v146, v147
  v_mfma_f32_16x16x32_bf16 a[24:27], a[228:231], v[88:91], a[24:27]
  v_exp_f32 v148, v148
  v_mfma_f32_16x16x32_bf16 a[24:27], a[232:235], v[104:107], a[24:27]
  ds_read_b64_tr_b16 a[208:209], v198 offset:32768
  v_mfma_f32_16x16x32_bf16 a[24:27], a[236:239], v[120:123], a[24:27]
  v_exp_f32 v149, v149
  v_mfma_f32_16x16x32_bf16 a[28:31], a[236:239], v[124:127], a[28:31]
  ds_read_b64_tr_b16 a[210:211], v198 offset:36864
  v_cvt_pk_bf16_f32 v6, v148, v149
  v_mfma_f32_16x16x32_bf16 a[28:31], a[232:235], v[108:111], a[28:31]
  v_exp_f32 v150, v150
  v_mfma_f32_16x16x32_bf16 a[28:31], a[228:231], v[92:95], a[28:31]
  ds_read_b64_tr_b16 a[212:213], v198 offset:40960
  v_mfma_f32_16x16x32_bf16 a[28:31], a[224:227], v[76:79], a[28:31]
  s_waitcnt lgkmcnt(3)
  v_exp_f32 v151, v151
  v_mfma_f32_16x16x32_bf16 v[128:131], a[192:195], a[128:131], v[160:163]
  buffer_load_dwordx4 v205, s[16:19], s48 offen offset:1024 lds
  v_mfma_f32_16x16x32_bf16 v[128:131], a[196:199], a[132:135], v[128:131]
  v_exp_f32 v152, v152
  v_mfma_f32_16x16x32_bf16 v[128:131], a[200:203], a[136:139], v[128:131]
  ds_read_b64_tr_b16 a[214:215], v198 offset:45056
  v_cvt_pk_bf16_f32 v7, v150, v151
  v_mfma_f32_16x16x32_bf16 v[128:131], a[204:207], a[140:143], v[128:131]
  v_exp_f32 v153, v153
  v_mfma_f32_16x16x32_bf16 v[132:135], a[204:207], a[156:159], v[164:167]
  ds_read_b64_tr_b16 a[216:217], v198 offset:49152
  v_cvt_pk_bf16_f32 v10, v152, v153
  v_mfma_f32_16x16x32_bf16 v[132:135], a[200:203], a[152:155], v[132:135]
  v_exp_f32 v154, v154
  v_mfma_f32_16x16x32_bf16 v[132:135], a[196:199], a[148:151], v[132:135]
  ds_read_b64_tr_b16 a[218:219], v198 offset:53248
  v_mfma_f32_16x16x32_bf16 v[132:135], a[192:195], a[144:147], v[132:135]
  v_exp_f32 v155, v155
  v_mfma_f32_16x16x32_bf16 v[136:139], a[192:195], a[160:163], v[168:171]
  ds_read_b64_tr_b16 a[220:221], v198 offset:57344
  v_cvt_pk_bf16_f32 v11, v154, v155
  v_mfma_f32_16x16x32_bf16 v[136:139], a[196:199], a[164:167], v[136:139]
  v_exp_f32 v156, v156
  v_mfma_f32_16x16x32_bf16 v[136:139], a[200:203], a[168:171], v[136:139]
  ds_read_b64_tr_b16 a[222:223], v198 offset:61440
  v_mfma_f32_16x16x32_bf16 v[136:139], a[204:207], a[172:175], v[136:139]
  v_exp_f32 v157, v157
  v_mfma_f32_16x16x32_bf16 v[140:143], a[204:207], a[188:191], v[172:175]
  buffer_load_dwordx4 v204, s[16:19], s48 offen offset:2048 lds
  v_mfma_f32_16x16x32_bf16 v[140:143], a[200:203], a[184:187], v[140:143]
  v_exp_f32 v158, v158
  v_mfma_f32_16x16x32_bf16 v[140:143], a[196:199], a[180:183], v[140:143]
  v_cvt_pk_bf16_f32 v14, v156, v157
  v_mfma_f32_16x16x32_bf16 v[140:143], a[192:195], a[176:179], v[140:143]
  s_waitcnt lgkmcnt(0)
  v_exp_f32 v159, v159
  v_smfmac_f32_16x16x64_bf16 v[176:179], v[212:215], v[80:87], v184
  buffer_load_dwordx4 v205, s[16:19], s48 offen offset:3072 lds
  v_mfma_f32_16x16x32_bf16 a[32:35], a[208:211], v[64:67], a[32:35]
  ds_read_b128 a[192:195], v192 offset:45056
  v_cvt_pk_bf16_f32 v15, v158, v159
  v_mfma_f32_16x16x32_bf16 a[32:35], a[212:215], v[80:83], a[32:35]
  s_add_u32 m0, s53, 102400
  v_exp_f32 v128, v128
  v_mfma_f32_16x16x32_bf16 a[32:35], a[216:219], v[96:99], a[32:35]
  ds_read_b128 a[196:199], v193 offset:45056
  v_mfma_f32_16x16x32_bf16 a[32:35], a[220:223], v[112:115], a[32:35]
  s_add_u32 s48, s52, 36864
  v_exp_f32 v129, v129
  v_mfma_f32_16x16x32_bf16 a[36:39], a[220:223], v[116:119], a[36:39]
  buffer_load_dwordx4 v204, s[16:19], s48 offen lds
  v_mfma_f32_16x16x32_bf16 a[36:39], a[216:219], v[100:103], a[36:39]
  s_cmp_eq_u32 s54, 2
  v_exp_f32 v130, v130
  v_mfma_f32_16x16x32_bf16 a[36:39], a[212:215], v[84:87], a[36:39]
  ds_read_b128 a[200:203], v194 offset:45056
  v_cvt_pk_bf16_f32 v16, v128, v129
  v_mfma_f32_16x16x32_bf16 a[36:39], a[208:211], v[68:71], a[36:39]
  s_cselect_b32 s50, 0, 1073741824
  v_exp_f32 v131, v131
  v_mfma_f32_16x16x32_bf16 a[40:43], a[208:211], v[72:75], a[40:43]
  ds_read_b128 a[204:207], v195 offset:45056
  v_cvt_pk_bf16_f32 v17, v130, v131
  v_mfma_f32_16x16x32_bf16 a[40:43], a[212:215], v[88:91], a[40:43]
  s_cmp_eq_u32 s54, 1
  v_exp_f32 v132, v132
  v_mfma_f32_16x16x32_bf16 a[40:43], a[216:219], v[104:107], a[40:43]
  ds_read_b64_tr_b16 a[224:225], v199 offset:32768
  v_mfma_f32_16x16x32_bf16 a[40:43], a[220:223], v[120:123], a[40:43]
  s_cselect_b32 s45, s59, 1073741824
  v_exp_f32 v133, v133
  v_mfma_f32_16x16x32_bf16 a[44:47], a[220:223], v[124:127], a[44:47]
  ds_read_b64_tr_b16 a[226:227], v199 offset:36864
  v_cvt_pk_bf16_f32 v20, v132, v133
  v_mfma_f32_16x16x32_bf16 a[44:47], a[216:219], v[108:111], a[44:47]
  s_sub_u32 s3, s54, 2
  v_exp_f32 v134, v134
  v_mfma_f32_16x16x32_bf16 a[44:47], a[212:215], v[92:95], a[44:47]
  ds_read_b64_tr_b16 a[228:229], v199 offset:40960
  v_mfma_f32_16x16x32_bf16 a[44:47], a[208:211], v[76:79], a[44:47]
  s_waitcnt lgkmcnt(3)
  v_exp_f32 v135, v135
  v_mfma_f32_16x16x32_bf16 v[144:147], a[192:195], a[128:131], v[160:163]
  buffer_load_dwordx4 v205, s[16:19], s48 offen offset:1024 lds
  v_mfma_f32_16x16x32_bf16 v[144:147], a[196:199], a[132:135], v[144:147]
  s_lshl_b32 s51, s3, 13
  v_exp_f32 v136, v136
  v_mfma_f32_16x16x32_bf16 v[144:147], a[200:203], a[136:139], v[144:147]
  ds_read_b64_tr_b16 a[230:231], v199 offset:45056
  v_cvt_pk_bf16_f32 v21, v134, v135
  v_mfma_f32_16x16x32_bf16 v[144:147], a[204:207], a[140:143], v[144:147]
  s_add_u32 s51, s51, s62
  v_exp_f32 v137, v137
  v_mfma_f32_16x16x32_bf16 v[148:151], a[204:207], a[156:159], v[164:167]
  ds_read_b64_tr_b16 a[232:233], v199 offset:49152
  v_cvt_pk_bf16_f32 v24, v136, v137
  v_mfma_f32_16x16x32_bf16 v[148:151], a[200:203], a[152:155], v[148:151]
  s_cmp_lt_u32 s3, 4
  v_exp_f32 v138, v138
  v_mfma_f32_16x16x32_bf16 v[148:151], a[196:199], a[148:151], v[148:151]
  ds_read_b64_tr_b16 a[234:235], v199 offset:53248
  v_mfma_f32_16x16x32_bf16 v[148:151], a[192:195], a[144:147], v[148:151]
  s_cselect_b32 s51, s51, 1073741824
  v_exp_f32 v139, v139
  v_mfma_f32_16x16x32_bf16 v[152:155], a[192:195], a[160:163], v[168:171]
  ds_read_b64_tr_b16 a[236:237], v199 offset:57344
  v_cvt_pk_bf16_f32 v25, v138, v139
  v_mfma_f32_16x16x32_bf16 v[152:155], a[196:199], a[164:167], v[152:155]
  s_add_u32 s44, s52, s72
  v_exp_f32 v140, v140
  v_mfma_f32_16x16x32_bf16 v[152:155], a[200:203], a[168:171], v[152:155]
  ds_read_b64_tr_b16 a[238:239], v199 offset:61440
  v_mfma_f32_16x16x32_bf16 v[152:155], a[204:207], a[172:175], v[152:155]
  s_add_u32 s44, s44, 32768
  v_exp_f32 v141, v141
  v_mfma_f32_16x16x32_bf16 v[156:159], a[204:207], a[188:191], v[172:175]
  buffer_load_dwordx4 v204, s[16:19], s48 offen offset:2048 lds
  v_mfma_f32_16x16x32_bf16 v[156:159], a[200:203], a[184:187], v[156:159]
  v_exp_f32 v142, v142
  v_mfma_f32_16x16x32_bf16 v[156:159], a[196:199], a[180:183], v[156:159]
  v_cvt_pk_bf16_f32 v28, v140, v141
  v_mfma_f32_16x16x32_bf16 v[156:159], a[192:195], a[176:179], v[156:159]
  s_waitcnt lgkmcnt(0)
  v_exp_f32 v143, v143
  v_smfmac_f32_16x16x64_bf16 v[176:179], v[212:215], v[96:103], v184
  buffer_load_dwordx4 v205, s[16:19], s48 offen offset:3072 lds
  v_mfma_f32_16x16x32_bf16 a[48:51], a[224:227], v[64:67], a[48:51]
  ds_read_b128 a[192:195], v192 offset:49152
  v_cvt_pk_bf16_f32 v29, v142, v143
  v_mfma_f32_16x16x32_bf16 a[48:51], a[228:231], v[80:83], a[48:51]
  v_exp_f32 v144, v144
  v_mfma_f32_16x16x32_bf16 a[48:51], a[232:235], v[96:99], a[48:51]
  ds_read_b128 a[196:199], v193 offset:49152
  v_mfma_f32_16x16x32_bf16 a[48:51], a[236:239], v[112:115], a[48:51]
  v_exp_f32 v145, v145
  v_mfma_f32_16x16x32_bf16 a[52:55], a[236:239], v[116:119], a[52:55]
  buffer_load_dword v223, v226, s[68:71], s44 offen
  v_mfma_f32_16x16x32_bf16 a[52:55], a[232:235], v[100:103], a[52:55]
  v_exp_f32 v146, v146
  v_mfma_f32_16x16x32_bf16 a[52:55], a[228:231], v[84:87], a[52:55]
  ds_read_b128 a[200:203], v194 offset:49152
  v_cvt_pk_bf16_f32 v18, v144, v145
  v_mfma_f32_16x16x32_bf16 a[52:55], a[224:227], v[68:71], a[52:55]
  v_exp_f32 v147, v147
  v_mfma_f32_16x16x32_bf16 a[56:59], a[224:227], v[72:75], a[56:59]
  ds_read_b128 a[204:207], v195 offset:49152
  v_cvt_pk_bf16_f32 v19, v146, v147
  v_mfma_f32_16x16x32_bf16 a[56:59], a[228:231], v[88:91], a[56:59]
  v_exp_f32 v148, v148
  v_mfma_f32_16x16x32_bf16 a[56:59], a[232:235], v[104:107], a[56:59]
  ds_read_b64_tr_b16 a[208:209], v196 offset:33280
  v_mfma_f32_16x16x32_bf16 a[56:59], a[236:239], v[120:123], a[56:59]
  v_exp_f32 v149, v149
  v_mfma_f32_16x16x32_bf16 a[60:63], a[236:239], v[124:127], a[60:63]
  ds_read_b64_tr_b16 a[210:211], v196 offset:37376
  v_cvt_pk_bf16_f32 v22, v148, v149
  v_mfma_f32_16x16x32_bf16 a[60:63], a[232:235], v[108:111], a[60:63]
  v_exp_f32 v150, v150
  v_mfma_f32_16x16x32_bf16 a[60:63], a[228:231], v[92:95], a[60:63]
  ds_read_b64_tr_b16 a[212:213], v196 offset:41472
  v_mfma_f32_16x16x32_bf16 a[60:63], a[224:227], v[76:79], a[60:63]
  s_waitcnt lgkmcnt(3)
  v_exp_f32 v151, v151
  v_mfma_f32_16x16x32_bf16 v[128:131], a[192:195], a[128:131], v[160:163]
  buffer_load_dword v206, v226, s[24:27], s51 offen
  v_mfma_f32_16x16x32_bf16 v[128:131], a[196:199], a[132:135], v[128:131]
  v_exp_f32 v152, v152
  v_mfma_f32_16x16x32_bf16 v[128:131], a[200:203], a[136:139], v[128:131]
  ds_read_b64_tr_b16 a[214:215], v196 offset:45568
  v_cvt_pk_bf16_f32 v23, v150, v151
  v_mfma_f32_16x16x32_bf16 v[128:131], a[204:207], a[140:143], v[128:131]
  v_exp_f32 v153, v153
  v_mfma_f32_16x16x32_bf16 v[132:135], a[204:207], a[156:159], v[164:167]
  ds_read_b64_tr_b16 a[216:217], v196 offset:49664
  v_cvt_pk_bf16_f32 v26, v152, v153
  v_mfma_f32_16x16x32_bf16 v[132:135], a[200:203], a[152:155], v[132:135]
  v_exp_f32 v154, v154
  v_mfma_f32_16x16x32_bf16 v[132:135], a[196:199], a[148:151], v[132:135]
  ds_read_b64_tr_b16 a[218:219], v196 offset:53760
  v_mfma_f32_16x16x32_bf16 v[132:135], a[192:195], a[144:147], v[132:135]
  v_exp_f32 v155, v155
  v_mfma_f32_16x16x32_bf16 v[136:139], a[192:195], a[160:163], v[168:171]
  ds_read_b64_tr_b16 a[220:221], v196 offset:57856
  v_cvt_pk_bf16_f32 v27, v154, v155
  v_mfma_f32_16x16x32_bf16 v[136:139], a[196:199], a[164:167], v[136:139]
  v_exp_f32 v156, v156
  v_mfma_f32_16x16x32_bf16 v[136:139], a[200:203], a[168:171], v[136:139]
  ds_read_b64_tr_b16 a[222:223], v196 offset:61952
  v_mfma_f32_16x16x32_bf16 v[136:139], a[204:207], a[172:175], v[136:139]
  v_exp_f32 v157, v157
  v_mfma_f32_16x16x32_bf16 v[140:143], a[204:207], a[188:191], v[172:175]
  buffer_atomic_add v225, v207, s[4:7], s50 offen sc1
  v_mfma_f32_16x16x32_bf16 v[140:143], a[200:203], a[184:187], v[140:143]
  v_exp_f32 v158, v158
  v_mfma_f32_16x16x32_bf16 v[140:143], a[196:199], a[180:183], v[140:143]
  v_cvt_pk_bf16_f32 v30, v156, v157
  v_mfma_f32_16x16x32_bf16 v[140:143], a[192:195], a[176:179], v[140:143]
  s_waitcnt lgkmcnt(0)
  v_exp_f32 v159, v159
  v_smfmac_f32_16x16x64_bf16 v[176:179], v[212:215], v[112:119], v184
  buffer_load_dword v224, off, s[4:7], s45 sc1
  v_mfma_f32_16x16x32_bf16 a[64:67], a[208:211], v[64:67], a[64:67]
  ds_read_b128 a[192:195], v192 offset:53248
  v_cvt_pk_bf16_f32 v31, v158, v159
  v_mfma_f32_16x16x32_bf16 a[64:67], a[212:215], v[80:83], a[64:67]
  v_exp_f32 v128, v128
  v_mfma_f32_16x16x32_bf16 a[64:67], a[216:219], v[96:99], a[64:67]
  ds_read_b128 a[196:199], v193 offset:53248
  v_mfma_f32_16x16x32_bf16 a[64:67], a[220:223], v[112:115], a[64:67]
  v_exp_f32 v129, v129
  v_mfma_f32_16x16x32_bf16 a[68:71], a[220:223], v[116:119], a[68:71]
  v_mfma_f32_16x16x32_bf16 a[68:71], a[216:219], v[100:103], a[68:71]
  v_exp_f32 v130, v130
  v_mfma_f32_16x16x32_bf16 a[68:71], a[212:215], v[84:87], a[68:71]
  ds_read_b128 a[200:203], v194 offset:53248
  v_cvt_pk_bf16_f32 v32, v128, v129
  v_mfma_f32_16x16x32_bf16 a[68:71], a[208:211], v[68:71], a[68:71]
  v_exp_f32 v131, v131
  v_mfma_f32_16x16x32_bf16 a[72:75], a[208:211], v[72:75], a[72:75]
  ds_read_b128 a[204:207], v195 offset:53248
  v_cvt_pk_bf16_f32 v33, v130, v131
  v_mfma_f32_16x16x32_bf16 a[72:75], a[212:215], v[88:91], a[72:75]
  v_exp_f32 v132, v132
  v_mfma_f32_16x16x32_bf16 a[72:75], a[216:219], v[104:107], a[72:75]
  ds_read_b64_tr_b16 a[224:225], v197 offset:33280
  v_mfma_f32_16x16x32_bf16 a[72:75], a[220:223], v[120:123], a[72:75]
  v_exp_f32 v133, v133
  v_mfma_f32_16x16x32_bf16 a[76:79], a[220:223], v[124:127], a[76:79]
  ds_read_b64_tr_b16 a[226:227], v197 offset:37376
  v_cvt_pk_bf16_f32 v36, v132, v133
  v_mfma_f32_16x16x32_bf16 a[76:79], a[216:219], v[108:111], a[76:79]
  v_exp_f32 v134, v134
  v_mfma_f32_16x16x32_bf16 a[76:79], a[212:215], v[92:95], a[76:79]
  ds_read_b64_tr_b16 a[228:229], v197 offset:41472
  v_mfma_f32_16x16x32_bf16 a[76:79], a[208:211], v[76:79], a[76:79]
  s_waitcnt lgkmcnt(3)
  v_exp_f32 v135, v135
  v_mfma_f32_16x16x32_bf16 v[144:147], a[192:195], a[128:131], v[160:163]
  v_mfma_f32_16x16x32_bf16 v[144:147], a[196:199], a[132:135], v[144:147]
  v_exp_f32 v136, v136
  v_mfma_f32_16x16x32_bf16 v[144:147], a[200:203], a[136:139], v[144:147]
  ds_read_b64_tr_b16 a[230:231], v197 offset:45568
  v_cvt_pk_bf16_f32 v37, v134, v135
  v_mfma_f32_16x16x32_bf16 v[144:147], a[204:207], a[140:143], v[144:147]
  v_exp_f32 v137, v137
  v_mfma_f32_16x16x32_bf16 v[148:151], a[204:207], a[156:159], v[164:167]
  ds_read_b64_tr_b16 a[232:233], v197 offset:49664
  v_cvt_pk_bf16_f32 v40, v136, v137
  v_mfma_f32_16x16x32_bf16 v[148:151], a[200:203], a[152:155], v[148:151]
  v_exp_f32 v138, v138
  v_mfma_f32_16x16x32_bf16 v[148:151], a[196:199], a[148:151], v[148:151]
  ds_read_b64_tr_b16 a[234:235], v197 offset:53760
  v_mfma_f32_16x16x32_bf16 v[148:151], a[192:195], a[144:147], v[148:151]
  v_exp_f32 v139, v139
  v_mfma_f32_16x16x32_bf16 v[152:155], a[192:195], a[160:163], v[168:171]
  ds_read_b64_tr_b16 a[236:237], v197 offset:57856
  v_cvt_pk_bf16_f32 v41, v138, v139
  v_mfma_f32_16x16x32_bf16 v[152:155], a[196:199], a[164:167], v[152:155]
  v_exp_f32 v140, v140
  v_mfma_f32_16x16x32_bf16 v[152:155], a[200:203], a[168:171], v[152:155]
  ds_read_b64_tr_b16 a[238:239], v197 offset:61952
  v_mfma_f32_16x16x32_bf16 v[152:155], a[204:207], a[172:175], v[152:155]
  v_exp_f32 v141, v141
  v_mfma_f32_16x16x32_bf16 v[156:159], a[204:207], a[188:191], v[172:175]
  v_mfma_f32_16x16x32_bf16 v[156:159], a[200:203], a[184:187], v[156:159]
  v_exp_f32 v142, v142
  v_mfma_f32_16x16x32_bf16 v[156:159], a[196:199], a[180:183], v[156:159]
  v_cvt_pk_bf16_f32 v44, v140, v141
  v_mfma_f32_16x16x32_bf16 v[156:159], a[192:195], a[176:179], v[156:159]
  s_waitcnt lgkmcnt(0)
  v_exp_f32 v143, v143
  v_smfmac_f32_16x16x64_bf16 v[180:183], v[212:215], v[72:79], v184
  v_mfma_f32_16x16x32_bf16 a[80:83], a[224:227], v[64:67], a[80:83]
  ds_read_b128 a[192:195], v192 offset:57344
  v_cvt_pk_bf16_f32 v45, v142, v143
  v_mfma_f32_16x16x32_bf16 a[80:83], a[228:231], v[80:83], a[80:83]
  v_exp_f32 v144, v144
  v_mfma_f32_16x16x32_bf16 a[80:83], a[232:235], v[96:99], a[80:83]
  ds_read_b128 a[196:199], v193 offset:57344
  v_mfma_f32_16x16x32_bf16 a[80:83], a[236:239], v[112:115], a[80:83]
  v_exp_f32 v145, v145
  v_mfma_f32_16x16x32_bf16 a[84:87], a[236:239], v[116:119], a[84:87]
  v_mfma_f32_16x16x32_bf16 a[84:87], a[232:235], v[100:103], a[84:87]
  v_exp_f32 v146, v146
  v_mfma_f32_16x16x32_bf16 a[84:87], a[228:231], v[84:87], a[84:87]
  ds_read_b128 a[200:203], v194 offset:57344
  v_cvt_pk_bf16_f32 v34, v144, v145
  v_mfma_f32_16x16x32_bf16 a[84:87], a[224:227], v[68:71], a[84:87]
  v_exp_f32 v147, v147
  v_mfma_f32_16x16x32_bf16 a[88:91], a[224:227], v[72:75], a[88:91]
  ds_read_b128 a[204:207], v195 offset:57344
  v_cvt_pk_bf16_f32 v35, v146, v147
  v_mfma_f32_16x16x32_bf16 a[88:91], a[228:231], v[88:91], a[88:91]
  v_exp_f32 v148, v148
  v_mfma_f32_16x16x32_bf16 a[88:91], a[232:235], v[104:107], a[88:91]
  ds_read_b64_tr_b16 a[208:209], v198 offset:33280
  v_mfma_f32_16x16x32_bf16 a[88:91], a[236:239], v[120:123], a[88:91]
  v_exp_f32 v149, v149
  v_mfma_f32_16x16x32_bf16 a[92:95], a[236:239], v[124:127], a[92:95]
  ds_read_b64_tr_b16 a[210:211], v198 offset:37376
  v_cvt_pk_bf16_f32 v38, v148, v149
  v_mfma_f32_16x16x32_bf16 a[92:95], a[232:235], v[108:111], a[92:95]
  v_exp_f32 v150, v150
  v_mfma_f32_16x16x32_bf16 a[92:95], a[228:231], v[92:95], a[92:95]
  ds_read_b64_tr_b16 a[212:213], v198 offset:41472
  v_mfma_f32_16x16x32_bf16 a[92:95], a[224:227], v[76:79], a[92:95]
  s_waitcnt lgkmcnt(3)
  v_exp_f32 v151, v151
  v_mfma_f32_16x16x32_bf16 v[128:131], a[192:195], a[128:131], v[160:163]
  v_mfma_f32_16x16x32_bf16 v[128:131], a[196:199], a[132:135], v[128:131]
  v_exp_f32 v152, v152
  v_mfma_f32_16x16x32_bf16 v[128:131], a[200:203], a[136:139], v[128:131]
  ds_read_b64_tr_b16 a[214:215], v198 offset:45568
  v_cvt_pk_bf16_f32 v39, v150, v151
  v_mfma_f32_16x16x32_bf16 v[128:131], a[204:207], a[140:143], v[128:131]
  v_exp_f32 v153, v153
  v_mfma_f32_16x16x32_bf16 v[132:135], a[204:207], a[156:159], v[164:167]
  ds_read_b64_tr_b16 a[216:217], v198 offset:49664
  v_cvt_pk_bf16_f32 v42, v152, v153
  v_mfma_f32_16x16x32_bf16 v[132:135], a[200:203], a[152:155], v[132:135]
  v_exp_f32 v154, v154
  v_mfma_f32_16x16x32_bf16 v[132:135], a[196:199], a[148:151], v[132:135]
  ds_read_b64_tr_b16 a[218:219], v198 offset:53760
  v_mfma_f32_16x16x32_bf16 v[132:135], a[192:195], a[144:147], v[132:135]
  v_exp_f32 v155, v155
  v_mfma_f32_16x16x32_bf16 v[136:139], a[192:195], a[160:163], v[168:171]
  ds_read_b64_tr_b16 a[220:221], v198 offset:57856
  v_cvt_pk_bf16_f32 v43, v154, v155
  v_mfma_f32_16x16x32_bf16 v[136:139], a[196:199], a[164:167], v[136:139]
  v_exp_f32 v156, v156
  v_mfma_f32_16x16x32_bf16 v[136:139], a[200:203], a[168:171], v[136:139]
  ds_read_b64_tr_b16 a[222:223], v198 offset:61952
  v_mfma_f32_16x16x32_bf16 v[136:139], a[204:207], a[172:175], v[136:139]
  v_exp_f32 v157, v157
  v_mfma_f32_16x16x32_bf16 v[140:143], a[204:207], a[188:191], v[172:175]
  v_mfma_f32_16x16x32_bf16 v[140:143], a[200:203], a[184:187], v[140:143]
  v_exp_f32 v158, v158
  v_mfma_f32_16x16x32_bf16 v[140:143], a[196:199], a[180:183], v[140:143]
  v_cvt_pk_bf16_f32 v46, v156, v157
  v_mfma_f32_16x16x32_bf16 v[140:143], a[192:195], a[176:179], v[140:143]
  s_waitcnt lgkmcnt(0)
  v_exp_f32 v159, v159
  v_smfmac_f32_16x16x64_bf16 v[180:183], v[212:215], v[88:95], v184
  v_mfma_f32_16x16x32_bf16 a[96:99], a[208:211], v[64:67], a[96:99]
  ds_read_b128 a[192:195], v192 offset:61440
  v_cvt_pk_bf16_f32 v47, v158, v159
  v_mfma_f32_16x16x32_bf16 a[96:99], a[212:215], v[80:83], a[96:99]
  v_exp_f32 v128, v128
  v_mfma_f32_16x16x32_bf16 a[96:99], a[216:219], v[96:99], a[96:99]
  ds_read_b128 a[196:199], v193 offset:61440
  v_mfma_f32_16x16x32_bf16 a[96:99], a[220:223], v[112:115], a[96:99]
  v_exp_f32 v129, v129
  v_mfma_f32_16x16x32_bf16 a[100:103], a[220:223], v[116:119], a[100:103]
  v_mfma_f32_16x16x32_bf16 a[100:103], a[216:219], v[100:103], a[100:103]
  v_exp_f32 v130, v130
  v_mfma_f32_16x16x32_bf16 a[100:103], a[212:215], v[84:87], a[100:103]
  ds_read_b128 a[200:203], v194 offset:61440
  v_cvt_pk_bf16_f32 v48, v128, v129
  v_mfma_f32_16x16x32_bf16 a[100:103], a[208:211], v[68:71], a[100:103]
  v_exp_f32 v131, v131
  v_mfma_f32_16x16x32_bf16 a[104:107], a[208:211], v[72:75], a[104:107]
  ds_read_b128 a[204:207], v195 offset:61440
  v_cvt_pk_bf16_f32 v49, v130, v131
  v_mfma_f32_16x16x32_bf16 a[104:107], a[212:215], v[88:91], a[104:107]
  v_exp_f32 v132, v132
  v_mfma_f32_16x16x32_bf16 a[104:107], a[216:219], v[104:107], a[104:107]
  ds_read_b64_tr_b16 a[224:225], v199 offset:33280
  v_mfma_f32_16x16x32_bf16 a[104:107], a[220:223], v[120:123], a[104:107]
  v_exp_f32 v133, v133
  v_mfma_f32_16x16x32_bf16 a[108:111], a[220:223], v[124:127], a[108:111]
  ds_read_b64_tr_b16 a[226:227], v199 offset:37376
  v_cvt_pk_bf16_f32 v52, v132, v133
  v_mfma_f32_16x16x32_bf16 a[108:111], a[216:219], v[108:111], a[108:111]
  v_exp_f32 v134, v134
  v_mfma_f32_16x16x32_bf16 a[108:111], a[212:215], v[92:95], a[108:111]
  ds_read_b64_tr_b16 a[228:229], v199 offset:41472
  v_mfma_f32_16x16x32_bf16 a[108:111], a[208:211], v[76:79], a[108:111]
  s_waitcnt lgkmcnt(3)
  v_exp_f32 v135, v135
  v_mfma_f32_16x16x32_bf16 v[144:147], a[192:195], a[128:131], v[160:163]
  v_mfma_f32_16x16x32_bf16 v[144:147], a[196:199], a[132:135], v[144:147]
  v_exp_f32 v136, v136
  v_mfma_f32_16x16x32_bf16 v[144:147], a[200:203], a[136:139], v[144:147]
  ds_read_b64_tr_b16 a[230:231], v199 offset:45568
  v_cvt_pk_bf16_f32 v53, v134, v135
  v_mfma_f32_16x16x32_bf16 v[144:147], a[204:207], a[140:143], v[144:147]
  v_exp_f32 v137, v137
  v_mfma_f32_16x16x32_bf16 v[148:151], a[204:207], a[156:159], v[164:167]
  ds_read_b64_tr_b16 a[232:233], v199 offset:49664
  v_cvt_pk_bf16_f32 v56, v136, v137
  v_mfma_f32_16x16x32_bf16 v[148:151], a[200:203], a[152:155], v[148:151]
  v_exp_f32 v138, v138
  v_mfma_f32_16x16x32_bf16 v[148:151], a[196:199], a[148:151], v[148:151]
  ds_read_b64_tr_b16 a[234:235], v199 offset:53760
  v_mfma_f32_16x16x32_bf16 v[148:151], a[192:195], a[144:147], v[148:151]
  v_exp_f32 v139, v139
  v_mfma_f32_16x16x32_bf16 v[152:155], a[192:195], a[160:163], v[168:171]
  ds_read_b64_tr_b16 a[236:237], v199 offset:57856
  v_cvt_pk_bf16_f32 v57, v138, v139
  v_mfma_f32_16x16x32_bf16 v[152:155], a[196:199], a[164:167], v[152:155]
  v_exp_f32 v140, v140
  v_mfma_f32_16x16x32_bf16 v[152:155], a[200:203], a[168:171], v[152:155]
  ds_read_b64_tr_b16 a[238:239], v199 offset:61952
  v_mfma_f32_16x16x32_bf16 v[152:155], a[204:207], a[172:175], v[152:155]
  s_add_u32 s52, s52, 32768
  v_exp_f32 v141, v141
  v_mfma_f32_16x16x32_bf16 v[156:159], a[204:207], a[188:191], v[172:175]
  v_mfma_f32_16x16x32_bf16 v[156:159], a[200:203], a[184:187], v[156:159]
  v_exp_f32 v142, v142
  v_mfma_f32_16x16x32_bf16 v[156:159], a[196:199], a[180:183], v[156:159]
  v_cvt_pk_bf16_f32 v60, v140, v141
  v_mfma_f32_16x16x32_bf16 v[156:159], a[192:195], a[176:179], v[156:159]
  v_exp_f32 v143, v143
  v_smfmac_f32_16x16x64_bf16 v[180:183], v[212:215], v[104:111], v184
  s_waitcnt vmcnt(4) lgkmcnt(0)
  s_barrier
  v_mfma_f32_16x16x32_bf16 a[112:115], a[224:227], v[64:67], a[112:115]
  ds_read_b128 a[192:195], v192 offset:0
  v_cvt_pk_bf16_f32 v61, v142, v143
  v_mfma_f32_16x16x32_bf16 a[112:115], a[228:231], v[80:83], a[112:115]
  s_add_u32 m0, s53, 32768
  v_exp_f32 v144, v144
  v_mfma_f32_16x16x32_bf16 a[112:115], a[232:235], v[96:99], a[112:115]
  ds_read_b128 a[196:199], v193 offset:0
  v_mfma_f32_16x16x32_bf16 a[112:115], a[236:239], v[112:115], a[112:115]
  s_add_u32 s48, s52, 65536
  v_exp_f32 v145, v145
  v_mfma_f32_16x16x32_bf16 a[116:119], a[236:239], v[116:119], a[116:119]
  buffer_load_dwordx4 v200, s[12:15], s48 offen lds
  v_mfma_f32_16x16x32_bf16 a[116:119], a[232:235], v[100:103], a[116:119]
  v_exp_f32 v146, v146
  v_mfma_f32_16x16x32_bf16 a[116:119], a[228:231], v[84:87], a[116:119]
  ds_read_b128 a[200:203], v194 offset:0
  v_cvt_pk_bf16_f32 v50, v144, v145
  v_mfma_f32_16x16x32_bf16 a[116:119], a[224:227], v[68:71], a[116:119]
  v_exp_f32 v147, v147
  v_mfma_f32_16x16x32_bf16 a[120:123], a[224:227], v[72:75], a[120:123]
  ds_read_b128 a[204:207], v195 offset:0
  v_cvt_pk_bf16_f32 v51, v146, v147
  v_mfma_f32_16x16x32_bf16 a[120:123], a[228:231], v[88:91], a[120:123]
  v_exp_f32 v148, v148
  v_mfma_f32_16x16x32_bf16 a[120:123], a[232:235], v[104:107], a[120:123]
  ds_read_b64_tr_b16 a[208:209], v196 offset:0
  v_mfma_f32_16x16x32_bf16 a[120:123], a[236:239], v[120:123], a[120:123]
  v_exp_f32 v149, v149
  v_mfma_f32_16x16x32_bf16 a[124:127], a[236:239], v[124:127], a[124:127]
  ds_read_b64_tr_b16 a[210:211], v196 offset:4096
  v_cvt_pk_bf16_f32 v54, v148, v149
  v_mfma_f32_16x16x32_bf16 a[124:127], a[232:235], v[108:111], a[124:127]
  v_exp_f32 v150, v150
  v_mfma_f32_16x16x32_bf16 a[124:127], a[228:231], v[92:95], a[124:127]
  ds_read_b64_tr_b16 a[212:213], v196 offset:8192
  v_mfma_f32_16x16x32_bf16 a[124:127], a[224:227], v[76:79], a[124:127]
  s_waitcnt lgkmcnt(3)
  v_exp_f32 v151, v151
  v_mfma_f32_16x16x32_bf16 v[128:131], a[192:195], a[128:131], v[160:163]
  buffer_load_dwordx4 v201, s[12:15], s48 offen offset:1024 lds
  v_mfma_f32_16x16x32_bf16 v[128:131], a[196:199], a[132:135], v[128:131]
  v_exp_f32 v152, v152
  v_mfma_f32_16x16x32_bf16 v[128:131], a[200:203], a[136:139], v[128:131]
  ds_read_b64_tr_b16 a[214:215], v196 offset:12288
  v_cvt_pk_bf16_f32 v55, v150, v151
  v_mfma_f32_16x16x32_bf16 v[128:131], a[204:207], a[140:143], v[128:131]
  v_exp_f32 v153, v153
  v_mfma_f32_16x16x32_bf16 v[132:135], a[204:207], a[156:159], v[164:167]
  ds_read_b64_tr_b16 a[216:217], v196 offset:16384
  v_cvt_pk_bf16_f32 v58, v152, v153
  v_mfma_f32_16x16x32_bf16 v[132:135], a[200:203], a[152:155], v[132:135]
  v_exp_f32 v154, v154
  v_mfma_f32_16x16x32_bf16 v[132:135], a[196:199], a[148:151], v[132:135]
  ds_read_b64_tr_b16 a[218:219], v196 offset:20480
  v_mfma_f32_16x16x32_bf16 v[132:135], a[192:195], a[144:147], v[132:135]
  v_exp_f32 v155, v155
  v_mfma_f32_16x16x32_bf16 v[136:139], a[192:195], a[160:163], v[168:171]
  ds_read_b64_tr_b16 a[220:221], v196 offset:24576
  v_cvt_pk_bf16_f32 v59, v154, v155
  v_mfma_f32_16x16x32_bf16 v[136:139], a[196:199], a[164:167], v[136:139]
  v_exp_f32 v156, v156
  v_mfma_f32_16x16x32_bf16 v[136:139], a[200:203], a[168:171], v[136:139]
  ds_read_b64_tr_b16 a[222:223], v196 offset:28672
  v_mfma_f32_16x16x32_bf16 v[136:139], a[204:207], a[172:175], v[136:139]
  v_exp_f32 v157, v157
  v_mfma_f32_16x16x32_bf16 v[140:143], a[204:207], a[188:191], v[172:175]
  buffer_load_dwordx4 v202, s[12:15], s48 offen offset:2048 lds
  v_mfma_f32_16x16x32_bf16 v[140:143], a[200:203], a[184:187], v[140:143]
  v_exp_f32 v158, v158
  v_mfma_f32_16x16x32_bf16 v[140:143], a[196:199], a[180:183], v[140:143]
  v_cvt_pk_bf16_f32 v62, v156, v157
  v_mfma_f32_16x16x32_bf16 v[140:143], a[192:195], a[176:179], v[140:143]
  s_waitcnt lgkmcnt(0)
  v_exp_f32 v159, v159
  v_smfmac_f32_16x16x64_bf16 v[180:183], v[212:215], v[120:127], v184
  buffer_load_dwordx4 v203, s[12:15], s48 offen offset:3072 lds
  v_mfma_f32_16x16x32_bf16 a[0:3], a[208:211], v[0:3], a[0:3]
  ds_read_b128 a[192:195], v192 offset:4096
  v_cvt_pk_bf16_f32 v63, v158, v159
  v_mfma_f32_16x16x32_bf16 a[0:3], a[212:215], v[16:19], a[0:3]
  s_add_u32 m0, s53, 36864
  v_exp_f32 v128, v128
  v_mfma_f32_16x16x32_bf16 a[0:3], a[216:219], v[32:35], a[0:3]
  ds_read_b128 a[196:199], v193 offset:4096
  v_mfma_f32_16x16x32_bf16 a[0:3], a[220:223], v[48:51], a[0:3]
  s_add_u32 s48, s52, 69632
  v_exp_f32 v129, v129
  v_mfma_f32_16x16x32_bf16 a[4:7], a[220:223], v[52:55], a[4:7]
  buffer_load_dwordx4 v200, s[12:15], s48 offen lds
  v_mfma_f32_16x16x32_bf16 a[4:7], a[216:219], v[36:39], a[4:7]
  v_exp_f32 v130, v130
  v_mfma_f32_16x16x32_bf16 a[4:7], a[212:215], v[20:23], a[4:7]
  ds_read_b128 a[200:203], v194 offset:4096
  v_cvt_pk_bf16_f32 v64, v128, v129
  v_mfma_f32_16x16x32_bf16 a[4:7], a[208:211], v[4:7], a[4:7]
  v_exp_f32 v131, v131
  v_mfma_f32_16x16x32_bf16 a[8:11], a[208:211], v[8:11], a[8:11]
  ds_read_b128 a[204:207], v195 offset:4096
  v_cvt_pk_bf16_f32 v65, v130, v131
  v_mfma_f32_16x16x32_bf16 a[8:11], a[212:215], v[24:27], a[8:11]
  v_exp_f32 v132, v132
  v_mfma_f32_16x16x32_bf16 a[8:11], a[216:219], v[40:43], a[8:11]
  ds_read_b64_tr_b16 a[224:225], v197 offset:0
  v_mfma_f32_16x16x32_bf16 a[8:11], a[220:223], v[56:59], a[8:11]
  v_exp_f32 v133, v133
  v_mfma_f32_16x16x32_bf16 a[12:15], a[220:223], v[60:63], a[12:15]
  ds_read_b64_tr_b16 a[226:227], v197 offset:4096
  v_cvt_pk_bf16_f32 v68, v132, v133
  v_mfma_f32_16x16x32_bf16 a[12:15], a[216:219], v[44:47], a[12:15]
  v_exp_f32 v134, v134
  v_mfma_f32_16x16x32_bf16 a[12:15], a[212:215], v[28:31], a[12:15]
  ds_read_b64_tr_b16 a[228:229], v197 offset:8192
  v_mfma_f32_16x16x32_bf16 a[12:15], a[208:211], v[12:15], a[12:15]
  s_waitcnt lgkmcnt(3)
  v_exp_f32 v135, v135
  v_mfma_f32_16x16x32_bf16 v[144:147], a[192:195], a[128:131], v[160:163]
  buffer_load_dwordx4 v201, s[12:15], s48 offen offset:1024 lds
  v_mfma_f32_16x16x32_bf16 v[144:147], a[196:199], a[132:135], v[144:147]
  v_exp_f32 v136, v136
  v_mfma_f32_16x16x32_bf16 v[144:147], a[200:203], a[136:139], v[144:147]
  ds_read_b64_tr_b16 a[230:231], v197 offset:12288
  v_cvt_pk_bf16_f32 v69, v134, v135
  v_mfma_f32_16x16x32_bf16 v[144:147], a[204:207], a[140:143], v[144:147]
  v_exp_f32 v137, v137
  v_mfma_f32_16x16x32_bf16 v[148:151], a[204:207], a[156:159], v[164:167]
  ds_read_b64_tr_b16 a[232:233], v197 offset:16384
  v_cvt_pk_bf16_f32 v72, v136, v137
  v_mfma_f32_16x16x32_bf16 v[148:151], a[200:203], a[152:155], v[148:151]
  v_exp_f32 v138, v138
  v_mfma_f32_16x16x32_bf16 v[148:151], a[196:199], a[148:151], v[148:151]
  ds_read_b64_tr_b16 a[234:235], v197 offset:20480
  v_mfma_f32_16x16x32_bf16 v[148:151], a[192:195], a[144:147], v[148:151]
  v_exp_f32 v139, v139
  v_mfma_f32_16x16x32_bf16 v[152:155], a[192:195], a[160:163], v[168:171]
  ds_read_b64_tr_b16 a[236:237], v197 offset:24576
  v_cvt_pk_bf16_f32 v73, v138, v139
  v_mfma_f32_16x16x32_bf16 v[152:155], a[196:199], a[164:167], v[152:155]
  v_exp_f32 v140, v140
  v_mfma_f32_16x16x32_bf16 v[152:155], a[200:203], a[168:171], v[152:155]
  ds_read_b64_tr_b16 a[238:239], v197 offset:28672
  v_mfma_f32_16x16x32_bf16 v[152:155], a[204:207], a[172:175], v[152:155]
  v_exp_f32 v141, v141
  v_mfma_f32_16x16x32_bf16 v[156:159], a[204:207], a[188:191], v[172:175]
  buffer_load_dwordx4 v202, s[12:15], s48 offen offset:2048 lds
  v_mfma_f32_16x16x32_bf16 v[156:159], a[200:203], a[184:187], v[156:159]
  v_exp_f32 v142, v142
  v_mfma_f32_16x16x32_bf16 v[156:159], a[196:199], a[180:183], v[156:159]
  v_cvt_pk_bf16_f32 v76, v140, v141
  v_mfma_f32_16x16x32_bf16 v[156:159], a[192:195], a[176:179], v[156:159]
  s_waitcnt lgkmcnt(0)
  v_exp_f32 v143, v143
  v_smfmac_f32_16x16x64_bf16 v[176:179], v[212:215], v[0:7], v184
  buffer_load_dwordx4 v203, s[12:15], s48 offen offset:3072 lds
  v_mfma_f32_16x16x32_bf16 a[16:19], a[224:227], v[0:3], a[16:19]
L_hop8:
  s_cbranch_execz L_hop12
  ds_read_b128 a[192:195], v192 offset:8192
  v_cvt_pk_bf16_f32 v77, v142, v143
  v_mfma_f32_16x16x32_bf16 a[16:19], a[228:231], v[16:19], a[16:19]
  s_add_u32 m0, s53, 131072
  v_exp_f32 v144, v144
  v_mfma_f32_16x16x32_bf16 a[16:19], a[232:235], v[32:35], a[16:19]
  ds_read_b128 a[196:199], v193 offset:8192
  v_mfma_f32_16x16x32_bf16 a[16:19], a[236:239], v[48:51], a[16:19]
  s_add_u32 s48, s52, 32768
  v_exp_f32 v145, v145
  v_mfma_f32_16x16x32_bf16 a[20:23], a[236:239], v[52:55], a[20:23]
  buffer_load_dwordx4 v204, s[16:19], s48 offen lds
  v_mfma_f32_16x16x32_bf16 a[20:23], a[232:235], v[36:39], a[20:23]
  v_exp_f32 v146, v146
  v_mfma_f32_16x16x32_bf16 a[20:23], a[228:231], v[20:23], a[20:23]
  ds_read_b128 a[200:203], v194 offset:8192
  v_cvt_pk_bf16_f32 v66, v144, v145
  v_mfma_f32_16x16x32_bf16 a[20:23], a[224:227], v[4:7], a[20:23]
  v_exp_f32 v147, v147
  v_mfma_f32_16x16x32_bf16 a[24:27], a[224:227], v[8:11], a[24:27]
  ds_read_b128 a[204:207], v195 offset:8192
  v_cvt_pk_bf16_f32 v67, v146, v147
  v_mfma_f32_16x16x32_bf16 a[24:27], a[228:231], v[24:27], a[24:27]
  v_exp_f32 v148, v148
  v_mfma_f32_16x16x32_bf16 a[24:27], a[232:235], v[40:43], a[24:27]
  ds_read_b64_tr_b16 a[208:209], v198 offset:0
  v_mfma_f32_16x16x32_bf16 a[24:27], a[236:239], v[56:59], a[24:27]
  v_exp_f32 v149, v149
  v_mfma_f32_16x16x32_bf16 a[28:31], a[236:239], v[60:63], a[28:31]
  ds_read_b64_tr_b16 a[210:211], v198 offset:4096
  v_cvt_pk_bf16_f32 v70, v148, v149
  v_mfma_f32_16x16x32_bf16 a[28:31], a[232:235], v[44:47], a[28:31]
  v_exp_f32 v150, v150
  v_mfma_f32_16x16x32_bf16 a[28:31], a[228:231], v[28:31], a[28:31]
  ds_read_b64_tr_b16 a[212:213], v198 offset:8192
  v_mfma_f32_16x16x32_bf16 a[28:31], a[224:227], v[12:15], a[28:31]
  s_waitcnt lgkmcnt(3)
  v_exp_f32 v151, v151
  v_mfma_f32_16x16x32_bf16 v[128:131], a[192:195], a[128:131], v[160:163]
  buffer_load_dwordx4 v205, s[16:19], s48 offen offset:1024 lds
  v_mfma_f32_16x16x32_bf16 v[128:131], a[196:199], a[132:135], v[128:131]
  v_exp_f32 v152, v152
  v_mfma_f32_16x16x32_bf16 v[128:131], a[200:203], a[136:139], v[128:131]
  ds_read_b64_tr_b16 a[214:215], v198 offset:12288
  v_cvt_pk_bf16_f32 v71, v150, v151
  v_mfma_f32_16x16x32_bf16 v[128:131], a[204:207], a[140:143], v[128:131]
  v_exp_f32 v153, v153
  v_mfma_f32_16x16x32_bf16 v[132:135], a[204:207], a[156:159], v[164:167]
  ds_read_b64_tr_b16 a[216:217], v198 offset:16384
  v_cvt_pk_bf16_f32 v74, v152, v153
  v_mfma_f32_16x16x32_bf16 v[132:135], a[200:203], a[152:155], v[132:135]
  v_exp_f32 v154, v154
  v_mfma_f32_16x16x32_bf16 v[132:135], a[196:199], a[148:151], v[132:135]
  ds_read_b64_tr_b16 a[218:219], v198 offset:20480
  v_mfma_f32_16x16x32_bf16 v[132:135], a[192:195], a[144:147], v[132:135]
  v_exp_f32 v155, v155
  v_mfma_f32_16x16x32_bf16 v[136:139], a[192:195], a[160:163], v[168:171]
  ds_read_b64_tr_b16 a[220:221], v198 offset:24576
  v_cvt_pk_bf16_f32 v75, v154, v155
  v_mfma_f32_16x16x32_bf16 v[136:139], a[196:199], a[164:167], v[136:139]
  v_exp_f32 v156, v156
  v_mfma_f32_16x16x32_bf16 v[136:139], a[200:203], a[168:171], v[136:139]
  ds_read_b64_tr_b16 a[222:223], v198 offset:28672
  v_mfma_f32_16x16x32_bf16 v[136:139], a[204:207], a[172:175], v[136:139]
  v_exp_f32 v157, v157
  v_mfma_f32_16x16x32_bf16 v[140:143], a[204:207], a[188:191], v[172:175]
  buffer_load_dwordx4 v204, s[16:19], s48 offen offset:2048 lds
  v_mfma_f32_16x16x32_bf16 v[140:143], a[200:203], a[184:187], v[140:143]
  v_exp_f32 v158, v158
  v_mfma_f32_16x16x32_bf16 v[140:143], a[196:199], a[180:183], v[140:143]
  v_cvt_pk_bf16_f32 v78, v156, v157
  v_mfma_f32_16x16x32_bf16 v[140:143], a[192:195], a[176:179], v[140:143]
  s_waitcnt lgkmcnt(0)
  v_exp_f32 v159, v159
  v_smfmac_f32_16x16x64_bf16 v[176:179], v[212:215], v[16:23], v184
  buffer_load_dwordx4 v205, s[16:19], s48 offen offset:3072 lds
  v_mfma_f32_16x16x32_bf16 a[32:35], a[208:211], v[0:3], a[32:35]
  ds_read_b128 a[192:195], v192 offset:12288
  v_cvt_pk_bf16_f32 v79, v158, v159
  v_mfma_f32_16x16x32_bf16 a[32:35], a[212:215], v[16:19], a[32:35]
  s_add_u32 m0, s53, 135168
  v_exp_f32 v128, v128
  v_mfma_f32_16x16x32_bf16 a[32:35], a[216:219], v[32:35], a[32:35]
  ds_read_b128 a[196:199], v193 offset:12288
  v_mfma_f32_16x16x32_bf16 a[32:35], a[220:223], v[48:51], a[32:35]
  s_add_u32 s48, s52, 36864
  v_exp_f32 v129, v129
  v_mfma_f32_16x16x32_bf16 a[36:39], a[220:223], v[52:55], a[36:39]
  buffer_load_dwordx4 v204, s[16:19], s48 offen lds
  v_mfma_f32_16x16x32_bf16 a[36:39], a[216:219], v[36:39], a[36:39]
  s_add_u32 s49, s56, s60
  v_exp_f32 v130, v130
  v_mfma_f32_16x16x32_bf16 a[36:39], a[212:215], v[20:23], a[36:39]
  ds_read_b128 a[200:203], v194 offset:12288
  v_cvt_pk_bf16_f32 v80, v128, v129
  v_mfma_f32_16x16x32_bf16 a[36:39], a[208:211], v[4:7], a[36:39]
  s_cmp_lt_u32 s60, 16384
  v_exp_f32 v131, v131
  v_mfma_f32_16x16x32_bf16 a[40:43], a[208:211], v[8:11], a[40:43]
  ds_read_b128 a[204:207], v195 offset:12288
  v_cvt_pk_bf16_f32 v81, v130, v131
  v_mfma_f32_16x16x32_bf16 a[40:43], a[212:215], v[24:27], a[40:43]
  s_cselect_b32 s49, s49, 1073741824
  v_exp_f32 v132, v132
  v_mfma_f32_16x16x32_bf16 a[40:43], a[216:219], v[40:43], a[40:43]
  ds_read_b64_tr_b16 a[224:225], v199 offset:0
  v_mfma_f32_16x16x32_bf16 a[40:43], a[220:223], v[56:59], a[40:43]
  s_add_u32 s60, s60, 4096
  v_exp_f32 v133, v133
  v_mfma_f32_16x16x32_bf16 a[44:47], a[220:223], v[60:63], a[44:47]
  ds_read_b64_tr_b16 a[226:227], v199 offset:4096
  v_cvt_pk_bf16_f32 v84, v132, v133
  v_mfma_f32_16x16x32_bf16 a[44:47], a[216:219], v[44:47], a[44:47]
  v_exp_f32 v134, v134
  v_mfma_f32_16x16x32_bf16 a[44:47], a[212:215], v[28:31], a[44:47]
  ds_read_b64_tr_b16 a[228:229], v199 offset:8192
  v_mfma_f32_16x16x32_bf16 a[44:47], a[208:211], v[12:15], a[44:47]
  s_waitcnt lgkmcnt(3)
  v_exp_f32 v135, v135
  v_mfma_f32_16x16x32_bf16 v[144:147], a[192:195], a[128:131], v[160:163]
  buffer_load_dwordx4 v205, s[16:19], s48 offen offset:1024 lds
  v_mfma_f32_16x16x32_bf16 v[144:147], a[196:199], a[132:135], v[144:147]
  v_exp_f32 v136, v136
  v_mfma_f32_16x16x32_bf16 v[144:147], a[200:203], a[136:139], v[144:147]
  ds_read_b64_tr_b16 a[230:231], v199 offset:12288
  v_cvt_pk_bf16_f32 v85, v134, v135
  v_mfma_f32_16x16x32_bf16 v[144:147], a[204:207], a[140:143], v[144:147]
  v_exp_f32 v137, v137
  v_mfma_f32_16x16x32_bf16 v[148:151], a[204:207], a[156:159], v[164:167]
  ds_read_b64_tr_b16 a[232:233], v199 offset:16384
  v_cvt_pk_bf16_f32 v88, v136, v137
  v_mfma_f32_16x16x32_bf16 v[148:151], a[200:203], a[152:155], v[148:151]
  v_exp_f32 v138, v138
  v_mfma_f32_16x16x32_bf16 v[148:151], a[196:199], a[148:151], v[148:151]
  ds_read_b64_tr_b16 a[234:235], v199 offset:20480
  v_mfma_f32_16x16x32_bf16 v[148:151], a[192:195], a[144:147], v[148:151]
  v_exp_f32 v139, v139
  v_mfma_f32_16x16x32_bf16 v[152:155], a[192:195], a[160:163], v[168:171]
  ds_read_b64_tr_b16 a[236:237], v199 offset:24576
  v_cvt_pk_bf16_f32 v89, v138, v139
  v_mfma_f32_16x16x32_bf16 v[152:155], a[196:199], a[164:167], v[152:155]
  v_exp_f32 v140, v140
  v_mfma_f32_16x16x32_bf16 v[152:155], a[200:203], a[168:171], v[152:155]
  ds_read_b64_tr_b16 a[238:239], v199 offset:28672
  v_mfma_f32_16x16x32_bf16 v[152:155], a[204:207], a[172:175], v[152:155]
  v_exp_f32 v141, v141
  v_mfma_f32_16x16x32_bf16 v[156:159], a[204:207], a[188:191], v[172:175]
  buffer_load_dwordx4 v204, s[16:19], s48 offen offset:2048 lds
  v_mfma_f32_16x16x32_bf16 v[156:159], a[200:203], a[184:187], v[156:159]
  v_exp_f32 v142, v142
  v_mfma_f32_16x16x32_bf16 v[156:159], a[196:199], a[180:183], v[156:159]
  v_cvt_pk_bf16_f32 v92, v140, v141
  v_mfma_f32_16x16x32_bf16 v[156:159], a[192:195], a[176:179], v[156:159]
  s_waitcnt lgkmcnt(0)
  v_exp_f32 v143, v143
  v_smfmac_f32_16x16x64_bf16 v[176:179], v[212:215], v[32:39], v184
  buffer_load_dwordx4 v205, s[16:19], s48 offen offset:3072 lds
  v_mfma_f32_16x16x32_bf16 a[48:51], a[224:227], v[0:3], a[48:51]
  ds_read_b128 a[192:195], v192 offset:16384
  v_cvt_pk_bf16_f32 v93, v142, v143
  v_mfma_f32_16x16x32_bf16 a[48:51], a[228:231], v[16:19], a[48:51]
  v_exp_f32 v144, v144
  v_mfma_f32_16x16x32_bf16 a[48:51], a[232:235], v[32:35], a[48:51]
  ds_read_b128 a[196:199], v193 offset:16384
  v_mfma_f32_16x16x32_bf16 a[48:51], a[236:239], v[48:51], a[48:51]
  v_exp_f32 v145, v145
  v_mfma_f32_16x16x32_bf16 a[52:55], a[236:239], v[52:55], a[52:55]
  v_mfma_f32_16x16x32_bf16 a[52:55], a[232:235], v[36:39], a[52:55]
  v_exp_f32 v146, v146
  v_mfma_f32_16x16x32_bf16 a[52:55], a[228:231], v[20:23], a[52:55]
  ds_read_b128 a[200:203], v194 offset:16384
  v_cvt_pk_bf16_f32 v82, v144, v145
  v_mfma_f32_16x16x32_bf16 a[52:55], a[224:227], v[4:7], a[52:55]
  v_exp_f32 v147, v147
  v_mfma_f32_16x16x32_bf16 a[56:59], a[224:227], v[8:11], a[56:59]
  ds_read_b128 a[204:207], v195 offset:16384
  v_cvt_pk_bf16_f32 v83, v146, v147
  v_mfma_f32_16x16x32_bf16 a[56:59], a[228:231], v[24:27], a[56:59]
  v_exp_f32 v148, v148
  v_mfma_f32_16x16x32_bf16 a[56:59], a[232:235], v[40:43], a[56:59]
  ds_read_b64_tr_b16 a[208:209], v196 offset:512
  v_mfma_f32_16x16x32_bf16 a[56:59], a[236:239], v[56:59], a[56:59]
  v_exp_f32 v149, v149
  v_mfma_f32_16x16x32_bf16 a[60:63], a[236:239], v[60:63], a[60:63]
  ds_read_b64_tr_b16 a[210:211], v196 offset:4608
  v_cvt_pk_bf16_f32 v86, v148, v149
  v_mfma_f32_16x16x32_bf16 a[60:63], a[232:235], v[44:47], a[60:63]
  v_exp_f32 v150, v150
  v_mfma_f32_16x16x32_bf16 a[60:63], a[228:231], v[28:31], a[60:63]
  ds_read_b64_tr_b16 a[212:213], v196 offset:8704
  v_mfma_f32_16x16x32_bf16 a[60:63], a[224:227], v[12:15], a[60:63]
  s_waitcnt lgkmcnt(3)
  v_exp_f32 v151, v151
  v_mfma_f32_16x16x32_bf16 v[128:131], a[192:195], a[128:131], v[160:163]
  v_mfma_f32_16x16x32_bf16 v[128:131], a[196:199], a[132:135], v[128:131]
  v_exp_f32 v152, v152
  v_mfma_f32_16x16x32_bf16 v[128:131], a[200:203], a[136:139], v[128:131]
  ds_read_b64_tr_b16 a[214:215], v196 offset:12800
  v_cvt_pk_bf16_f32 v87, v150, v151
  v_mfma_f32_16x16x32_bf16 v[128:131], a[204:207], a[140:143], v[128:131]
  v_exp_f32 v153, v153
  v_mfma_f32_16x16x32_bf16 v[132:135], a[204:207], a[156:159], v[164:167]
  ds_read_b64_tr_b16 a[216:217], v196 offset:16896
  v_cvt_pk_bf16_f32 v90, v152, v153
  v_mfma_f32_16x16x32_bf16 v[132:135], a[200:203], a[152:155], v[132:135]
  v_exp_f32 v154, v154
  v_mfma_f32_16x16x32_bf16 v[132:135], a[196:199], a[148:151], v[132:135]
  ds_read_b64_tr_b16 a[218:219], v196 offset:20992
  v_mfma_f32_16x16x32_bf16 v[132:135], a[192:195], a[144:147], v[132:135]
  v_exp_f32 v155, v155
  v_mfma_f32_16x16x32_bf16 v[136:139], a[192:195], a[160:163], v[168:171]
  ds_read_b64_tr_b16 a[220:221], v196 offset:25088
  v_cvt_pk_bf16_f32 v91, v154, v155
  v_mfma_f32_16x16x32_bf16 v[136:139], a[196:199], a[164:167], v[136:139]
  v_exp_f32 v156, v156
  v_mfma_f32_16x16x32_bf16 v[136:139], a[200:203], a[168:171], v[136:139]
  ds_read_b64_tr_b16 a[222:223], v196 offset:29184
  v_mfma_f32_16x16x32_bf16 v[136:139], a[204:207], a[172:175], v[136:139]
  v_exp_f32 v157, v157
  v_mfma_f32_16x16x32_bf16 v[140:143], a[204:207], a[188:191], v[172:175]
  buffer_store_dwordx4 a[240:243], v242, s[36:39], s49 offen sc1
  v_mfma_f32_16x16x32_bf16 v[140:143], a[200:203], a[184:187], v[140:143]
  v_exp_f32 v158, v158
  v_mfma_f32_16x16x32_bf16 v[140:143], a[196:199], a[180:183], v[140:143]
  v_cvt_pk_bf16_f32 v94, v156, v157
  v_mfma_f32_16x16x32_bf16 v[140:143], a[192:195], a[176:179], v[140:143]
  s_waitcnt lgkmcnt(0)
  v_exp_f32 v159, v159
  v_smfmac_f32_16x16x64_bf16 v[176:179], v[212:215], v[48:55], v184
  v_mfma_f32_16x16x32_bf16 a[64:67], a[208:211], v[0:3], a[64:67]
  ds_read_b128 a[192:195], v192 offset:20480
  v_cvt_pk_bf16_f32 v95, v158, v159
  v_mfma_f32_16x16x32_bf16 a[64:67], a[212:215], v[16:19], a[64:67]
  v_exp_f32 v128, v128
  v_mfma_f32_16x16x32_bf16 a[64:67], a[216:219], v[32:35], a[64:67]
  ds_read_b128 a[196:199], v193 offset:20480
  v_mfma_f32_16x16x32_bf16 a[64:67], a[220:223], v[48:51], a[64:67]
  v_exp_f32 v129, v129
  v_mfma_f32_16x16x32_bf16 a[68:71], a[220:223], v[52:55], a[68:71]
  v_mfma_f32_16x16x32_bf16 a[68:71], a[216:219], v[36:39], a[68:71]
  v_exp_f32 v130, v130
  v_mfma_f32_16x16x32_bf16 a[68:71], a[212:215], v[20:23], a[68:71]
  ds_read_b128 a[200:203], v194 offset:20480
  v_cvt_pk_bf16_f32 v96, v128, v129
  v_mfma_f32_16x16x32_bf16 a[68:71], a[208:211], v[4:7], a[68:71]
  v_exp_f32 v131, v131
  v_mfma_f32_16x16x32_bf16 a[72:75], a[208:211], v[8:11], a[72:75]
  ds_read_b128 a[204:207], v195 offset:20480
  v_cvt_pk_bf16_f32 v97, v130, v131
  v_mfma_f32_16x16x32_bf16 a[72:75], a[212:215], v[24:27], a[72:75]
  v_exp_f32 v132, v132
  v_mfma_f32_16x16x32_bf16 a[72:75], a[216:219], v[40:43], a[72:75]
  ds_read_b64_tr_b16 a[224:225], v197 offset:512
  v_mfma_f32_16x16x32_bf16 a[72:75], a[220:223], v[56:59], a[72:75]
  v_exp_f32 v133, v133
  v_mfma_f32_16x16x32_bf16 a[76:79], a[220:223], v[60:63], a[76:79]
  ds_read_b64_tr_b16 a[226:227], v197 offset:4608
  v_cvt_pk_bf16_f32 v100, v132, v133
  v_mfma_f32_16x16x32_bf16 a[76:79], a[216:219], v[44:47], a[76:79]
  v_exp_f32 v134, v134
  v_mfma_f32_16x16x32_bf16 a[76:79], a[212:215], v[28:31], a[76:79]
  ds_read_b64_tr_b16 a[228:229], v197 offset:8704
  v_mfma_f32_16x16x32_bf16 a[76:79], a[208:211], v[12:15], a[76:79]
  s_waitcnt lgkmcnt(3)
  v_exp_f32 v135, v135
  v_mfma_f32_16x16x32_bf16 v[144:147], a[192:195], a[128:131], v[160:163]
  v_mfma_f32_16x16x32_bf16 v[144:147], a[196:199], a[132:135], v[144:147]
  v_exp_f32 v136, v136
  v_mfma_f32_16x16x32_bf16 v[144:147], a[200:203], a[136:139], v[144:147]
  ds_read_b64_tr_b16 a[230:231], v197 offset:12800
  v_cvt_pk_bf16_f32 v101, v134, v135
  v_mfma_f32_16x16x32_bf16 v[144:147], a[204:207], a[140:143], v[144:147]
  v_exp_f32 v137, v137
  v_mfma_f32_16x16x32_bf16 v[148:151], a[204:207], a[156:159], v[164:167]
  ds_read_b64_tr_b16 a[232:233], v197 offset:16896
  v_cvt_pk_bf16_f32 v104, v136, v137
  v_mfma_f32_16x16x32_bf16 v[148:151], a[200:203], a[152:155], v[148:151]
  v_exp_f32 v138, v138
  v_mfma_f32_16x16x32_bf16 v[148:151], a[196:199], a[148:151], v[148:151]
  ds_read_b64_tr_b16 a[234:235], v197 offset:20992
  v_mfma_f32_16x16x32_bf16 v[148:151], a[192:195], a[144:147], v[148:151]
  v_exp_f32 v139, v139
  v_mfma_f32_16x16x32_bf16 v[152:155], a[192:195], a[160:163], v[168:171]
  ds_read_b64_tr_b16 a[236:237], v197 offset:25088
  v_cvt_pk_bf16_f32 v105, v138, v139
  v_mfma_f32_16x16x32_bf16 v[152:155], a[196:199], a[164:167], v[152:155]
  v_exp_f32 v140, v140
  v_mfma_f32_16x16x32_bf16 v[152:155], a[200:203], a[168:171], v[152:155]
  ds_read_b64_tr_b16 a[238:239], v197 offset:29184
  v_mfma_f32_16x16x32_bf16 v[152:155], a[204:207], a[172:175], v[152:155]
  v_exp_f32 v141, v141
  v_mfma_f32_16x16x32_bf16 v[156:159], a[204:207], a[188:191], v[172:175]
  buffer_store_dwordx4 a[240:243], v242, s[36:39], s49 offen offset:1024 sc1
  v_mfma_f32_16x16x32_bf16 v[156:159], a[200:203], a[184:187], v[156:159]
  v_exp_f32 v142, v142
  v_mfma_f32_16x16x32_bf16 v[156:159], a[196:199], a[180:183], v[156:159]
  v_cvt_pk_bf16_f32 v108, v140, v141
  v_mfma_f32_16x16x32_bf16 v[156:159], a[192:195], a[176:179], v[156:159]
  s_waitcnt lgkmcnt(0)
  v_exp_f32 v143, v143
  v_smfmac_f32_16x16x64_bf16 v[180:183], v[212:215], v[8:15], v184
  v_mfma_f32_16x16x32_bf16 a[80:83], a[224:227], v[0:3], a[80:83]
  ds_read_b128 a[192:195], v192 offset:24576
  v_cvt_pk_bf16_f32 v109, v142, v143
  v_mfma_f32_16x16x32_bf16 a[80:83], a[228:231], v[16:19], a[80:83]
  v_exp_f32 v144, v144
  v_mfma_f32_16x16x32_bf16 a[80:83], a[232:235], v[32:35], a[80:83]
  ds_read_b128 a[196:199], v193 offset:24576
  v_mfma_f32_16x16x32_bf16 a[80:83], a[236:239], v[48:51], a[80:83]
  v_exp_f32 v145, v145
  v_mfma_f32_16x16x32_bf16 a[84:87], a[236:239], v[52:55], a[84:87]
  v_mfma_f32_16x16x32_bf16 a[84:87], a[232:235], v[36:39], a[84:87]
  v_exp_f32 v146, v146
  v_mfma_f32_16x16x32_bf16 a[84:87], a[228:231], v[20:23], a[84:87]
  ds_read_b128 a[200:203], v194 offset:24576
  v_cvt_pk_bf16_f32 v98, v144, v145
  v_mfma_f32_16x16x32_bf16 a[84:87], a[224:227], v[4:7], a[84:87]
  v_exp_f32 v147, v147
  v_mfma_f32_16x16x32_bf16 a[88:91], a[224:227], v[8:11], a[88:91]
  ds_read_b128 a[204:207], v195 offset:24576
  v_cvt_pk_bf16_f32 v99, v146, v147
  v_mfma_f32_16x16x32_bf16 a[88:91], a[228:231], v[24:27], a[88:91]
  v_exp_f32 v148, v148
  v_mfma_f32_16x16x32_bf16 a[88:91], a[232:235], v[40:43], a[88:91]
  ds_read_b64_tr_b16 a[208:209], v198 offset:512
  v_mfma_f32_16x16x32_bf16 a[88:91], a[236:239], v[56:59], a[88:91]
  v_exp_f32 v149, v149
  v_mfma_f32_16x16x32_bf16 a[92:95], a[236:239], v[60:63], a[92:95]
  ds_read_b64_tr_b16 a[210:211], v198 offset:4608
  v_cvt_pk_bf16_f32 v102, v148, v149
  v_mfma_f32_16x16x32_bf16 a[92:95], a[232:235], v[44:47], a[92:95]
  v_exp_f32 v150, v150
  v_mfma_f32_16x16x32_bf16 a[92:95], a[228:231], v[28:31], a[92:95]
  ds_read_b64_tr_b16 a[212:213], v198 offset:8704
  v_mfma_f32_16x16x32_bf16 a[92:95], a[224:227], v[12:15], a[92:95]
  s_waitcnt lgkmcnt(3)
  v_exp_f32 v151, v151
  v_mfma_f32_16x16x32_bf16 v[128:131], a[192:195], a[128:131], v[160:163]
  v_mfma_f32_16x16x32_bf16 v[128:131], a[196:199], a[132:135], v[128:131]
  v_exp_f32 v152, v152
  v_mfma_f32_16x16x32_bf16 v[128:131], a[200:203], a[136:139], v[128:131]
  ds_read_b64_tr_b16 a[214:215], v198 offset:12800
  v_cvt_pk_bf16_f32 v103, v150, v151
  v_mfma_f32_16x16x32_bf16 v[128:131], a[204:207], a[140:143], v[128:131]
  v_exp_f32 v153, v153
  v_mfma_f32_16x16x32_bf16 v[132:135], a[204:207], a[156:159], v[164:167]
  ds_read_b64_tr_b16 a[216:217], v198 offset:16896
  v_cvt_pk_bf16_f32 v106, v152, v153
  v_mfma_f32_16x16x32_bf16 v[132:135], a[200:203], a[152:155], v[132:135]
  v_exp_f32 v154, v154
  v_mfma_f32_16x16x32_bf16 v[132:135], a[196:199], a[148:151], v[132:135]
  ds_read_b64_tr_b16 a[218:219], v198 offset:20992
  v_mfma_f32_16x16x32_bf16 v[132:135], a[192:195], a[144:147], v[132:135]
  v_exp_f32 v155, v155
  v_mfma_f32_16x16x32_bf16 v[136:139], a[192:195], a[160:163], v[168:171]
  ds_read_b64_tr_b16 a[220:221], v198 offset:25088
  v_cvt_pk_bf16_f32 v107, v154, v155
  v_mfma_f32_16x16x32_bf16 v[136:139], a[196:199], a[164:167], v[136:139]
  v_exp_f32 v156, v156
  v_mfma_f32_16x16x32_bf16 v[136:139], a[200:203], a[168:171], v[136:139]
  ds_read_b64_tr_b16 a[222:223], v198 offset:29184
  v_mfma_f32_16x16x32_bf16 v[136:139], a[204:207], a[172:175], v[136:139]
  v_exp_f32 v157, v157
  v_mfma_f32_16x16x32_bf16 v[140:143], a[204:207], a[188:191], v[172:175]
  buffer_store_dwordx4 a[240:243], v242, s[36:39], s49 offen offset:2048 sc1
  v_mfma_f32_16x16x32_bf16 v[140:143], a[200:203], a[184:187], v[140:143]
  v_exp_f32 v158, v158
  v_mfma_f32_16x16x32_bf16 v[140:143], a[196:199], a[180:183], v[140:143]
  v_cvt_pk_bf16_f32 v110, v156, v157
  v_mfma_f32_16x16x32_bf16 v[140:143], a[192:195], a[176:179], v[140:143]
  s_waitcnt lgkmcnt(0)
  v_exp_f32 v159, v159
  v_smfmac_f32_16x16x64_bf16 v[180:183], v[212:215], v[24:31], v184
  v_mfma_f32_16x16x32_bf16 a[96:99], a[208:211], v[0:3], a[96:99]
  ds_read_b128 a[192:195], v192 offset:28672
  v_cvt_pk_bf16_f32 v111, v158, v159
  v_mfma_f32_16x16x32_bf16 a[96:99], a[212:215], v[16:19], a[96:99]
  v_exp_f32 v128, v128
  v_mfma_f32_16x16x32_bf16 a[96:99], a[216:219], v[32:35], a[96:99]
  ds_read_b128 a[196:199], v193 offset:28672
  v_mfma_f32_16x16x32_bf16 a[96:99], a[220:223], v[48:51], a[96:99]
  v_exp_f32 v129, v129
  v_mfma_f32_16x16x32_bf16 a[100:103], a[220:223], v[52:55], a[100:103]
  v_mfma_f32_16x16x32_bf16 a[100:103], a[216:219], v[36:39], a[100:103]
  v_exp_f32 v130, v130
  v_mfma_f32_16x16x32_bf16 a[100:103], a[212:215], v[20:23], a[100:103]
  ds_read_b128 a[200:203], v194 offset:28672
  v_cvt_pk_bf16_f32 v112, v128, v129
  v_mfma_f32_16x16x32_bf16 a[100:103], a[208:211], v[4:7], a[100:103]
  v_exp_f32 v131, v131
  v_mfma_f32_16x16x32_bf16 a[104:107], a[208:211], v[8:11], a[104:107]
  ds_read_b128 a[204:207], v195 offset:28672
  v_cvt_pk_bf16_f32 v113, v130, v131
  v_mfma_f32_16x16x32_bf16 a[104:107], a[212:215], v[24:27], a[104:107]
  v_exp_f32 v132, v132
  v_mfma_f32_16x16x32_bf16 a[104:107], a[216:219], v[40:43], a[104:107]
  ds_read_b64_tr_b16 a[224:225], v199 offset:512
  v_mfma_f32_16x16x32_bf16 a[104:107], a[220:223], v[56:59], a[104:107]
  v_exp_f32 v133, v133
  v_mfma_f32_16x16x32_bf16 a[108:111], a[220:223], v[60:63], a[108:111]
  ds_read_b64_tr_b16 a[226:227], v199 offset:4608
  v_cvt_pk_bf16_f32 v116, v132, v133
  v_mfma_f32_16x16x32_bf16 a[108:111], a[216:219], v[44:47], a[108:111]
  v_exp_f32 v134, v134
  v_mfma_f32_16x16x32_bf16 a[108:111], a[212:215], v[28:31], a[108:111]
  ds_read_b64_tr_b16 a[228:229], v199 offset:8704
  v_mfma_f32_16x16x32_bf16 a[108:111], a[208:211], v[12:15], a[108:111]
  s_waitcnt lgkmcnt(3)
  v_exp_f32 v135, v135
  v_mfma_f32_16x16x32_bf16 v[144:147], a[192:195], a[128:131], v[160:163]
  buffer_store_dwordx4 a[240:243], v242, s[36:39], s49 offen offset:3072 sc1
  v_mfma_f32_16x16x32_bf16 v[144:147], a[196:199], a[132:135], v[144:147]
  v_exp_f32 v136, v136
  v_mfma_f32_16x16x32_bf16 v[144:147], a[200:203], a[136:139], v[144:147]
  ds_read_b64_tr_b16 a[230:231], v199 offset:12800
  v_cvt_pk_bf16_f32 v117, v134, v135
  v_mfma_f32_16x16x32_bf16 v[144:147], a[204:207], a[140:143], v[144:147]
  v_exp_f32 v137, v137
  v_mfma_f32_16x16x32_bf16 v[148:151], a[204:207], a[156:159], v[164:167]
  ds_read_b64_tr_b16 a[232:233], v199 offset:16896
  v_cvt_pk_bf16_f32 v120, v136, v137
  v_mfma_f32_16x16x32_bf16 v[148:151], a[200:203], a[152:155], v[148:151]
  v_exp_f32 v138, v138
  v_mfma_f32_16x16x32_bf16 v[148:151], a[196:199], a[148:151], v[148:151]
  ds_read_b64_tr_b16 a[234:235], v199 offset:20992
  v_mfma_f32_16x16x32_bf16 v[148:151], a[192:195], a[144:147], v[148:151]
  v_exp_f32 v139, v139
  v_mfma_f32_16x16x32_bf16 v[152:155], a[192:195], a[160:163], v[168:171]
  ds_read_b64_tr_b16 a[236:237], v199 offset:25088
  v_cvt_pk_bf16_f32 v121, v138, v139
  v_mfma_f32_16x16x32_bf16 v[152:155], a[196:199], a[164:167], v[152:155]
  s_sub_u32 s54, s54, 1
  v_exp_f32 v140, v140
  v_mfma_f32_16x16x32_bf16 v[152:155], a[200:203], a[168:171], v[152:155]
  ds_read_b64_tr_b16 a[238:239], v199 offset:29184
  v_mfma_f32_16x16x32_bf16 v[152:155], a[204:207], a[172:175], v[152:155]
  s_add_u32 s52, s52, 32768
  v_exp_f32 v141, v141
  v_mfma_f32_16x16x32_bf16 v[156:159], a[204:207], a[188:191], v[172:175]
  v_mfma_f32_16x16x32_bf16 v[156:159], a[200:203], a[184:187], v[156:159]
  s_cmp_lg_u32 s54, 0
  v_exp_f32 v142, v142
  v_mfma_f32_16x16x32_bf16 v[156:159], a[196:199], a[180:183], v[156:159]
  v_cvt_pk_bf16_f32 v124, v140, v141
  v_mfma_f32_16x16x32_bf16 v[156:159], a[192:195], a[176:179], v[156:159]
  v_exp_f32 v143, v143
  v_smfmac_f32_16x16x64_bf16 v[180:183], v[212:215], v[40:47], v184
  s_waitcnt vmcnt(4) lgkmcnt(0)
  s_cbranch_scc1 L_loop
  v_readfirstlane_b32 s50, v224
  s_nop 0
  s_cmp_lt_u32 s50, 8
  s_cbranch_scc1 L_ywait
L_yok:
  s_barrier
  v_mfma_f32_16x16x32_bf16 a[112:115], a[224:227], v[0:3], a[112:115]
  ds_read_b64_tr_b16 a[208:209], v196 offset:32768
  v_cvt_pk_bf16_f32 v125, v142, v143
  v_exp_f32 v144, v144
  v_mfma_f32_16x16x32_bf16 a[112:115], a[228:231], v[16:19], a[112:115]
  ds_read_b64_tr_b16 a[192:193], v232 offset:0
  v_exp_f32 v145, v145
  v_mfma_f32_16x16x32_bf16 a[112:115], a[232:235], v[32:35], a[112:115]
  ds_read_b64_tr_b16 a[210:211], v196 offset:36864
  v_cvt_pk_bf16_f32 v114, v144, v145
  v_exp_f32 v146, v146
  v_mfma_f32_16x16x32_bf16 a[112:115], a[236:239], v[48:51], a[112:115]
  ds_read_b64_tr_b16 a[194:195], v232 offset:2048
  v_exp_f32 v147, v147
  v_mfma_f32_16x16x32_bf16 a[116:119], a[236:239], v[52:55], a[116:119]
  ds_read_b64_tr_b16 a[212:213], v196 offset:40960
  v_cvt_pk_bf16_f32 v115, v146, v147
  v_exp_f32 v148, v148
  v_mfma_f32_16x16x32_bf16 a[116:119], a[232:235], v[36:39], a[116:119]
  ds_read_b64_tr_b16 a[196:197], v233 offset:0
  v_exp_f32 v149, v149
  v_mfma_f32_16x16x32_bf16 a[116:119], a[228:231], v[20:23], a[116:119]
  ds_read_b64_tr_b16 a[214:215], v196 offset:45056
  v_cvt_pk_bf16_f32 v118, v148, v149
  v_exp_f32 v150, v150
  v_mfma_f32_16x16x32_bf16 a[116:119], a[224:227], v[4:7], a[116:119]
  ds_read_b64_tr_b16 a[198:199], v233 offset:2048
  v_exp_f32 v151, v151
  v_mfma_f32_16x16x32_bf16 a[120:123], a[224:227], v[8:11], a[120:123]
  ds_read_b64_tr_b16 a[216:217], v196 offset:49152
  v_cvt_pk_bf16_f32 v119, v150, v151
  v_exp_f32 v152, v152
  v_mfma_f32_16x16x32_bf16 a[120:123], a[228:231], v[24:27], a[120:123]
  ds_read_b64_tr_b16 a[200:201], v234 offset:0
  v_exp_f32 v153, v153
  v_mfma_f32_16x16x32_bf16 a[120:123], a[232:235], v[40:43], a[120:123]
  ds_read_b64_tr_b16 a[218:219], v196 offset:53248
  v_cvt_pk_bf16_f32 v122, v152, v153
  v_exp_f32 v154, v154
  v_mfma_f32_16x16x32_bf16 a[120:123], a[236:239], v[56:59], a[120:123]
  ds_read_b64_tr_b16 a[202:203], v234 offset:2048
  v_exp_f32 v155, v155
  v_mfma_f32_16x16x32_bf16 a[124:127], a[236:239], v[60:63], a[124:127]
  ds_read_b64_tr_b16 a[220:221], v196 offset:57344
  v_cvt_pk_bf16_f32 v123, v154, v155
  v_exp_f32 v156, v156
  v_mfma_f32_16x16x32_bf16 a[124:127], a[232:235], v[44:47], a[124:127]
  ds_read_b64_tr_b16 a[204:205], v235 offset:0
  v_exp_f32 v157, v157
  v_mfma_f32_16x16x32_bf16 a[124:127], a[228:231], v[28:31], a[124:127]
  ds_read_b64_tr_b16 a[222:223], v196 offset:61440
  v_cvt_pk_bf16_f32 v126, v156, v157
  v_exp_f32 v158, v158
  v_mfma_f32_16x16x32_bf16 a[124:127], a[224:227], v[12:15], a[124:127]
  ds_read_b64_tr_b16 a[206:207], v235 offset:2048
  v_exp_f32 v159, v159
  v_smfmac_f32_16x16x64_bf16 v[180:183], v[212:215], v[56:63], v184
  v_cvt_pk_bf16_f32 v127, v158, v159
  v_smfmac_f32_16x16x64_bf16 v[176:179], v[212:215], v[64:71], v184
  ds_read_b64_tr_b16 a[240:241], v232 offset:4096
  v_mov_b32 v216, 0x4e800000
  v_smfmac_f32_16x16x64_bf16 v[176:179], v[212:215], v[80:87], v184
  ds_read_b64_tr_b16 a[242:243], v232 offset:6144
  v_and_b32 v217, 3, v247
  v_smfmac_f32_16x16x64_bf16 v[176:179], v[212:215], v[96:103], v184
  ds_read_b64_tr_b16 a[244:245], v233 offset:4096
  v_lshlrev_b32 v217, 14, v217
  v_smfmac_f32_16x16x64_bf16 v[176:179], v[212:215], v[112:119], v184
  s_lshl_b32 s50, s42, 2
  ds_read_b64_tr_b16 a[246:247], v233 offset:6144
  v_add_u32 v217, s50, v217
  v_smfmac_f32_16x16x64_bf16 v[180:183], v[212:215], v[72:79], v184
  s_lshl_b32 s50, s42, 14
  ds_read_b64_tr_b16 a[248:249], v234 offset:4096
  v_add_u32 v218, s50, v242
  v_smfmac_f32_16x16x64_bf16 v[180:183], v[212:215], v[88:95], v184
  ds_read_b64_tr_b16 a[250:251], v234 offset:6144
  v_mov_b32 v219, s50
  v_smfmac_f32_16x16x64_bf16 v[180:183], v[212:215], v[104:111], v184
  ds_read_b64_tr_b16 a[252:253], v235 offset:4096
  v_smfmac_f32_16x16x64_bf16 v[180:183], v[212:215], v[120:127], v184
  s_waitcnt lgkmcnt(15)
  ds_read_b64_tr_b16 a[254:255], v235 offset:6144
  v_mfma_f32_16x16x32_bf16 a[0:3], a[208:211], v[64:67], a[0:3]
  ds_read_b64_tr_b16 a[224:225], v197 offset:32768
  v_mfma_f32_16x16x32_bf16 a[0:3], a[212:215], v[80:83], a[0:3]
  s_waitcnt lgkmcnt(14)
  s_add_u32 m0, s43, 32768
  ds_read_b64_tr_b16 a[226:227], v197 offset:36864
  v_mfma_f32_16x16x32_bf16 a[0:3], a[216:219], v[96:99], a[0:3]
  s_waitcnt lgkmcnt(11)
  s_add_u32 s48, s47, 128
  ds_read_b64_tr_b16 a[228:229], v197 offset:40960
  v_mfma_f32_16x16x32_bf16 a[0:3], a[220:223], v[112:115], a[0:3]
  buffer_load_dwordx4 v243, s[24:27], s48 offen lds
  v_mfma_f32_16x16x32_bf16 a[4:7], a[220:223], v[116:119], a[4:7]
  ds_read_b64_tr_b16 a[230:231], v197 offset:45056
  v_mfma_f32_16x16x32_bf16 a[4:7], a[216:219], v[100:103], a[4:7]
  ds_read_b64_tr_b16 a[232:233], v197 offset:49152
  v_add_f32 v208, v176, v177
  v_add_f32 v209, v178, v179
  v_mfma_f32_16x16x32_bf16 a[4:7], a[212:215], v[84:87], a[4:7]
  ds_read_b64_tr_b16 a[234:235], v197 offset:53248
  v_add_f32 v210, v180, v181
  v_add_f32 v211, v182, v183
  v_mfma_f32_16x16x32_bf16 a[4:7], a[208:211], v[68:71], a[4:7]
  buffer_load_dwordx4 v244, s[24:27], s48 offen offset:1024 lds
  v_mfma_f32_16x16x32_bf16 a[8:11], a[208:211], v[72:75], a[8:11]
  ds_read_b64_tr_b16 a[236:237], v197 offset:57344
  v_mov_b32 v220, v208
  v_mov_b32 v221, v209
  v_mfma_f32_16x16x32_bf16 a[8:11], a[212:215], v[88:91], a[8:11]
  ds_read_b64_tr_b16 a[238:239], v197 offset:61440
  v_mov_b32 v222, v210
  v_mov_b32 v223, v211
  v_mfma_f32_16x16x32_bf16 a[8:11], a[216:219], v[104:107], a[8:11]
  v_permlane32_swap_b32 v208, v220
  v_mfma_f32_16x16x32_bf16 a[8:11], a[220:223], v[120:123], a[8:11]
  buffer_load_dwordx4 v245, s[24:27], s48 offen offset:2048 lds
  v_mfma_f32_16x16x32_bf16 a[12:15], a[220:223], v[124:127], a[12:15]
  v_permlane32_swap_b32 v209, v221
  v_permlane32_swap_b32 v210, v222
  v_mfma_f32_16x16x32_bf16 a[12:15], a[216:219], v[108:111], a[12:15]
  v_permlane32_swap_b32 v211, v223
  v_add_f32 v208, v208, v220
  v_mfma_f32_16x16x32_bf16 a[12:15], a[212:215], v[92:95], a[12:15]
  v_add_f32 v209, v209, v221
  v_add_f32 v210, v210, v222
  v_add_f32 v211, v211, v223
  v_mfma_f32_16x16x32_bf16 a[12:15], a[208:211], v[76:79], a[12:15]
  s_waitcnt lgkmcnt(6)
  buffer_load_dwordx4 v246, s[24:27], s48 offen offset:3072 lds
  v_mfma_f32_16x16x32_bf16 a[16:19], a[224:227], v[64:67], a[16:19]
  s_waitcnt lgkmcnt(4)
  ds_read_b64_tr_b16 a[208:209], v198 offset:32768
  v_mov_b32 v220, v208
  v_mov_b32 v221, v209
  v_mfma_f32_16x16x32_bf16 a[16:19], a[228:231], v[80:83], a[16:19]
L_hop9:
  s_cbranch_execz L_hop13
  s_waitcnt lgkmcnt(3)
  s_add_u32 m0, s43, 36864
  ds_read_b64_tr_b16 a[210:211], v198 offset:36864
  v_mov_b32 v222, v210
  v_mov_b32 v223, v211
  v_mfma_f32_16x16x32_bf16 a[16:19], a[232:235], v[96:99], a[16:19]
  s_waitcnt lgkmcnt(2)
  s_add_u32 s48, s47, 32896
  ds_read_b64_tr_b16 a[212:213], v198 offset:40960
  v_permlane16_swap_b32 v208, v220
  v_mfma_f32_16x16x32_bf16 a[16:19], a[236:239], v[112:115], a[16:19]
  buffer_load_dwordx4 v243, s[24:27], s48 offen lds
  v_mfma_f32_16x16x32_bf16 a[20:23], a[236:239], v[116:119], a[20:23]
  ds_read_b64_tr_b16 a[214:215], v198 offset:45056
  v_permlane16_swap_b32 v209, v221
  v_mfma_f32_16x16x32_bf16 a[20:23], a[232:235], v[100:103], a[20:23]
  ds_read_b64_tr_b16 a[216:217], v198 offset:49152
  v_permlane16_swap_b32 v210, v222
  v_mfma_f32_16x16x32_bf16 a[20:23], a[228:231], v[84:87], a[20:23]
  ds_read_b64_tr_b16 a[218:219], v198 offset:53248
  v_permlane16_swap_b32 v211, v223
  v_mfma_f32_16x16x32_bf16 a[20:23], a[224:227], v[68:71], a[20:23]
  buffer_load_dwordx4 v244, s[24:27], s48 offen offset:1024 lds
  v_mfma_f32_16x16x32_bf16 a[24:27], a[224:227], v[72:75], a[24:27]
  ds_read_b64_tr_b16 a[220:221], v198 offset:57344
  v_add_f32 v208, v208, v220
  v_add_f32 v209, v209, v221
  v_mfma_f32_16x16x32_bf16 a[24:27], a[228:231], v[88:91], a[24:27]
  ds_read_b64_tr_b16 a[222:223], v198 offset:61440
  v_add_f32 v210, v210, v222
  v_add_f32 v211, v211, v223
  v_mfma_f32_16x16x32_bf16 a[24:27], a[232:235], v[104:107], a[24:27]
  v_cmp_nlt_f32 s[76:77], v208, v216
  v_cmp_nlt_f32 s[44:45], v209, v216
  v_cmp_nlt_f32 s[60:61], v210, v216
  v_mfma_f32_16x16x32_bf16 a[24:27], a[236:239], v[120:123], a[24:27]
  buffer_load_dwordx4 v245, s[24:27], s48 offen offset:2048 lds
  v_mfma_f32_16x16x32_bf16 a[28:31], a[236:239], v[124:127], a[28:31]
  v_cmp_nlt_f32 vcc, v211, v216
  v_rcp_f32 v208, v208
  v_mfma_f32_16x16x32_bf16 a[28:31], a[232:235], v[108:111], a[28:31]
  v_rcp_f32 v209, v209
  v_mfma_f32_16x16x32_bf16 a[28:31], a[228:231], v[92:95], a[28:31]
  v_rcp_f32 v210, v210
  v_mfma_f32_16x16x32_bf16 a[28:31], a[224:227], v[76:79], a[28:31]
  s_waitcnt lgkmcnt(6)
  buffer_load_dwordx4 v246, s[24:27], s48 offen offset:3072 lds
  v_mfma_f32_16x16x32_bf16 a[32:35], a[208:211], v[64:67], a[32:35]
  s_waitcnt lgkmcnt(4)
  ds_read_b64_tr_b16 a[224:225], v199 offset:32768
  v_rcp_f32 v211, v211
  v_mfma_f32_16x16x32_bf16 a[32:35], a[212:215], v[80:83], a[32:35]
  s_waitcnt lgkmcnt(3)
  s_add_u32 m0, s43, 0
  ds_read_b64_tr_b16 a[226:227], v199 offset:36864
  s_or_b64 s[76:77], s[76:77], s[44:45]
  s_or_b64 vcc, vcc, s[60:61]
  v_mfma_f32_16x16x32_bf16 a[32:35], a[216:219], v[96:99], a[32:35]
  s_waitcnt lgkmcnt(2)
  s_add_u32 s48, s47, 65536
  ds_read_b64_tr_b16 a[228:229], v199 offset:40960
  s_or_b64 vcc, vcc, s[76:77]
  s_cselect_b32 s49, 1, 0
  v_mov_b32 v216, s49
  v_mfma_f32_16x16x32_bf16 a[32:35], a[220:223], v[112:115], a[32:35]
  buffer_load_dwordx4 v243, s[24:27], s48 offen lds
  v_mfma_f32_16x16x32_bf16 a[36:39], a[220:223], v[116:119], a[36:39]
  ds_read_b64_tr_b16 a[230:231], v199 offset:45056
  v_accvgpr_read_b32 v0, a0
  v_accvgpr_read_b32 v1, a1
  v_accvgpr_read_b32 v2, a2
  v_accvgpr_read_b32 v3, a3
  v_mfma_f32_16x16x32_bf16 a[36:39], a[216:219], v[100:103], a[36:39]
  ds_read_b64_tr_b16 a[232:233], v199 offset:49152
  v_accvgpr_read_b32 v4, a16
  v_accvgpr_read_b32 v5, a17
  v_accvgpr_read_b32 v6, a18
  v_accvgpr_read_b32 v7, a19
  v_mfma_f32_16x16x32_bf16 a[36:39], a[212:215], v[84:87], a[36:39]
  ds_read_b64_tr_b16 a[234:235], v199 offset:53248
  v_mul_f32 v0, v208, v0
  v_mul_f32 v1, v208, v1
  v_mul_f32 v2, v208, v2
  v_mfma_f32_16x16x32_bf16 a[36:39], a[208:211], v[68:71], a[36:39]
  buffer_load_dwordx4 v244, s[24:27], s48 offen offset:1024 lds
  v_mfma_f32_16x16x32_bf16 a[40:43], a[208:211], v[72:75], a[40:43]
  ds_read_b64_tr_b16 a[236:237], v199 offset:57344
  v_mul_f32 v3, v208, v3
  v_mul_f32 v4, v208, v4
  v_mul_f32 v5, v208, v5
  v_mul_f32 v6, v208, v6
  v_mfma_f32_16x16x32_bf16 a[40:43], a[212:215], v[88:91], a[40:43]
  ds_read_b64_tr_b16 a[238:239], v199 offset:61440
  v_mul_f32 v7, v208, v7
  v_cvt_pk_bf16_f32 v0, v0, v1
  v_cvt_pk_bf16_f32 v1, v2, v3
  v_cvt_pk_bf16_f32 v2, v4, v5
  v_mfma_f32_16x16x32_bf16 a[40:43], a[216:219], v[104:107], a[40:43]
  ds_write_b32 v217, v216 offset:15360
  v_cvt_pk_bf16_f32 v3, v6, v7
  v_accvgpr_read_b32 v8, a4
  v_accvgpr_read_b32 v9, a5
  v_accvgpr_read_b32 v10, a6
  v_mfma_f32_16x16x32_bf16 a[40:43], a[220:223], v[120:123], a[40:43]
  buffer_load_dwordx4 v245, s[24:27], s48 offen offset:2048 lds
  v_mfma_f32_16x16x32_bf16 a[44:47], a[220:223], v[124:127], a[44:47]
  ds_write_b128 v218, v[0:3] offset:0
  v_accvgpr_read_b32 v11, a7
  v_accvgpr_read_b32 v12, a20
  v_accvgpr_read_b32 v13, a21
  v_accvgpr_read_b32 v14, a22
  v_mfma_f32_16x16x32_bf16 a[44:47], a[216:219], v[108:111], a[44:47]
  v_accvgpr_read_b32 v15, a23
  v_mul_f32 v8, v209, v8
  v_mul_f32 v9, v209, v9
  v_mul_f32 v10, v209, v10
  v_mul_f32 v11, v209, v11
  v_mfma_f32_16x16x32_bf16 a[44:47], a[212:215], v[92:95], a[44:47]
  v_mul_f32 v12, v209, v12
  v_mul_f32 v13, v209, v13
  v_mul_f32 v14, v209, v14
  v_mul_f32 v15, v209, v15
  v_mfma_f32_16x16x32_bf16 a[44:47], a[208:211], v[76:79], a[44:47]
  s_waitcnt lgkmcnt(8)
  buffer_load_dwordx4 v246, s[24:27], s48 offen offset:3072 lds
  v_mfma_f32_16x16x32_bf16 a[48:51], a[224:227], v[64:67], a[48:51]
  s_waitcnt lgkmcnt(6)
  ds_read_b64_tr_b16 a[208:209], v196 offset:33280
  v_cvt_pk_bf16_f32 v8, v8, v9
  v_cvt_pk_bf16_f32 v9, v10, v11
  v_cvt_pk_bf16_f32 v10, v12, v13
  v_cvt_pk_bf16_f32 v11, v14, v15
  v_mfma_f32_16x16x32_bf16 a[48:51], a[228:231], v[80:83], a[48:51]
  s_waitcnt lgkmcnt(5)
  s_add_u32 m0, s43, 4096
  ds_read_b64_tr_b16 a[210:211], v196 offset:37376
  v_accvgpr_read_b32 v16, a8
  v_accvgpr_read_b32 v17, a9
  v_accvgpr_read_b32 v18, a10
  v_accvgpr_read_b32 v19, a11
  v_mfma_f32_16x16x32_bf16 a[48:51], a[232:235], v[96:99], a[48:51]
  s_waitcnt lgkmcnt(4)
  s_add_u32 s48, s47, 98304
  ds_read_b64_tr_b16 a[212:213], v196 offset:41472
  v_accvgpr_read_b32 v20, a24
  v_accvgpr_read_b32 v21, a25
  v_accvgpr_read_b32 v22, a26
  v_accvgpr_read_b32 v23, a27
  v_mfma_f32_16x16x32_bf16 a[48:51], a[236:239], v[112:115], a[48:51]
  buffer_load_dwordx4 v243, s[24:27], s48 offen lds
  v_mfma_f32_16x16x32_bf16 a[52:55], a[236:239], v[116:119], a[52:55]
  ds_read_b64_tr_b16 a[214:215], v196 offset:45568
  v_mul_f32 v16, v210, v16
  v_mul_f32 v17, v210, v17
  v_mul_f32 v18, v210, v18
  v_mul_f32 v19, v210, v19
  v_mfma_f32_16x16x32_bf16 a[52:55], a[232:235], v[100:103], a[52:55]
  ds_read_b64_tr_b16 a[216:217], v196 offset:49664
  v_mul_f32 v20, v210, v20
  v_mul_f32 v21, v210, v21
  v_mul_f32 v22, v210, v22
  v_mul_f32 v23, v210, v23
  v_mfma_f32_16x16x32_bf16 a[52:55], a[228:231], v[84:87], a[52:55]
  ds_read_b64_tr_b16 a[218:219], v196 offset:53760
  v_cvt_pk_bf16_f32 v16, v16, v17
  v_cvt_pk_bf16_f32 v17, v18, v19
  v_cvt_pk_bf16_f32 v18, v20, v21
  v_mfma_f32_16x16x32_bf16 a[52:55], a[224:227], v[68:71], a[52:55]
  buffer_load_dwordx4 v244, s[24:27], s48 offen offset:1024 lds
  v_mfma_f32_16x16x32_bf16 a[56:59], a[224:227], v[72:75], a[56:59]
  ds_read_b64_tr_b16 a[220:221], v196 offset:57856
  v_cvt_pk_bf16_f32 v19, v22, v23
  v_accvgpr_read_b32 v24, a12
  v_accvgpr_read_b32 v25, a13
  v_accvgpr_read_b32 v26, a14
  v_mfma_f32_16x16x32_bf16 a[56:59], a[228:231], v[88:91], a[56:59]
  ds_read_b64_tr_b16 a[222:223], v196 offset:61952
  v_accvgpr_read_b32 v27, a15
  v_accvgpr_read_b32 v28, a28
  v_accvgpr_read_b32 v29, a29
  v_accvgpr_read_b32 v30, a30
  v_mfma_f32_16x16x32_bf16 a[56:59], a[232:235], v[104:107], a[56:59]
  ds_write_b128 v218, v[8:11] offset:1024
  v_accvgpr_read_b32 v31, a31
  v_mul_f32 v24, v211, v24
  v_mul_f32 v25, v211, v25
  v_mul_f32 v26, v211, v26
  v_mfma_f32_16x16x32_bf16 a[56:59], a[236:239], v[120:123], a[56:59]
  buffer_load_dwordx4 v245, s[24:27], s48 offen offset:2048 lds
  v_mfma_f32_16x16x32_bf16 a[60:63], a[236:239], v[124:127], a[60:63]
  ds_write_b128 v218, v[16:19] offset:2048
  v_mul_f32 v27, v211, v27
  v_mul_f32 v28, v211, v28
  v_mul_f32 v29, v211, v29
  v_mul_f32 v30, v211, v30
  v_mfma_f32_16x16x32_bf16 a[60:63], a[232:235], v[108:111], a[60:63]
  v_mul_f32 v31, v211, v31
  v_cvt_pk_bf16_f32 v24, v24, v25
  v_cvt_pk_bf16_f32 v25, v26, v27
  v_cvt_pk_bf16_f32 v26, v28, v29
  v_cvt_pk_bf16_f32 v27, v30, v31
  v_mfma_f32_16x16x32_bf16 a[60:63], a[228:231], v[92:95], a[60:63]
  ds_write_b128 v218, v[24:27] offset:3072
  v_mfma_f32_16x16x32_bf16 a[60:63], a[224:227], v[76:79], a[60:63]
  s_waitcnt lgkmcnt(9)
  buffer_load_dwordx4 v246, s[24:27], s48 offen offset:3072 lds
  v_mfma_f32_16x16x32_bf16 a[64:67], a[208:211], v[64:67], a[64:67]
  s_waitcnt lgkmcnt(7)
  ds_read_b64_tr_b16 a[224:225], v197 offset:33280
  v_mfma_f32_16x16x32_bf16 a[64:67], a[212:215], v[80:83], a[64:67]
  s_waitcnt lgkmcnt(6)
  s_add_u32 s48, s73, 0
  ds_read_b64_tr_b16 a[226:227], v197 offset:37376
  v_accvgpr_read_b32 v32, a32
  v_accvgpr_read_b32 v33, a33
  v_accvgpr_read_b32 v34, a34
  v_mfma_f32_16x16x32_bf16 a[64:67], a[216:219], v[96:99], a[64:67]
  s_waitcnt lgkmcnt(5)
  s_add_u32 s51, s73, 2265088
  ds_read_b64_tr_b16 a[228:229], v197 offset:41472
  v_accvgpr_read_b32 v35, a35
  v_accvgpr_read_b32 v36, a48
  v_accvgpr_read_b32 v37, a49
  v_accvgpr_read_b32 v38, a50
  v_mfma_f32_16x16x32_bf16 a[64:67], a[220:223], v[112:115], a[64:67]
  buffer_load_dwordx4 v[128:131], v242, s[36:39], s48 offen sc1
  v_mfma_f32_16x16x32_bf16 a[68:71], a[220:223], v[116:119], a[68:71]
  ds_read_b64_tr_b16 a[230:231], v197 offset:45568
  v_accvgpr_read_b32 v39, a51
  v_mul_f32 v32, v208, v32
  v_mul_f32 v33, v208, v33
  v_mfma_f32_16x16x32_bf16 a[68:71], a[216:219], v[100:103], a[68:71]
  ds_read_b64_tr_b16 a[232:233], v197 offset:49664
  v_mul_f32 v34, v208, v34
  v_mul_f32 v35, v208, v35
  v_mul_f32 v36, v208, v36
  v_mul_f32 v37, v208, v37
  v_mfma_f32_16x16x32_bf16 a[68:71], a[212:215], v[84:87], a[68:71]
  ds_read_b64_tr_b16 a[234:235], v197 offset:53760
  v_mul_f32 v38, v208, v38
  v_mul_f32 v39, v208, v39
  v_cvt_pk_bf16_f32 v32, v32, v33
  v_mfma_f32_16x16x32_bf16 a[68:71], a[208:211], v[68:71], a[68:71]
  buffer_load_dwordx4 v[132:135], v228, s[36:39], s48 offen sc1
  v_mfma_f32_16x16x32_bf16 a[72:75], a[208:211], v[72:75], a[72:75]
  ds_read_b64_tr_b16 a[236:237], v197 offset:57856
  v_cvt_pk_bf16_f32 v33, v34, v35
  v_cvt_pk_bf16_f32 v34, v36, v37
  v_cvt_pk_bf16_f32 v35, v38, v39
  v_accvgpr_read_b32 v40, a36
  v_mfma_f32_16x16x32_bf16 a[72:75], a[212:215], v[88:91], a[72:75]
  ds_read_b64_tr_b16 a[238:239], v197 offset:61952
  v_accvgpr_read_b32 v41, a37
  v_accvgpr_read_b32 v42, a38
  v_accvgpr_read_b32 v43, a39
  v_mfma_f32_16x16x32_bf16 a[72:75], a[216:219], v[104:107], a[72:75]
  ds_write_b128 v218, v[32:35] offset:4096
  v_accvgpr_read_b32 v44, a52
  v_accvgpr_read_b32 v45, a53
  v_accvgpr_read_b32 v46, a54
  v_accvgpr_read_b32 v47, a55
  v_mfma_f32_16x16x32_bf16 a[72:75], a[220:223], v[120:123], a[72:75]
  buffer_load_dwordx4 v[136:139], v242, s[36:39], s51 offen sc1
  v_mfma_f32_16x16x32_bf16 a[76:79], a[220:223], v[124:127], a[76:79]
  v_mul_f32 v40, v209, v40
  v_mul_f32 v41, v209, v41
  v_mul_f32 v42, v209, v42
  v_mul_f32 v43, v209, v43
  v_mfma_f32_16x16x32_bf16 a[76:79], a[216:219], v[108:111], a[76:79]
  v_mul_f32 v44, v209, v44
  v_mul_f32 v45, v209, v45
  v_mul_f32 v46, v209, v46
  v_mul_f32 v47, v209, v47
  v_mfma_f32_16x16x32_bf16 a[76:79], a[212:215], v[92:95], a[76:79]
  v_cvt_pk_bf16_f32 v40, v40, v41
  v_cvt_pk_bf16_f32 v41, v42, v43
  v_cvt_pk_bf16_f32 v42, v44, v45
  v_cvt_pk_bf16_f32 v43, v46, v47
  v_accvgpr_read_b32 v48, a40
  v_mfma_f32_16x16x32_bf16 a[76:79], a[208:211], v[76:79], a[76:79]
  s_waitcnt lgkmcnt(7)
  buffer_load_dwordx4 v[140:143], v228, s[36:39], s51 offen sc1
  v_mfma_f32_16x16x32_bf16 a[80:83], a[224:227], v[64:67], a[80:83]
  s_waitcnt lgkmcnt(5)
  ds_read_b64_tr_b16 a[208:209], v198 offset:33280
  v_accvgpr_read_b32 v49, a41
  v_accvgpr_read_b32 v50, a42
  v_accvgpr_read_b32 v51, a43
  v_mfma_f32_16x16x32_bf16 a[80:83], a[228:231], v[80:83], a[80:83]
  s_waitcnt lgkmcnt(4)
  s_add_u32 s48, s73, 4530176
  ds_read_b64_tr_b16 a[210:211], v198 offset:37376
  v_accvgpr_read_b32 v52, a56
  v_accvgpr_read_b32 v53, a57
  v_accvgpr_read_b32 v54, a58
  v_accvgpr_read_b32 v55, a59
  v_mfma_f32_16x16x32_bf16 a[80:83], a[232:235], v[96:99], a[80:83]
  s_waitcnt lgkmcnt(3)
  s_add_u32 s51, s73, 6795264
  ds_read_b64_tr_b16 a[212:213], v198 offset:41472
  v_mul_f32 v48, v210, v48
  v_mul_f32 v49, v210, v49
  v_mul_f32 v50, v210, v50
  v_mfma_f32_16x16x32_bf16 a[80:83], a[236:239], v[112:115], a[80:83]
  buffer_load_dwordx4 v[144:147], v242, s[36:39], s48 offen sc1
  v_mfma_f32_16x16x32_bf16 a[84:87], a[236:239], v[116:119], a[84:87]
  ds_read_b64_tr_b16 a[214:215], v198 offset:45568
  v_mul_f32 v51, v210, v51
  v_mul_f32 v52, v210, v52
  v_mul_f32 v53, v210, v53
  v_mul_f32 v54, v210, v54
  v_mfma_f32_16x16x32_bf16 a[84:87], a[232:235], v[100:103], a[84:87]
  ds_read_b64_tr_b16 a[216:217], v198 offset:49664
  v_mul_f32 v55, v210, v55
  v_cvt_pk_bf16_f32 v48, v48, v49
  v_cvt_pk_bf16_f32 v49, v50, v51
  v_mfma_f32_16x16x32_bf16 a[84:87], a[228:231], v[84:87], a[84:87]
  ds_read_b64_tr_b16 a[218:219], v198 offset:53760
  v_cvt_pk_bf16_f32 v50, v52, v53
  v_cvt_pk_bf16_f32 v51, v54, v55
  v_accvgpr_read_b32 v56, a44
  v_mfma_f32_16x16x32_bf16 a[84:87], a[224:227], v[68:71], a[84:87]
  buffer_load_dwordx4 v[148:151], v228, s[36:39], s48 offen sc1
  v_mfma_f32_16x16x32_bf16 a[88:91], a[224:227], v[72:75], a[88:91]
  ds_read_b64_tr_b16 a[220:221], v198 offset:57856
  v_accvgpr_read_b32 v57, a45
  v_accvgpr_read_b32 v58, a46
  v_accvgpr_read_b32 v59, a47
  v_accvgpr_read_b32 v60, a60
  v_mfma_f32_16x16x32_bf16 a[88:91], a[228:231], v[88:91], a[88:91]
  ds_read_b64_tr_b16 a[222:223], v198 offset:61952
  v_accvgpr_read_b32 v61, a61
  v_accvgpr_read_b32 v62, a62
  v_accvgpr_read_b32 v63, a63
  v_mfma_f32_16x16x32_bf16 a[88:91], a[232:235], v[104:107], a[88:91]
  ds_write_b128 v218, v[40:43] offset:5120
  v_mul_f32 v56, v211, v56
  v_mul_f32 v57, v211, v57
  v_mul_f32 v58, v211, v58
  v_mul_f32 v59, v211, v59
  v_mfma_f32_16x16x32_bf16 a[88:91], a[236:239], v[120:123], a[88:91]
  buffer_load_dwordx4 v[152:155], v242, s[36:39], s51 offen sc1
  v_mfma_f32_16x16x32_bf16 a[92:95], a[236:239], v[124:127], a[92:95]
  ds_write_b128 v218, v[48:51] offset:6144
  v_mul_f32 v60, v211, v60
  v_mul_f32 v61, v211, v61
  v_mul_f32 v62, v211, v62
  v_mfma_f32_16x16x32_bf16 a[92:95], a[232:235], v[108:111], a[92:95]
  v_mul_f32 v63, v211, v63
  v_cvt_pk_bf16_f32 v56, v56, v57
  v_cvt_pk_bf16_f32 v57, v58, v59
  v_cvt_pk_bf16_f32 v58, v60, v61
  v_cvt_pk_bf16_f32 v59, v62, v63
  v_mfma_f32_16x16x32_bf16 a[92:95], a[228:231], v[92:95], a[92:95]
  ds_write_b128 v218, v[56:59] offset:7168
  v_mfma_f32_16x16x32_bf16 a[92:95], a[224:227], v[76:79], a[92:95]
  s_waitcnt lgkmcnt(9)
  buffer_load_dwordx4 v[156:159], v228, s[36:39], s51 offen sc1
  v_mfma_f32_16x16x32_bf16 a[96:99], a[208:211], v[64:67], a[96:99]
  s_waitcnt lgkmcnt(7)
  ds_read_b64_tr_b16 a[224:225], v199 offset:33280
  v_mfma_f32_16x16x32_bf16 a[96:99], a[212:215], v[80:83], a[96:99]
  s_waitcnt lgkmcnt(6)
  s_add_u32 s48, s73, 9060352
  ds_read_b64_tr_b16 a[226:227], v199 offset:37376
  v_accvgpr_read_b32 v0, a64
  v_accvgpr_read_b32 v1, a65
  v_accvgpr_read_b32 v2, a66
  v_mfma_f32_16x16x32_bf16 a[96:99], a[216:219], v[96:99], a[96:99]
  s_waitcnt lgkmcnt(5)
  s_add_u32 s51, s73, 11325440
  ds_read_b64_tr_b16 a[228:229], v199 offset:41472
  v_accvgpr_read_b32 v3, a67
  v_accvgpr_read_b32 v4, a80
  v_accvgpr_read_b32 v5, a81
  v_mfma_f32_16x16x32_bf16 a[96:99], a[220:223], v[112:115], a[96:99]
  buffer_load_dwordx4 v[160:163], v242, s[36:39], s48 offen sc1
  v_mfma_f32_16x16x32_bf16 a[100:103], a[220:223], v[116:119], a[100:103]
  ds_read_b64_tr_b16 a[230:231], v199 offset:45568
  v_accvgpr_read_b32 v6, a82
  v_accvgpr_read_b32 v7, a83
  v_mul_f32 v0, v208, v0
  v_mfma_f32_16x16x32_bf16 a[100:103], a[216:219], v[100:103], a[100:103]
  ds_read_b64_tr_b16 a[232:233], v199 offset:49664
  v_mul_f32 v1, v208, v1
  v_mul_f32 v2, v208, v2
  v_mul_f32 v3, v208, v3
  v_mul_f32 v4, v208, v4
  v_mfma_f32_16x16x32_bf16 a[100:103], a[212:215], v[84:87], a[100:103]
  ds_read_b64_tr_b16 a[234:235], v199 offset:53760
  v_mul_f32 v5, v208, v5
  v_mul_f32 v6, v208, v6
  v_mul_f32 v7, v208, v7
  v_mfma_f32_16x16x32_bf16 a[100:103], a[208:211], v[68:71], a[100:103]
  buffer_load_dwordx4 v[164:167], v228, s[36:39], s48 offen sc1
  v_mfma_f32_16x16x32_bf16 a[104:107], a[208:211], v[72:75], a[104:107]
  ds_read_b64_tr_b16 a[236:237], v199 offset:57856
  v_cvt_pk_bf16_f32 v0, v0, v1
  v_cvt_pk_bf16_f32 v1, v2, v3
  v_cvt_pk_bf16_f32 v2, v4, v5
  v_mfma_f32_16x16x32_bf16 a[104:107], a[212:215], v[88:91], a[104:107]
  ds_read_b64_tr_b16 a[238:239], v199 offset:61952
  v_cvt_pk_bf16_f32 v3, v6, v7
  v_accvgpr_read_b32 v8, a68
  v_accvgpr_read_b32 v9, a69
  v_mfma_f32_16x16x32_bf16 a[104:107], a[216:219], v[104:107], a[104:107]
  ds_write_b128 v218, v[0:3] offset:8192
  v_accvgpr_read_b32 v10, a70
  v_accvgpr_read_b32 v11, a71
  v_accvgpr_read_b32 v12, a84
  v_mfma_f32_16x16x32_bf16 a[104:107], a[220:223], v[120:123], a[104:107]
  buffer_load_dwordx4 v[168:171], v242, s[36:39], s51 offen sc1
  v_mfma_f32_16x16x32_bf16 a[108:111], a[220:223], v[124:127], a[108:111]
  v_accvgpr_read_b32 v13, a85
  v_accvgpr_read_b32 v14, a86
  v_accvgpr_read_b32 v15, a87
  v_mul_f32 v8, v209, v8
  v_mfma_f32_16x16x32_bf16 a[108:111], a[216:219], v[108:111], a[108:111]
  v_mul_f32 v9, v209, v9
  v_mul_f32 v10, v209, v10
  v_mul_f32 v11, v209, v11
  v_mul_f32 v12, v209, v12
  v_mfma_f32_16x16x32_bf16 a[108:111], a[212:215], v[92:95], a[108:111]
  v_mul_f32 v13, v209, v13
  v_mul_f32 v14, v209, v14
  v_mul_f32 v15, v209, v15
  v_cvt_pk_bf16_f32 v8, v8, v9
  v_mfma_f32_16x16x32_bf16 a[108:111], a[208:211], v[76:79], a[108:111]
  s_waitcnt lgkmcnt(7)
  buffer_load_dwordx4 v[172:175], v228, s[36:39], s51 offen sc1
  s_waitcnt lgkmcnt(0)
  s_barrier
  v_mfma_f32_16x16x32_bf16 a[112:115], a[224:227], v[64:67], a[112:115]
  ds_read_b128 v[220:223], v219 offset:15360
  v_cvt_pk_bf16_f32 v9, v10, v11
  v_cvt_pk_bf16_f32 v10, v12, v13
  v_cvt_pk_bf16_f32 v11, v14, v15
  v_accvgpr_read_b32 v16, a72
  v_mfma_f32_16x16x32_bf16 a[112:115], a[228:231], v[80:83], a[112:115]
  s_add_u32 s48, s73, 13590528
  ds_write_b128 v218, v[8:11] offset:9216
  v_accvgpr_read_b32 v17, a73
  v_accvgpr_read_b32 v18, a74
  v_accvgpr_read_b32 v19, a75
  v_mfma_f32_16x16x32_bf16 a[112:115], a[232:235], v[96:99], a[112:115]
  s_add_u32 s51, s73, 15855616
  v_accvgpr_read_b32 v20, a88
  v_accvgpr_read_b32 v21, a89
  v_accvgpr_read_b32 v22, a90
  v_accvgpr_read_b32 v23, a91
  v_mfma_f32_16x16x32_bf16 a[112:115], a[236:239], v[112:115], a[112:115]
  buffer_load_dwordx4 v[176:179], v242, s[36:39], s48 offen sc1
  v_mfma_f32_16x16x32_bf16 a[116:119], a[236:239], v[116:119], a[116:119]
  v_mul_f32 v16, v210, v16
  v_mul_f32 v17, v210, v17
  v_mul_f32 v18, v210, v18
  v_mul_f32 v19, v210, v19
  v_mfma_f32_16x16x32_bf16 a[116:119], a[232:235], v[100:103], a[116:119]
  v_mul_f32 v20, v210, v20
  v_mul_f32 v21, v210, v21
  v_mul_f32 v22, v210, v22
  v_mul_f32 v23, v210, v23
  v_mfma_f32_16x16x32_bf16 a[116:119], a[228:231], v[84:87], a[116:119]
  v_cvt_pk_bf16_f32 v16, v16, v17
  v_cvt_pk_bf16_f32 v17, v18, v19
  v_cvt_pk_bf16_f32 v18, v20, v21
  v_cvt_pk_bf16_f32 v19, v22, v23
  v_mfma_f32_16x16x32_bf16 a[116:119], a[224:227], v[68:71], a[116:119]
  buffer_load_dwordx4 v[180:183], v228, s[36:39], s48 offen sc1
  v_mfma_f32_16x16x32_bf16 a[120:123], a[224:227], v[72:75], a[120:123]
  ds_write_b128 v218, v[16:19] offset:10240
  v_accvgpr_read_b32 v24, a76
  v_accvgpr_read_b32 v25, a77
  v_accvgpr_read_b32 v26, a78
  v_mfma_f32_16x16x32_bf16 a[120:123], a[228:231], v[88:91], a[120:123]
  v_accvgpr_read_b32 v27, a79
  v_accvgpr_read_b32 v28, a92
  v_accvgpr_read_b32 v29, a93
  v_accvgpr_read_b32 v30, a94
  v_mfma_f32_16x16x32_bf16 a[120:123], a[232:235], v[104:107], a[120:123]
  v_accvgpr_read_b32 v31, a95
  v_mul_f32 v24, v211, v24
  v_mul_f32 v25, v211, v25
  v_mul_f32 v26, v211, v26
  v_mul_f32 v27, v211, v27
  v_mfma_f32_16x16x32_bf16 a[120:123], a[236:239], v[120:123], a[120:123]
  buffer_load_dwordx4 v[184:187], v242, s[36:39], s51 offen sc1
  v_mfma_f32_16x16x32_bf16 a[124:127], a[236:239], v[124:127], a[124:127]
  v_mul_f32 v28, v211, v28
  v_mul_f32 v29, v211, v29
  v_mul_f32 v30, v211, v30
  v_mul_f32 v31, v211, v31
  v_mfma_f32_16x16x32_bf16 a[124:127], a[232:235], v[108:111], a[124:127]
  v_cvt_pk_bf16_f32 v24, v24, v25
  v_cvt_pk_bf16_f32 v25, v26, v27
  v_cvt_pk_bf16_f32 v26, v28, v29
  v_cvt_pk_bf16_f32 v27, v30, v31
  v_mfma_f32_16x16x32_bf16 a[124:127], a[228:231], v[92:95], a[124:127]
  ds_write_b128 v218, v[24:27] offset:11264
  v_mfma_f32_16x16x32_bf16 a[124:127], a[224:227], v[76:79], a[124:127]
  buffer_load_dwordx4 v[188:191], v228, s[36:39], s51 offen sc1
  s_waitcnt lgkmcnt(3)
  v_or_b32 v220, v220, v221
  v_or3_b32 v220, v220, v222, v223
  s_nop 0
  v_readfirstlane_b32 s49, v220
  v_mov_b32 v220, v208
  v_mov_b32 v221, v208
  v_accvgpr_read_b32 v32, a96
  v_accvgpr_read_b32 v33, a97
  v_accvgpr_read_b32 v34, a98
  v_accvgpr_read_b32 v35, a99
  v_accvgpr_read_b32 v36, a112
  v_accvgpr_read_b32 v37, a113
  v_accvgpr_read_b32 v38, a114
  v_accvgpr_read_b32 v39, a115
  v_pk_mul_f32 v[32:33], v[32:33], v[220:221]
  v_pk_mul_f32 v[34:35], v[34:35], v[220:221]
  v_pk_mul_f32 v[36:37], v[36:37], v[220:221]
  v_pk_mul_f32 v[38:39], v[38:39], v[220:221]
  v_cvt_pk_bf16_f32 v32, v32, v33
  v_cvt_pk_bf16_f32 v33, v34, v35
  v_cvt_pk_bf16_f32 v34, v36, v37
  v_cvt_pk_bf16_f32 v35, v38, v39
  ds_write_b128 v218, v[32:35] offset:12288
  v_mov_b32 v220, v209
  v_mov_b32 v221, v209
  v_accvgpr_read_b32 v40, a100
  v_accvgpr_read_b32 v41, a101
  v_accvgpr_read_b32 v42, a102
  v_accvgpr_read_b32 v43, a103
  v_accvgpr_read_b32 v44, a116
  v_accvgpr_read_b32 v45, a117
  v_accvgpr_read_b32 v46, a118
  v_accvgpr_read_b32 v47, a119
  v_pk_mul_f32 v[40:41], v[40:41], v[220:221]
  v_pk_mul_f32 v[42:43], v[42:43], v[220:221]
  v_pk_mul_f32 v[44:45], v[44:45], v[220:221]
  v_pk_mul_f32 v[46:47], v[46:47], v[220:221]
  v_cvt_pk_bf16_f32 v40, v40, v41
  v_cvt_pk_bf16_f32 v41, v42, v43
  v_cvt_pk_bf16_f32 v42, v44, v45
  v_cvt_pk_bf16_f32 v43, v46, v47
  ds_write_b128 v218, v[40:43] offset:13312
  v_mov_b32 v220, v210
  v_mov_b32 v221, v210
  v_accvgpr_read_b32 v48, a104
  v_accvgpr_read_b32 v49, a105
  v_accvgpr_read_b32 v50, a106
  v_accvgpr_read_b32 v51, a107
  v_accvgpr_read_b32 v52, a120
  v_accvgpr_read_b32 v53, a121
  v_accvgpr_read_b32 v54, a122
  v_accvgpr_read_b32 v55, a123
  v_pk_mul_f32 v[48:49], v[48:49], v[220:221]
  v_pk_mul_f32 v[50:51], v[50:51], v[220:221]
  v_pk_mul_f32 v[52:53], v[52:53], v[220:221]
  v_pk_mul_f32 v[54:55], v[54:55], v[220:221]
  v_cvt_pk_bf16_f32 v48, v48, v49
  v_cvt_pk_bf16_f32 v49, v50, v51
  v_cvt_pk_bf16_f32 v50, v52, v53
  v_cvt_pk_bf16_f32 v51, v54, v55
  ds_write_b128 v218, v[48:51] offset:14336
  v_mov_b32 v220, v211
  v_mov_b32 v221, v211
  v_accvgpr_read_b32 v56, a108
  v_accvgpr_read_b32 v57, a109
  v_accvgpr_read_b32 v58, a110
  v_accvgpr_read_b32 v59, a111
  v_accvgpr_read_b32 v60, a124
  v_accvgpr_read_b32 v61, a125
  v_accvgpr_read_b32 v62, a126
  v_accvgpr_read_b32 v63, a127
  v_pk_mul_f32 v[56:57], v[56:57], v[220:221]
  v_pk_mul_f32 v[58:59], v[58:59], v[220:221]
  v_pk_mul_f32 v[60:61], v[60:61], v[220:221]
  v_pk_mul_f32 v[62:63], v[62:63], v[220:221]
  v_cvt_pk_bf16_f32 v56, v56, v57
  v_cvt_pk_bf16_f32 v57, v58, v59
  v_cvt_pk_bf16_f32 v58, v60, v61
  v_cvt_pk_bf16_f32 v59, v62, v63
  ds_write_b128 v218, v[56:59] offset:15360
  s_add_u32 m0, s43, 65536
  s_add_u32 s48, s47, 65664
  buffer_load_dwordx4 v243, s[24:27], s48 offen lds
  buffer_load_dwordx4 v244, s[24:27], s48 offen offset:1024 lds
  buffer_load_dwordx4 v245, s[24:27], s48 offen offset:2048 lds
  buffer_load_dwordx4 v246, s[24:27], s48 offen offset:3072 lds
  s_andn2_b32 s49, s49, s55
  s_waitcnt lgkmcnt(0)
  s_barrier
  s_cbranch_scc1 L_redo
  ds_read_b128 a[128:131], v242 offset:0
  ds_read_b128 a[144:147], v242 offset:4096
L_hop10:
  s_cbranch_execz L_hop_done
  ds_read_b128 a[132:135], v242 offset:1024
  ds_read_b128 a[148:151], v242 offset:5120
  ds_read_b128 a[136:139], v242 offset:2048
  ds_read_b128 a[152:155], v242 offset:6144
  ds_read_b128 a[140:143], v242 offset:3072
  ds_read_b128 a[156:159], v242 offset:7168
  s_waitcnt lgkmcnt(7)
  v_mfma_f32_16x16x32_bf16 v[0:3], a[192:195], a[128:131], 0
  s_waitcnt lgkmcnt(6)
  ds_read_b128 a[160:163], v242 offset:8192
  v_and_b32 v220, 1, v247
  v_mfma_f32_16x16x32_bf16 v[0:3], a[240:243], a[144:147], v[0:3]
  s_waitcnt lgkmcnt(5)
  s_add_u32 m0, s43, 69632
  ds_read_b128 a[164:167], v242 offset:9216
  v_lshlrev_b32 v220, 4, v220
  v_mfma_f32_16x16x32_bf16 v[4:7], a[240:243], a[148:151], 0
  s_add_u32 s48, s47, 98432
  ds_read_b128 a[0:3], v242 offset:32768
  v_mov_b32 v221, 0x3f80
  v_mfma_f32_16x16x32_bf16 v[4:7], a[192:195], a[132:135], v[4:7]
  s_waitcnt lgkmcnt(6)
  buffer_load_dwordx4 v243, s[24:27], s48 offen lds
  v_mfma_f32_16x16x32_bf16 v[8:11], a[192:195], a[136:139], 0
  s_waitcnt vmcnt(33)
  s_waitcnt lgkmcnt(5)
  ds_read_b64_tr_b16 a[208:209], v232 offset:32768
  v_lshlrev_b32 v220, v220, v221
  v_mfma_f32_16x16x32_bf16 v[8:11], a[240:243], a[152:155], v[8:11]
  s_waitcnt lgkmcnt(4)
  ds_read_b64_tr_b16 a[210:211], v232 offset:34816
  v_bfe_u32 v221, v247, 1, 1
  v_mfma_f32_16x16x32_bf16 v[12:15], a[240:243], a[156:159], 0
  ds_read_b64_tr_b16 a[212:213], v233 offset:32768
  v_bfe_u32 v222, v247, 3, 1
  v_mfma_f32_16x16x32_bf16 v[12:15], a[192:195], a[140:143], v[12:15]
  buffer_load_dwordx4 v244, s[24:27], s48 offen offset:1024 lds
  v_mfma_f32_16x16x32_bf16 v[28:31], a[196:199], a[140:143], 0
  ds_read_b64_tr_b16 a[214:215], v233 offset:34816
  v_lshl_add_u32 v221, v222, 1, v221
  v_mfma_f32_16x16x32_bf16 v[28:31], a[244:247], a[156:159], v[28:31]
  ds_read_b64_tr_b16 a[216:217], v234 offset:32768
  v_bfe_u32 v222, v247, 4, 1
  v_mfma_f32_16x16x32_bf16 v[24:27], a[244:247], a[152:155], 0
  ds_read_b64_tr_b16 a[218:219], v234 offset:34816
  v_lshl_add_u32 v221, v222, 2, v221
  v_mfma_f32_16x16x32_bf16 v[24:27], a[196:199], a[136:139], v[24:27]
  buffer_load_dwordx4 v245, s[24:27], s48 offen offset:2048 lds
  v_mfma_f32_16x16x32_bf16 v[20:23], a[196:199], a[132:135], 0
  ds_read_b64_tr_b16 a[220:221], v235 offset:32768
  v_bfe_u32 v222, v247, 2, 1
  v_mfma_f32_16x16x32_bf16 v[20:23], a[244:247], a[148:151], v[20:23]
  ds_read_b64_tr_b16 a[222:223], v235 offset:34816
  v_lshrrev_b32 v223, 5, v247
  v_mfma_f32_16x16x32_bf16 v[16:19], a[244:247], a[144:147], 0
  v_xor_b32 v222, v222, v223
  v_lshl_add_u32 v221, v222, 3, v221
  v_mfma_f32_16x16x32_bf16 v[16:19], a[196:199], a[128:131], v[16:19]
  buffer_load_dwordx4 v246, s[24:27], s48 offen offset:3072 lds
  v_mfma_f32_16x16x32_bf16 v[32:35], a[200:203], a[128:131], 0
  ds_read_b128 a[168:171], v242 offset:10240
  v_cmp_eq_u32 s[12:13], 0, v221
  v_mfma_f32_16x16x32_bf16 v[32:35], a[248:251], a[144:147], v[32:35]
  s_add_u32 m0, s43, 32768
  ds_read_b128 a[172:175], v242 offset:11264
  v_cmp_eq_u32 s[14:15], 1, v221
  v_mfma_f32_16x16x32_bf16 v[36:39], a[248:251], a[148:151], 0
  s_add_u32 s48, s47, 131072
  ds_read_b128 a[4:7], v242 offset:33792
  v_cmp_eq_u32 s[16:17], 2, v221
  v_mfma_f32_16x16x32_bf16 v[36:39], a[200:203], a[132:135], v[36:39]
  s_waitcnt lgkmcnt(3)
  buffer_load_dwordx4 v243, s[24:27], s48 offen lds
  v_mfma_f32_16x16x32_bf16 v[40:43], a[200:203], a[136:139], 0
  s_waitcnt vmcnt(33)
  ds_read_b64_tr_b16 a[224:225], v232 offset:36864
  v_cmp_eq_u32 s[18:19], 3, v221
  v_mfma_f32_16x16x32_bf16 v[40:43], a[248:251], a[152:155], v[40:43]
  ds_read_b64_tr_b16 a[226:227], v232 offset:38912
  v_cmp_eq_u32 s[20:21], 4, v221
  v_mfma_f32_16x16x32_bf16 v[44:47], a[248:251], a[156:159], 0
  ds_read_b64_tr_b16 a[228:229], v233 offset:36864
  v_cmp_eq_u32 s[22:23], 5, v221
  v_mfma_f32_16x16x32_bf16 v[44:47], a[200:203], a[140:143], v[44:47]
  buffer_load_dwordx4 v244, s[24:27], s48 offen offset:1024 lds
  v_mfma_f32_16x16x32_bf16 v[60:63], a[204:207], a[140:143], 0
  ds_read_b64_tr_b16 a[230:231], v233 offset:38912
  v_cmp_eq_u32 s[28:29], 6, v221
  v_mfma_f32_16x16x32_bf16 v[60:63], a[252:255], a[156:159], v[60:63]
  ds_read_b64_tr_b16 a[232:233], v234 offset:36864
  v_cmp_eq_u32 s[30:31], 7, v221
  v_mfma_f32_16x16x32_bf16 v[56:59], a[252:255], a[152:155], 0
  ds_read_b64_tr_b16 a[234:235], v234 offset:38912
  v_cndmask_b32 v192, 0, v220, s[12:13]
  v_mfma_f32_16x16x32_bf16 v[56:59], a[204:207], a[136:139], v[56:59]
  buffer_load_dwordx4 v245, s[24:27], s48 offen offset:2048 lds
  v_mfma_f32_16x16x32_bf16 v[52:55], a[204:207], a[132:135], 0
  ds_read_b64_tr_b16 a[236:237], v235 offset:36864
  v_cndmask_b32 v193, 0, v220, s[14:15]
  v_mfma_f32_16x16x32_bf16 v[52:55], a[252:255], a[148:151], v[52:55]
  ds_read_b64_tr_b16 a[238:239], v235 offset:38912
  v_cndmask_b32 v194, 0, v220, s[16:17]
  v_mfma_f32_16x16x32_bf16 v[48:51], a[252:255], a[144:147], 0
  v_cndmask_b32 v195, 0, v220, s[18:19]
  v_cndmask_b32 v196, 0, v220, s[20:21]
  v_mfma_f32_16x16x32_bf16 v[48:51], a[204:207], a[128:131], v[48:51]
  buffer_load_dwordx4 v246, s[24:27], s48 offen offset:3072 lds
  v_mfma_f32_16x16x32_bf16 v[64:67], a[208:211], a[128:131], 0
  s_waitcnt lgkmcnt(6)
  ds_read_b128 a[176:179], v242 offset:12288
  v_cndmask_b32 v197, 0, v220, s[22:23]
  v_mfma_f32_16x16x32_bf16 v[64:67], a[224:227], a[144:147], v[64:67]
  s_add_u32 m0, s43, 36864
  ds_read_b128 a[180:183], v242 offset:13312
  v_cndmask_b32 v198, 0, v220, s[28:29]
  v_mfma_f32_16x16x32_bf16 v[68:71], a[224:227], a[148:151], 0
  s_add_u32 s48, s47, 163840
  ds_read_b128 a[8:11], v242 offset:34816
  v_cndmask_b32 v199, 0, v220, s[30:31]
  v_mfma_f32_16x16x32_bf16 v[68:71], a[208:211], a[132:135], v[68:71]
  s_waitcnt lgkmcnt(3)
  buffer_load_dwordx4 v243, s[24:27], s48 offen lds
  v_mfma_f32_16x16x32_bf16 v[72:75], a[208:211], a[136:139], 0
  s_waitcnt vmcnt(33)
  ds_read_b64_tr_b16 a[192:193], v232 offset:0
  v_add_u32 v217, s88, v242
  v_mfma_f32_16x16x32_bf16 v[72:75], a[224:227], a[152:155], v[72:75]
  ds_read_b64_tr_b16 a[194:195], v232 offset:2048
  v_add_u32 v219, s89, v242
  v_mfma_f32_16x16x32_bf16 v[76:79], a[224:227], a[156:159], 0
  ds_read_b64_tr_b16 a[196:197], v233 offset:0
  v_add_u32 v224, s78, v242
  v_mfma_f32_16x16x32_bf16 v[76:79], a[208:211], a[140:143], v[76:79]
  s_lshl_b32 s49, s42, 10
  buffer_load_dwordx4 v244, s[24:27], s48 offen offset:1024 lds
  v_mfma_f32_16x16x32_bf16 v[92:95], a[212:215], a[140:143], 0
  ds_read_b64_tr_b16 a[198:199], v233 offset:2048
  v_add_u32 v225, s49, v224
  v_mfma_f32_16x16x32_bf16 v[92:95], a[228:231], a[156:159], v[92:95]
  ds_read_b64_tr_b16 a[200:201], v234 offset:0
  v_mfma_f32_16x16x32_bf16 v[88:91], a[228:231], a[152:155], 0
  ds_read_b64_tr_b16 a[202:203], v234 offset:2048
  v_mfma_f32_16x16x32_bf16 v[88:91], a[212:215], a[136:139], v[88:91]
  buffer_load_dwordx4 v245, s[24:27], s48 offen offset:2048 lds
  v_mfma_f32_16x16x32_bf16 v[84:87], a[212:215], a[132:135], 0
  ds_read_b64_tr_b16 a[204:205], v235 offset:0
  v_mfma_f32_16x16x32_bf16 v[84:87], a[228:231], a[148:151], v[84:87]
  ds_read_b64_tr_b16 a[206:207], v235 offset:2048
  v_mfma_f32_16x16x32_bf16 v[80:83], a[228:231], a[144:147], 0
  v_mfma_f32_16x16x32_bf16 v[80:83], a[212:215], a[128:131], v[80:83]
  buffer_load_dwordx4 v246, s[24:27], s48 offen offset:3072 lds
  v_mfma_f32_16x16x32_bf16 v[96:99], a[216:219], a[128:131], 0
  ds_read_b128 a[184:187], v242 offset:14336
  v_mfma_f32_16x16x32_bf16 v[96:99], a[232:235], a[144:147], v[96:99]
  s_add_u32 m0, s43, 0
  ds_read_b128 a[188:191], v242 offset:15360
  v_mfma_f32_16x16x32_bf16 v[100:103], a[232:235], a[148:151], 0
  s_add_u32 s48, s47, 131200
  ds_read_b128 a[12:15], v242 offset:35840
  v_mfma_f32_16x16x32_bf16 v[100:103], a[216:219], a[132:135], v[100:103]
  s_waitcnt lgkmcnt(3)
  buffer_load_dwordx4 v243, s[24:27], s48 offen lds
  v_mfma_f32_16x16x32_bf16 v[104:107], a[216:219], a[136:139], 0
  s_waitcnt vmcnt(33)
  ds_read_b64_tr_b16 a[240:241], v232 offset:4096
  v_mfma_f32_16x16x32_bf16 v[104:107], a[232:235], a[152:155], v[104:107]
  ds_read_b64_tr_b16 a[242:243], v232 offset:6144
  v_mfma_f32_16x16x32_bf16 v[108:111], a[232:235], a[156:159], 0
  ds_read_b64_tr_b16 a[244:245], v233 offset:4096
  v_mfma_f32_16x16x32_bf16 v[108:111], a[216:219], a[140:143], v[108:111]
  buffer_load_dwordx4 v244, s[24:27], s48 offen offset:1024 lds
  v_mfma_f32_16x16x32_bf16 v[124:127], a[220:223], a[140:143], 0
  ds_read_b64_tr_b16 a[246:247], v233 offset:6144
  v_mfma_f32_16x16x32_bf16 v[124:127], a[236:239], a[156:159], v[124:127]
  ds_read_b64_tr_b16 a[248:249], v234 offset:4096
  v_mfma_f32_16x16x32_bf16 v[120:123], a[236:239], a[152:155], 0
  ds_read_b64_tr_b16 a[250:251], v234 offset:6144
  v_mfma_f32_16x16x32_bf16 v[120:123], a[220:223], a[136:139], v[120:123]
  buffer_load_dwordx4 v245, s[24:27], s48 offen offset:2048 lds
  v_mfma_f32_16x16x32_bf16 v[116:119], a[220:223], a[132:135], 0
  ds_read_b64_tr_b16 a[252:253], v235 offset:4096
  v_mfma_f32_16x16x32_bf16 v[116:119], a[236:239], a[148:151], v[116:119]
  ds_read_b64_tr_b16 a[254:255], v235 offset:6144
  v_mfma_f32_16x16x32_bf16 v[112:115], a[236:239], a[144:147], 0
  v_mfma_f32_16x16x32_bf16 v[112:115], a[220:223], a[128:131], v[112:115]
  buffer_load_dwordx4 v246, s[24:27], s48 offen offset:3072 lds
  v_mfma_f32_16x16x32_bf16 v[0:3], a[192:195], a[160:163], v[0:3]
  s_waitcnt lgkmcnt(6)
  ds_read_b128 a[128:131], v242 offset:16384
  v_mfma_f32_16x16x32_bf16 v[0:3], a[240:243], a[176:179], v[0:3]
  s_add_u32 m0, s43, 4096
  ds_read_b128 a[132:135], v242 offset:17408
  v_mfma_f32_16x16x32_bf16 v[4:7], a[240:243], a[180:183], v[4:7]
  s_add_u32 s48, s47, 163968
  ds_read_b128 a[16:19], v242 offset:36864
  v_mfma_f32_16x16x32_bf16 v[4:7], a[192:195], a[164:167], v[4:7]
  s_waitcnt lgkmcnt(3)
  buffer_load_dwordx4 v243, s[24:27], s48 offen lds
  v_mfma_f32_16x16x32_bf16 v[8:11], a[192:195], a[168:171], v[8:11]
  s_waitcnt vmcnt(17)
  ds_read_b64_tr_b16 a[208:209], v236 offset:0
  v_mfma_f32_16x16x32_bf16 v[8:11], a[240:243], a[184:187], v[8:11]
  ds_read_b64_tr_b16 a[210:211], v236 offset:2048
  v_mfma_f32_16x16x32_bf16 v[12:15], a[240:243], a[188:191], v[12:15]
  ds_read_b64_tr_b16 a[212:213], v237 offset:0
  v_mfma_f32_16x16x32_bf16 v[12:15], a[192:195], a[172:175], v[12:15]
  buffer_load_dwordx4 v244, s[24:27], s48 offen offset:1024 lds
  v_mfma_f32_16x16x32_bf16 v[28:31], a[196:199], a[172:175], v[28:31]
  ds_read_b64_tr_b16 a[214:215], v237 offset:2048
  v_mfma_f32_16x16x32_bf16 v[28:31], a[244:247], a[188:191], v[28:31]
  ds_read_b64_tr_b16 a[216:217], v238 offset:0
  v_mfma_f32_16x16x32_bf16 v[24:27], a[244:247], a[184:187], v[24:27]
  ds_read_b64_tr_b16 a[218:219], v238 offset:2048
  v_mfma_f32_16x16x32_bf16 v[24:27], a[196:199], a[168:171], v[24:27]
  buffer_load_dwordx4 v245, s[24:27], s48 offen offset:2048 lds
  v_mfma_f32_16x16x32_bf16 v[20:23], a[196:199], a[164:167], v[20:23]
  ds_read_b64_tr_b16 a[220:221], v239 offset:0
  v_mfma_f32_16x16x32_bf16 v[20:23], a[244:247], a[180:183], v[20:23]
  ds_read_b64_tr_b16 a[222:223], v239 offset:2048
  v_mfma_f32_16x16x32_bf16 v[16:19], a[244:247], a[176:179], v[16:19]
  v_mfma_f32_16x16x32_bf16 v[16:19], a[196:199], a[160:163], v[16:19]
  buffer_load_dwordx4 v246, s[24:27], s48 offen offset:3072 lds
  v_mfma_f32_16x16x32_bf16 v[32:35], a[200:203], a[160:163], v[32:35]
  ds_read_b128 a[136:139], v242 offset:18432
  v_mfma_f32_16x16x32_bf16 v[32:35], a[248:251], a[176:179], v[32:35]
  s_add_u32 m0, s43, 65536
  ds_read_b128 a[140:143], v242 offset:19456
  v_mfma_f32_16x16x32_bf16 v[36:39], a[248:251], a[180:183], v[36:39]
  s_add_u32 s48, s47, 196608
  ds_read_b128 a[20:23], v242 offset:37888
  v_mfma_f32_16x16x32_bf16 v[36:39], a[200:203], a[164:167], v[36:39]
  s_waitcnt lgkmcnt(3)
  buffer_load_dwordx4 v243, s[24:27], s48 offen lds
  v_mfma_f32_16x16x32_bf16 v[40:43], a[200:203], a[168:171], v[40:43]
  s_waitcnt vmcnt(17)
  ds_read_b64_tr_b16 a[224:225], v236 offset:4096
  v_mfma_f32_16x16x32_bf16 v[40:43], a[248:251], a[184:187], v[40:43]
  ds_read_b64_tr_b16 a[226:227], v236 offset:6144
  v_mfma_f32_16x16x32_bf16 v[44:47], a[248:251], a[188:191], v[44:47]
  ds_read_b64_tr_b16 a[228:229], v237 offset:4096
  v_mfma_f32_16x16x32_bf16 v[44:47], a[200:203], a[172:175], v[44:47]
  buffer_load_dwordx4 v244, s[24:27], s48 offen offset:1024 lds
  v_mfma_f32_16x16x32_bf16 v[60:63], a[204:207], a[172:175], v[60:63]
  ds_read_b64_tr_b16 a[230:231], v237 offset:6144
  v_mfma_f32_16x16x32_bf16 v[60:63], a[252:255], a[188:191], v[60:63]
  ds_read_b64_tr_b16 a[232:233], v238 offset:4096
  v_mfma_f32_16x16x32_bf16 v[56:59], a[252:255], a[184:187], v[56:59]
  ds_read_b64_tr_b16 a[234:235], v238 offset:6144
  v_mfma_f32_16x16x32_bf16 v[56:59], a[204:207], a[168:171], v[56:59]
  buffer_load_dwordx4 v245, s[24:27], s48 offen offset:2048 lds
  v_mfma_f32_16x16x32_bf16 v[52:55], a[204:207], a[164:167], v[52:55]
  ds_read_b64_tr_b16 a[236:237], v239 offset:4096
  v_mfma_f32_16x16x32_bf16 v[52:55], a[252:255], a[180:183], v[52:55]
  ds_read_b64_tr_b16 a[238:239], v239 offset:6144
  v_mfma_f32_16x16x32_bf16 v[48:51], a[252:255], a[176:179], v[48:51]
  v_mfma_f32_16x16x32_bf16 v[48:51], a[204:207], a[160:163], v[48:51]
  buffer_load_dwordx4 v246, s[24:27], s48 offen offset:3072 lds
  v_mfma_f32_16x16x32_bf16 v[64:67], a[208:211], a[160:163], v[64:67]
  s_waitcnt lgkmcnt(6)
  ds_read_b128 a[144:147], v242 offset:20480
  v_mfma_f32_16x16x32_bf16 v[64:67], a[224:227], a[176:179], v[64:67]
  s_add_u32 m0, s43, 69632
  ds_read_b128 a[148:151], v242 offset:21504
  v_mfma_f32_16x16x32_bf16 v[68:71], a[224:227], a[180:183], v[68:71]
  s_add_u32 s48, s47, 229376
  ds_read_b128 a[24:27], v242 offset:38912
  v_mfma_f32_16x16x32_bf16 v[68:71], a[208:211], a[164:167], v[68:71]
  s_waitcnt lgkmcnt(3)
  buffer_load_dwordx4 v243, s[24:27], s48 offen lds
  v_mfma_f32_16x16x32_bf16 v[72:75], a[208:211], a[168:171], v[72:75]
  s_waitcnt vmcnt(17)
  ds_read_b64_tr_b16 a[192:193], v232 offset:32768
  v_mfma_f32_16x16x32_bf16 v[72:75], a[224:227], a[184:187], v[72:75]
  ds_read_b64_tr_b16 a[194:195], v232 offset:34816
  v_mfma_f32_16x16x32_bf16 v[76:79], a[224:227], a[188:191], v[76:79]
  ds_read_b64_tr_b16 a[196:197], v233 offset:32768
  v_mfma_f32_16x16x32_bf16 v[76:79], a[208:211], a[172:175], v[76:79]
  buffer_load_dwordx4 v244, s[24:27], s48 offen offset:1024 lds
  v_mfma_f32_16x16x32_bf16 v[92:95], a[212:215], a[172:175], v[92:95]
  ds_read_b64_tr_b16 a[198:199], v233 offset:34816
  v_mfma_f32_16x16x32_bf16 v[92:95], a[228:231], a[188:191], v[92:95]
  ds_read_b64_tr_b16 a[200:201], v234 offset:32768
  v_mfma_f32_16x16x32_bf16 v[88:91], a[228:231], a[184:187], v[88:91]
  ds_read_b64_tr_b16 a[202:203], v234 offset:34816
  v_mfma_f32_16x16x32_bf16 v[88:91], a[212:215], a[168:171], v[88:91]
  buffer_load_dwordx4 v245, s[24:27], s48 offen offset:2048 lds
  v_mfma_f32_16x16x32_bf16 v[84:87], a[212:215], a[164:167], v[84:87]
  ds_read_b64_tr_b16 a[204:205], v235 offset:32768
  v_mfma_f32_16x16x32_bf16 v[84:87], a[228:231], a[180:183], v[84:87]
  ds_read_b64_tr_b16 a[206:207], v235 offset:34816
  v_mfma_f32_16x16x32_bf16 v[80:83], a[228:231], a[176:179], v[80:83]
  v_mfma_f32_16x16x32_bf16 v[80:83], a[212:215], a[160:163], v[80:83]
  buffer_load_dwordx4 v246, s[24:27], s48 offen offset:3072 lds
  v_mfma_f32_16x16x32_bf16 v[96:99], a[216:219], a[160:163], v[96:99]
  ds_read_b128 a[152:155], v242 offset:22528
  v_mfma_f32_16x16x32_bf16 v[96:99], a[232:235], a[176:179], v[96:99]
  s_add_u32 m0, s43, 32768
  ds_read_b128 a[156:159], v242 offset:23552
  v_mfma_f32_16x16x32_bf16 v[100:103], a[232:235], a[180:183], v[100:103]
  s_add_u32 s48, s47, 196736
  ds_read_b128 a[28:31], v242 offset:39936
  v_mfma_f32_16x16x32_bf16 v[100:103], a[216:219], a[164:167], v[100:103]
  s_waitcnt lgkmcnt(3)
  buffer_load_dwordx4 v243, s[24:27], s48 offen lds
  v_mfma_f32_16x16x32_bf16 v[104:107], a[216:219], a[168:171], v[104:107]
  s_waitcnt vmcnt(17)
  ds_read_b64_tr_b16 a[240:241], v232 offset:36864
  v_mfma_f32_16x16x32_bf16 v[104:107], a[232:235], a[184:187], v[104:107]
  ds_read_b64_tr_b16 a[242:243], v232 offset:38912
  v_mfma_f32_16x16x32_bf16 v[108:111], a[232:235], a[188:191], v[108:111]
  ds_read_b64_tr_b16 a[244:245], v233 offset:36864
  v_mfma_f32_16x16x32_bf16 v[108:111], a[216:219], a[172:175], v[108:111]
  buffer_load_dwordx4 v244, s[24:27], s48 offen offset:1024 lds
  v_mfma_f32_16x16x32_bf16 v[124:127], a[220:223], a[172:175], v[124:127]
  ds_read_b64_tr_b16 a[246:247], v233 offset:38912
  v_mfma_f32_16x16x32_bf16 v[124:127], a[236:239], a[188:191], v[124:127]
  ds_read_b64_tr_b16 a[248:249], v234 offset:36864
  v_mfma_f32_16x16x32_bf16 v[120:123], a[236:239], a[184:187], v[120:123]
  ds_read_b64_tr_b16 a[250:251], v234 offset:38912
  v_mfma_f32_16x16x32_bf16 v[120:123], a[220:223], a[168:171], v[120:123]
  buffer_load_dwordx4 v245, s[24:27], s48 offen offset:2048 lds
  v_mfma_f32_16x16x32_bf16 v[116:119], a[220:223], a[164:167], v[116:119]
  ds_read_b64_tr_b16 a[252:253], v235 offset:36864
  v_mfma_f32_16x16x32_bf16 v[116:119], a[236:239], a[180:183], v[116:119]
  ds_read_b64_tr_b16 a[254:255], v235 offset:38912
  v_mfma_f32_16x16x32_bf16 v[112:115], a[236:239], a[176:179], v[112:115]
  v_mfma_f32_16x16x32_bf16 v[112:115], a[220:223], a[160:163], v[112:115]
  buffer_load_dwordx4 v246, s[24:27], s48 offen offset:3072 lds
  v_mfma_f32_16x16x32_bf16 v[0:3], a[192:195], a[128:131], v[0:3]
  s_waitcnt lgkmcnt(6)
  ds_read_b128 a[160:163], v242 offset:24576
  v_mfma_f32_16x16x32_bf16 v[0:3], a[240:243], a[144:147], v[0:3]
  s_add_u32 m0, s43, 36864
  ds_read_b128 a[164:167], v242 offset:25600
  v_mfma_f32_16x16x32_bf16 v[4:7], a[240:243], a[148:151], v[4:7]
  s_add_u32 s48, s47, 229504
  ds_read_b128 a[32:35], v242 offset:40960
  v_mfma_f32_16x16x32_bf16 v[4:7], a[192:195], a[132:135], v[4:7]
  s_waitcnt lgkmcnt(3)
  buffer_load_dwordx4 v243, s[24:27], s48 offen lds
  v_mfma_f32_16x16x32_bf16 v[8:11], a[192:195], a[136:139], v[8:11]
  s_waitcnt vmcnt(17)
  ds_read_b64_tr_b16 a[208:209], v232 offset:0
  v_mfma_f32_16x16x32_bf16 v[8:11], a[240:243], a[152:155], v[8:11]
  ds_read_b64_tr_b16 a[210:211], v232 offset:2048
  v_mfma_f32_16x16x32_bf16 v[12:15], a[240:243], a[156:159], v[12:15]
  ds_read_b64_tr_b16 a[212:213], v233 offset:0
  v_mfma_f32_16x16x32_bf16 v[12:15], a[192:195], a[140:143], v[12:15]
  buffer_load_dwordx4 v244, s[24:27], s48 offen offset:1024 lds
  v_mfma_f32_16x16x32_bf16 v[28:31], a[196:199], a[140:143], v[28:31]
  ds_read_b64_tr_b16 a[214:215], v233 offset:2048
  v_mfma_f32_16x16x32_bf16 v[28:31], a[244:247], a[156:159], v[28:31]
  ds_read_b64_tr_b16 a[216:217], v234 offset:0
  v_mfma_f32_16x16x32_bf16 v[24:27], a[244:247], a[152:155], v[24:27]
  ds_read_b64_tr_b16 a[218:219], v234 offset:2048
  v_mfma_f32_16x16x32_bf16 v[24:27], a[196:199], a[136:139], v[24:27]
  buffer_load_dwordx4 v245, s[24:27], s48 offen offset:2048 lds
  v_mfma_f32_16x16x32_bf16 v[20:23], a[196:199], a[132:135], v[20:23]
  ds_read_b64_tr_b16 a[220:221], v235 offset:0
  v_mfma_f32_16x16x32_bf16 v[20:23], a[244:247], a[148:151], v[20:23]
  ds_read_b64_tr_b16 a[222:223], v235 offset:2048
  v_mfma_f32_16x16x32_bf16 v[16:19], a[244:247], a[144:147], v[16:19]
  v_mfma_f32_16x16x32_bf16 v[16:19], a[196:199], a[128:131], v[16:19]
  buffer_load_dwordx4 v246, s[24:27], s48 offen offset:3072 lds
  v_mfma_f32_16x16x32_bf16 v[32:35], a[200:203], a[128:131], v[32:35]
  ds_read_b128 a[168:171], v242 offset:26624
  v_mfma_f32_16x16x32_bf16 v[32:35], a[248:251], a[144:147], v[32:35]
  s_add_u32 m0, s43, 0
  ds_read_b128 a[172:175], v242 offset:27648
  v_mfma_f32_16x16x32_bf16 v[36:39], a[248:251], a[148:151], v[36:39]
  s_add_u32 s48, s47, 262144
  ds_read_b128 a[36:39], v242 offset:41984
  v_mfma_f32_16x16x32_bf16 v[36:39], a[200:203], a[132:135], v[36:39]
  s_waitcnt lgkmcnt(3)
  buffer_load_dwordx4 v243, s[24:27], s48 offen lds
  v_mfma_f32_16x16x32_bf16 v[40:43], a[200:203], a[136:139], v[40:43]
  s_waitcnt vmcnt(17)
  ds_read_b64_tr_b16 a[224:225], v232 offset:4096
  v_mfma_f32_16x16x32_bf16 v[40:43], a[248:251], a[152:155], v[40:43]
  ds_read_b64_tr_b16 a[226:227], v232 offset:6144
  v_mfma_f32_16x16x32_bf16 v[44:47], a[248:251], a[156:159], v[44:47]
  ds_read_b64_tr_b16 a[228:229], v233 offset:4096
  v_mfma_f32_16x16x32_bf16 v[44:47], a[200:203], a[140:143], v[44:47]
  buffer_load_dwordx4 v244, s[24:27], s48 offen offset:1024 lds
  v_mfma_f32_16x16x32_bf16 v[60:63], a[204:207], a[140:143], v[60:63]
  ds_read_b64_tr_b16 a[230:231], v233 offset:6144
  v_mfma_f32_16x16x32_bf16 v[60:63], a[252:255], a[156:159], v[60:63]
  ds_read_b64_tr_b16 a[232:233], v234 offset:4096
  v_mfma_f32_16x16x32_bf16 v[56:59], a[252:255], a[152:155], v[56:59]
  ds_read_b64_tr_b16 a[234:235], v234 offset:6144
  v_mfma_f32_16x16x32_bf16 v[56:59], a[204:207], a[136:139], v[56:59]
  buffer_load_dwordx4 v245, s[24:27], s48 offen offset:2048 lds
  v_mfma_f32_16x16x32_bf16 v[52:55], a[204:207], a[132:135], v[52:55]
  ds_read_b64_tr_b16 a[236:237], v235 offset:4096
  v_mfma_f32_16x16x32_bf16 v[52:55], a[252:255], a[148:151], v[52:55]
  ds_read_b64_tr_b16 a[238:239], v235 offset:6144
  v_mfma_f32_16x16x32_bf16 v[48:51], a[252:255], a[144:147], v[48:51]
  v_mfma_f32_16x16x32_bf16 v[48:51], a[204:207], a[128:131], v[48:51]
  buffer_load_dwordx4 v246, s[24:27], s48 offen offset:3072 lds
  v_mfma_f32_16x16x32_bf16 v[64:67], a[208:211], a[128:131], v[64:67]
  s_waitcnt lgkmcnt(6)
  ds_read_b128 a[176:179], v242 offset:28672
  v_mfma_f32_16x16x32_bf16 v[64:67], a[224:227], a[144:147], v[64:67]
  s_add_u32 m0, s43, 4096
  ds_read_b128 a[180:183], v242 offset:29696
  v_mfma_f32_16x16x32_bf16 v[68:71], a[224:227], a[148:151], v[68:71]
  s_add_u32 s48, s47, 294912
  ds_read_b128 a[40:43], v242 offset:43008
  v_mfma_f32_16x16x32_bf16 v[68:71], a[208:211], a[132:135], v[68:71]
  s_waitcnt lgkmcnt(3)
  buffer_load_dwordx4 v243, s[24:27], s48 offen lds
  v_mfma_f32_16x16x32_bf16 v[72:75], a[208:211], a[136:139], v[72:75]
  s_waitcnt vmcnt(17)
  ds_read_b64_tr_b16 a[192:193], v236 offset:0
  v_mfma_f32_16x16x32_bf16 v[72:75], a[224:227], a[152:155], v[72:75]
  ds_read_b64_tr_b16 a[194:195], v236 offset:2048
  v_mfma_f32_16x16x32_bf16 v[76:79], a[224:227], a[156:159], v[76:79]
  ds_read_b64_tr_b16 a[196:197], v237 offset:0
  v_mfma_f32_16x16x32_bf16 v[76:79], a[208:211], a[140:143], v[76:79]
  buffer_load_dwordx4 v244, s[24:27], s48 offen offset:1024 lds
  v_mfma_f32_16x16x32_bf16 v[92:95], a[212:215], a[140:143], v[92:95]
  ds_read_b64_tr_b16 a[198:199], v237 offset:2048
  v_mfma_f32_16x16x32_bf16 v[92:95], a[228:231], a[156:159], v[92:95]
  ds_read_b64_tr_b16 a[200:201], v238 offset:0
  v_mfma_f32_16x16x32_bf16 v[88:91], a[228:231], a[152:155], v[88:91]
  ds_read_b64_tr_b16 a[202:203], v238 offset:2048
  v_mfma_f32_16x16x32_bf16 v[88:91], a[212:215], a[136:139], v[88:91]
  buffer_load_dwordx4 v245, s[24:27], s48 offen offset:2048 lds
  v_mfma_f32_16x16x32_bf16 v[84:87], a[212:215], a[132:135], v[84:87]
  ds_read_b64_tr_b16 a[204:205], v239 offset:0
  v_mfma_f32_16x16x32_bf16 v[84:87], a[228:231], a[148:151], v[84:87]
  ds_read_b64_tr_b16 a[206:207], v239 offset:2048
  v_mfma_f32_16x16x32_bf16 v[80:83], a[228:231], a[144:147], v[80:83]
  v_mfma_f32_16x16x32_bf16 v[80:83], a[212:215], a[128:131], v[80:83]
  buffer_load_dwordx4 v246, s[24:27], s48 offen offset:3072 lds
  v_mfma_f32_16x16x32_bf16 v[96:99], a[216:219], a[128:131], v[96:99]
  ds_read_b128 a[184:187], v242 offset:30720
  v_mfma_f32_16x16x32_bf16 v[96:99], a[232:235], a[144:147], v[96:99]
  s_add_u32 m0, s43, 65536
  ds_read_b128 a[188:191], v242 offset:31744
  v_mfma_f32_16x16x32_bf16 v[100:103], a[232:235], a[148:151], v[100:103]
  s_add_u32 s48, s47, 327680
  ds_read_b128 a[44:47], v242 offset:44032
  v_mfma_f32_16x16x32_bf16 v[100:103], a[216:219], a[132:135], v[100:103]
  s_waitcnt lgkmcnt(3)
  buffer_load_dwordx4 v243, s[24:27], s48 offen lds
  v_mfma_f32_16x16x32_bf16 v[104:107], a[216:219], a[136:139], v[104:107]
  s_waitcnt vmcnt(17)
  ds_read_b64_tr_b16 a[240:241], v236 offset:4096
  v_mfma_f32_16x16x32_bf16 v[104:107], a[232:235], a[152:155], v[104:107]
  ds_read_b64_tr_b16 a[242:243], v236 offset:6144
  v_mfma_f32_16x16x32_bf16 v[108:111], a[232:235], a[156:159], v[108:111]
  ds_read_b64_tr_b16 a[244:245], v237 offset:4096
  v_mfma_f32_16x16x32_bf16 v[108:111], a[216:219], a[140:143], v[108:111]
  buffer_load_dwordx4 v244, s[24:27], s48 offen offset:1024 lds
  v_mfma_f32_16x16x32_bf16 v[124:127], a[220:223], a[140:143], v[124:127]
  ds_read_b64_tr_b16 a[246:247], v237 offset:6144
  v_mfma_f32_16x16x32_bf16 v[124:127], a[236:239], a[156:159], v[124:127]
  ds_read_b64_tr_b16 a[248:249], v238 offset:4096
  v_mfma_f32_16x16x32_bf16 v[120:123], a[236:239], a[152:155], v[120:123]
  ds_read_b64_tr_b16 a[250:251], v238 offset:6144
  v_mfma_f32_16x16x32_bf16 v[120:123], a[220:223], a[136:139], v[120:123]
  buffer_load_dwordx4 v245, s[24:27], s48 offen offset:2048 lds
  v_mfma_f32_16x16x32_bf16 v[116:119], a[220:223], a[132:135], v[116:119]
  ds_read_b64_tr_b16 a[252:253], v239 offset:4096
  v_mfma_f32_16x16x32_bf16 v[116:119], a[236:239], a[148:151], v[116:119]
  ds_read_b64_tr_b16 a[254:255], v239 offset:6144
  v_mfma_f32_16x16x32_bf16 v[112:115], a[236:239], a[144:147], v[112:115]
  v_mfma_f32_16x16x32_bf16 v[112:115], a[220:223], a[128:131], v[112:115]
  buffer_load_dwordx4 v246, s[24:27], s48 offen offset:3072 lds
  v_mfma_f32_16x16x32_bf16 v[0:3], a[192:195], a[160:163], v[0:3]
  s_waitcnt lgkmcnt(6)
  ds_read_b128 a[48:51], v242 offset:45056
  v_mfma_f32_16x16x32_bf16 v[0:3], a[240:243], a[176:179], v[0:3]
  s_add_u32 m0, s43, 69632
  ds_read_b128 a[52:55], v242 offset:46080
  v_mfma_f32_16x16x32_bf16 v[4:7], a[240:243], a[180:183], v[4:7]
  s_add_u32 s48, s47, 360448
  ds_read_b128 a[56:59], v242 offset:47104
  v_mfma_f32_16x16x32_bf16 v[4:7], a[192:195], a[164:167], v[4:7]
  s_waitcnt lgkmcnt(3)
  buffer_load_dwordx4 v243, s[24:27], s48 offen lds
  v_mfma_f32_16x16x32_bf16 v[8:11], a[192:195], a[168:171], v[8:11]
  s_waitcnt vmcnt(17)
  ds_read_b64_tr_b16 a[208:209], v232 offset:32768
  v_mfma_f32_16x16x32_bf16 v[8:11], a[240:243], a[184:187], v[8:11]
  ds_read_b64_tr_b16 a[210:211], v232 offset:34816
  v_mfma_f32_16x16x32_bf16 v[12:15], a[240:243], a[188:191], v[12:15]
  ds_read_b64_tr_b16 a[212:213], v233 offset:32768
  v_mfma_f32_16x16x32_bf16 v[12:15], a[192:195], a[172:175], v[12:15]
  buffer_load_dwordx4 v244, s[24:27], s48 offen offset:1024 lds
  v_mfma_f32_16x16x32_bf16 v[28:31], a[196:199], a[172:175], v[28:31]
  ds_read_b64_tr_b16 a[214:215], v233 offset:34816
  v_mfma_f32_16x16x32_bf16 v[28:31], a[244:247], a[188:191], v[28:31]
  ds_read_b64_tr_b16 a[216:217], v234 offset:32768
  v_mfma_f32_16x16x32_bf16 v[24:27], a[244:247], a[184:187], v[24:27]
  ds_read_b64_tr_b16 a[218:219], v234 offset:34816
  v_mfma_f32_16x16x32_bf16 v[24:27], a[196:199], a[168:171], v[24:27]
  buffer_load_dwordx4 v245, s[24:27], s48 offen offset:2048 lds
  v_mfma_f32_16x16x32_bf16 v[20:23], a[196:199], a[164:167], v[20:23]
  ds_read_b64_tr_b16 a[220:221], v235 offset:32768
  v_mfma_f32_16x16x32_bf16 v[20:23], a[244:247], a[180:183], v[20:23]
  ds_read_b64_tr_b16 a[222:223], v235 offset:34816
  v_mfma_f32_16x16x32_bf16 v[16:19], a[244:247], a[176:179], v[16:19]
  v_mfma_f32_16x16x32_bf16 v[16:19], a[196:199], a[160:163], v[16:19]
  buffer_load_dwordx4 v246, s[24:27], s48 offen offset:3072 lds
  v_mfma_f32_16x16x32_bf16 v[32:35], a[200:203], a[160:163], v[32:35]
  ds_read_b128 a[60:63], v242 offset:48128
  v_mfma_f32_16x16x32_bf16 v[32:35], a[248:251], a[176:179], v[32:35]
  s_add_u32 m0, s43, 32768
  ds_read_b128 a[64:67], v242 offset:49152
  v_mfma_f32_16x16x32_bf16 v[36:39], a[248:251], a[180:183], v[36:39]
  s_add_u32 s48, s47, 393216
  ds_read_b128 a[68:71], v242 offset:50176
  v_mfma_f32_16x16x32_bf16 v[36:39], a[200:203], a[164:167], v[36:39]
  s_waitcnt lgkmcnt(3)
  buffer_load_dwordx4 v243, s[24:27], s48 offen lds
  v_mfma_f32_16x16x32_bf16 v[40:43], a[200:203], a[168:171], v[40:43]
  s_waitcnt vmcnt(17)
  ds_read_b64_tr_b16 a[224:225], v232 offset:36864
  v_mfma_f32_16x16x32_bf16 v[40:43], a[248:251], a[184:187], v[40:43]
  ds_read_b64_tr_b16 a[226:227], v232 offset:38912
  v_mfma_f32_16x16x32_bf16 v[44:47], a[248:251], a[188:191], v[44:47]
  ds_read_b64_tr_b16 a[228:229], v233 offset:36864
  v_mfma_f32_16x16x32_bf16 v[44:47], a[200:203], a[172:175], v[44:47]
  buffer_load_dwordx4 v244, s[24:27], s48 offen offset:1024 lds
  v_mfma_f32_16x16x32_bf16 v[60:63], a[204:207], a[172:175], v[60:63]
  ds_read_b64_tr_b16 a[230:231], v233 offset:38912
  v_mfma_f32_16x16x32_bf16 v[60:63], a[252:255], a[188:191], v[60:63]
  ds_read_b64_tr_b16 a[232:233], v234 offset:36864
  v_mfma_f32_16x16x32_bf16 v[56:59], a[252:255], a[184:187], v[56:59]
  ds_read_b64_tr_b16 a[234:235], v234 offset:38912
  v_mfma_f32_16x16x32_bf16 v[56:59], a[204:207], a[168:171], v[56:59]
  buffer_load_dwordx4 v245, s[24:27], s48 offen offset:2048 lds
  v_mfma_f32_16x16x32_bf16 v[52:55], a[204:207], a[164:167], v[52:55]
L_hop11:
  s_cbranch_execz L_hop_done
  ds_read_b64_tr_b16 a[236:237], v235 offset:36864
  v_mfma_f32_16x16x32_bf16 v[52:55], a[252:255], a[180:183], v[52:55]
  ds_read_b64_tr_b16 a[238:239], v235 offset:38912
  v_mfma_f32_16x16x32_bf16 v[48:51], a[252:255], a[176:179], v[48:51]
  v_mfma_f32_16x16x32_bf16 v[48:51], a[204:207], a[160:163], v[48:51]
  buffer_load_dwordx4 v246, s[24:27], s48 offen offset:3072 lds
  v_mfma_f32_16x16x32_bf16 v[64:67], a[208:211], a[160:163], v[64:67]
  s_waitcnt lgkmcnt(6)
  ds_read_b128 a[72:75], v242 offset:51200
  v_mfma_f32_16x16x32_bf16 v[64:67], a[224:227], a[176:179], v[64:67]
  s_add_u32 m0, s43, 36864
  ds_read_b128 a[76:79], v242 offset:52224
  v_mfma_f32_16x16x32_bf16 v[68:71], a[224:227], a[180:183], v[68:71]
  s_add_u32 s48, s47, 425984
  ds_read_b128 a[80:83], v242 offset:53248
  v_mfma_f32_16x16x32_bf16 v[68:71], a[208:211], a[164:167], v[68:71]
  s_waitcnt lgkmcnt(3)
  buffer_load_dwordx4 v243, s[24:27], s48 offen lds
  v_mfma_f32_16x16x32_bf16 v[72:75], a[208:211], a[168:171], v[72:75]
  s_waitcnt vmcnt(17)
  ds_read_b64_tr_b16 a[192:193], v232 offset:0
  v_mfma_f32_16x16x32_bf16 v[72:75], a[224:227], a[184:187], v[72:75]
  ds_read_b64_tr_b16 a[194:195], v232 offset:2048
  v_mfma_f32_16x16x32_bf16 v[76:79], a[224:227], a[188:191], v[76:79]
  ds_read_b64_tr_b16 a[196:197], v233 offset:0
  v_mfma_f32_16x16x32_bf16 v[76:79], a[208:211], a[172:175], v[76:79]
  buffer_load_dwordx4 v244, s[24:27], s48 offen offset:1024 lds
  v_mfma_f32_16x16x32_bf16 v[92:95], a[212:215], a[172:175], v[92:95]
  ds_read_b64_tr_b16 a[198:199], v233 offset:2048
  v_mfma_f32_16x16x32_bf16 v[92:95], a[228:231], a[188:191], v[92:95]
  ds_read_b64_tr_b16 a[200:201], v234 offset:0
  v_mfma_f32_16x16x32_bf16 v[88:91], a[228:231], a[184:187], v[88:91]
  ds_read_b64_tr_b16 a[202:203], v234 offset:2048
  v_mfma_f32_16x16x32_bf16 v[88:91], a[212:215], a[168:171], v[88:91]
  buffer_load_dwordx4 v245, s[24:27], s48 offen offset:2048 lds
  v_mfma_f32_16x16x32_bf16 v[84:87], a[212:215], a[164:167], v[84:87]
  ds_read_b64_tr_b16 a[204:205], v235 offset:0
  v_mfma_f32_16x16x32_bf16 v[84:87], a[228:231], a[180:183], v[84:87]
  ds_read_b64_tr_b16 a[206:207], v235 offset:2048
  v_mfma_f32_16x16x32_bf16 v[80:83], a[228:231], a[176:179], v[80:83]
  v_mfma_f32_16x16x32_bf16 v[80:83], a[212:215], a[160:163], v[80:83]
  buffer_load_dwordx4 v246, s[24:27], s48 offen offset:3072 lds
  v_mfma_f32_16x16x32_bf16 v[96:99], a[216:219], a[160:163], v[96:99]
  ds_read_b128 a[84:87], v242 offset:54272
  v_mfma_f32_16x16x32_bf16 v[96:99], a[232:235], a[176:179], v[96:99]
  s_add_u32 m0, s43, 0
  ds_read_b128 a[88:91], v242 offset:55296
  v_mfma_f32_16x16x32_bf16 v[100:103], a[232:235], a[180:183], v[100:103]
  s_add_u32 s48, s47, 458752
  ds_read_b128 a[92:95], v242 offset:56320
  v_mfma_f32_16x16x32_bf16 v[100:103], a[216:219], a[164:167], v[100:103]
  s_waitcnt lgkmcnt(3)
  buffer_load_dwordx4 v243, s[24:27], s48 offen lds
  v_mfma_f32_16x16x32_bf16 v[104:107], a[216:219], a[168:171], v[104:107]
  s_waitcnt vmcnt(17)
  ds_read_b64_tr_b16 a[240:241], v232 offset:4096
  v_mfma_f32_16x16x32_bf16 v[104:107], a[232:235], a[184:187], v[104:107]
  ds_read_b64_tr_b16 a[242:243], v232 offset:6144
  v_mfma_f32_16x16x32_bf16 v[108:111], a[232:235], a[188:191], v[108:111]
  ds_read_b64_tr_b16 a[244:245], v233 offset:4096
  v_mfma_f32_16x16x32_bf16 v[108:111], a[216:219], a[172:175], v[108:111]
  buffer_load_dwordx4 v244, s[24:27], s48 offen offset:1024 lds
  v_mfma_f32_16x16x32_bf16 v[124:127], a[220:223], a[172:175], v[124:127]
  ds_read_b64_tr_b16 a[246:247], v233 offset:6144
  v_mfma_f32_16x16x32_bf16 v[124:127], a[236:239], a[188:191], v[124:127]
  ds_read_b64_tr_b16 a[248:249], v234 offset:4096
  v_mfma_f32_16x16x32_bf16 v[120:123], a[236:239], a[184:187], v[120:123]
  ds_read_b64_tr_b16 a[250:251], v234 offset:6144
  v_mfma_f32_16x16x32_bf16 v[120:123], a[220:223], a[168:171], v[120:123]
  buffer_load_dwordx4 v245, s[24:27], s48 offen offset:2048 lds
  v_mfma_f32_16x16x32_bf16 v[116:119], a[220:223], a[164:167], v[116:119]
  ds_read_b64_tr_b16 a[252:253], v235 offset:4096
  v_mfma_f32_16x16x32_bf16 v[116:119], a[236:239], a[180:183], v[116:119]
  ds_read_b64_tr_b16 a[254:255], v235 offset:6144
  v_mfma_f32_16x16x32_bf16 v[112:115], a[236:239], a[176:179], v[112:115]
  v_mfma_f32_16x16x32_bf16 v[112:115], a[220:223], a[160:163], v[112:115]
  buffer_load_dwordx4 v246, s[24:27], s48 offen offset:3072 lds
  v_mfma_f32_16x16x32_bf16 v[0:3], a[192:195], a[0:3], v[0:3]
  s_waitcnt lgkmcnt(6)
  ds_read_b128 a[96:99], v242 offset:57344
  v_mfma_f32_16x16x32_bf16 v[0:3], a[240:243], a[16:19], v[0:3]
  s_add_u32 m0, s43, 4096
  ds_read_b128 a[100:103], v242 offset:58368
  v_mfma_f32_16x16x32_bf16 v[4:7], a[240:243], a[20:23], v[4:7]
  s_add_u32 s48, s47, 491520
  ds_read_b128 a[104:107], v242 offset:59392
  v_mfma_f32_16x16x32_bf16 v[4:7], a[192:195], a[4:7], v[4:7]
  s_waitcnt lgkmcnt(3)
  buffer_load_dwordx4 v243, s[24:27], s48 offen lds
  v_mfma_f32_16x16x32_bf16 v[8:11], a[192:195], a[8:11], v[8:11]
  s_waitcnt vmcnt(17)
  ds_read_b64_tr_b16 a[208:209], v236 offset:0
  v_mfma_f32_16x16x32_bf16 v[8:11], a[240:243], a[24:27], v[8:11]
  ds_read_b64_tr_b16 a[210:211], v236 offset:2048
  v_mfma_f32_16x16x32_bf16 v[12:15], a[240:243], a[28:31], v[12:15]
  ds_read_b64_tr_b16 a[212:213], v237 offset:0
  v_mfma_f32_16x16x32_bf16 v[12:15], a[192:195], a[12:15], v[12:15]
  buffer_load_dwordx4 v244, s[24:27], s48 offen offset:1024 lds
  v_mfma_f32_16x16x32_bf16 v[28:31], a[196:199], a[12:15], v[28:31]
  ds_read_b64_tr_b16 a[214:215], v237 offset:2048
  v_mfma_f32_16x16x32_bf16 v[28:31], a[244:247], a[28:31], v[28:31]
  ds_read_b64_tr_b16 a[216:217], v238 offset:0
  v_mfma_f32_16x16x32_bf16 v[24:27], a[244:247], a[24:27], v[24:27]
  ds_read_b64_tr_b16 a[218:219], v238 offset:2048
  v_mfma_f32_16x16x32_bf16 v[24:27], a[196:199], a[8:11], v[24:27]
  buffer_load_dwordx4 v245, s[24:27], s48 offen offset:2048 lds
  v_mfma_f32_16x16x32_bf16 v[20:23], a[196:199], a[4:7], v[20:23]
  ds_read_b64_tr_b16 a[220:221], v239 offset:0
  v_mfma_f32_16x16x32_bf16 v[20:23], a[244:247], a[20:23], v[20:23]
  ds_read_b64_tr_b16 a[222:223], v239 offset:2048
  v_mfma_f32_16x16x32_bf16 v[16:19], a[244:247], a[16:19], v[16:19]
  v_mfma_f32_16x16x32_bf16 v[16:19], a[196:199], a[0:3], v[16:19]
  buffer_load_dwordx4 v246, s[24:27], s48 offen offset:3072 lds
  v_mfma_f32_16x16x32_bf16 v[32:35], a[200:203], a[0:3], v[32:35]
  ds_read_b128 a[108:111], v242 offset:60416
  v_mfma_f32_16x16x32_bf16 v[32:35], a[248:251], a[16:19], v[32:35]
  s_add_u32 m0, s43, 65536
  ds_read_b128 a[112:115], v242 offset:61440
  v_mfma_f32_16x16x32_bf16 v[36:39], a[248:251], a[20:23], v[36:39]
  s_add_u32 s48, s47, 262272
  ds_read_b128 a[116:119], v242 offset:62464
  v_mfma_f32_16x16x32_bf16 v[36:39], a[200:203], a[4:7], v[36:39]
  s_waitcnt lgkmcnt(3)
  buffer_load_dwordx4 v243, s[24:27], s48 offen lds
  v_mfma_f32_16x16x32_bf16 v[40:43], a[200:203], a[8:11], v[40:43]
  s_waitcnt vmcnt(17)
  ds_read_b64_tr_b16 a[224:225], v236 offset:4096
  v_mfma_f32_16x16x32_bf16 v[40:43], a[248:251], a[24:27], v[40:43]
  ds_read_b64_tr_b16 a[226:227], v236 offset:6144
  v_mfma_f32_16x16x32_bf16 v[44:47], a[248:251], a[28:31], v[44:47]
  ds_read_b64_tr_b16 a[228:229], v237 offset:4096
  v_mfma_f32_16x16x32_bf16 v[44:47], a[200:203], a[12:15], v[44:47]
  buffer_load_dwordx4 v244, s[24:27], s48 offen offset:1024 lds
  v_mfma_f32_16x16x32_bf16 v[60:63], a[204:207], a[12:15], v[60:63]
  ds_read_b64_tr_b16 a[230:231], v237 offset:6144
  v_mfma_f32_16x16x32_bf16 v[60:63], a[252:255], a[28:31], v[60:63]
  ds_read_b64_tr_b16 a[232:233], v238 offset:4096
  v_mfma_f32_16x16x32_bf16 v[56:59], a[252:255], a[24:27], v[56:59]
  ds_read_b64_tr_b16 a[234:235], v238 offset:6144
  v_mfma_f32_16x16x32_bf16 v[56:59], a[204:207], a[8:11], v[56:59]
  buffer_load_dwordx4 v245, s[24:27], s48 offen offset:2048 lds
  v_mfma_f32_16x16x32_bf16 v[52:55], a[204:207], a[4:7], v[52:55]
  ds_read_b64_tr_b16 a[236:237], v239 offset:4096
  v_mfma_f32_16x16x32_bf16 v[52:55], a[252:255], a[20:23], v[52:55]
  ds_read_b64_tr_b16 a[238:239], v239 offset:6144
  v_mfma_f32_16x16x32_bf16 v[48:51], a[252:255], a[16:19], v[48:51]
  v_mfma_f32_16x16x32_bf16 v[48:51], a[204:207], a[0:3], v[48:51]
  buffer_load_dwordx4 v246, s[24:27], s48 offen offset:3072 lds
  v_mfma_f32_16x16x32_bf16 v[0:3], a[208:211], a[32:35], v[0:3]
  s_waitcnt lgkmcnt(6)
  ds_read_b128 a[120:123], v242 offset:63488
  v_mfma_f32_16x16x32_bf16 v[0:3], a[224:227], a[48:51], v[0:3]
  s_add_u32 m0, s43, 69632
  ds_read_b128 a[124:127], v242 offset:64512
  v_mfma_f32_16x16x32_bf16 v[4:7], a[224:227], a[52:55], v[4:7]
  s_waitcnt vmcnt(16)
  s_add_u32 s48, s47, 295040
  ds_read_b64_tr_b16 a[192:193], v232 offset:32768
  v_mfma_f32_16x16x32_bf16 v[4:7], a[208:211], a[36:39], v[4:7]
  s_waitcnt lgkmcnt(3)
  buffer_load_dwordx4 v243, s[24:27], s48 offen lds
  v_mfma_f32_16x16x32_bf16 v[8:11], a[208:211], a[40:43], v[8:11]
  ds_read_b64_tr_b16 a[194:195], v232 offset:34816
  v_mfma_f32_16x16x32_bf16 v[8:11], a[224:227], a[56:59], v[8:11]
  ds_read_b64_tr_b16 a[196:197], v233 offset:32768
  v_mfma_f32_16x16x32_bf16 v[12:15], a[224:227], a[60:63], v[12:15]
  ds_read_b64_tr_b16 a[198:199], v233 offset:34816
  v_mfma_f32_16x16x32_bf16 v[12:15], a[208:211], a[44:47], v[12:15]
  buffer_load_dwordx4 v244, s[24:27], s48 offen offset:1024 lds
  v_mfma_f32_16x16x32_bf16 v[28:31], a[212:215], a[44:47], v[28:31]
  ds_read_b64_tr_b16 a[200:201], v234 offset:32768
  v_mfma_f32_16x16x32_bf16 v[28:31], a[228:231], a[60:63], v[28:31]
  ds_read_b64_tr_b16 a[202:203], v234 offset:34816
  v_mfma_f32_16x16x32_bf16 v[24:27], a[228:231], a[56:59], v[24:27]
  ds_read_b64_tr_b16 a[204:205], v235 offset:32768
  v_mfma_f32_16x16x32_bf16 v[24:27], a[212:215], a[40:43], v[24:27]
  buffer_load_dwordx4 v245, s[24:27], s48 offen offset:2048 lds
  v_mfma_f32_16x16x32_bf16 v[20:23], a[212:215], a[36:39], v[20:23]
  ds_read_b64_tr_b16 a[206:207], v235 offset:34816
  v_mfma_f32_16x16x32_bf16 v[20:23], a[228:231], a[52:55], v[20:23]
  v_mfma_f32_16x16x32_bf16 v[16:19], a[228:231], a[48:51], v[16:19]
  v_mfma_f32_16x16x32_bf16 v[16:19], a[212:215], a[32:35], v[16:19]
  buffer_load_dwordx4 v246, s[24:27], s48 offen offset:3072 lds
  v_mfma_f32_16x16x32_bf16 v[32:35], a[216:219], a[32:35], v[32:35]
  s_waitcnt vmcnt(16)
  ds_read_b64_tr_b16 a[240:241], v232 offset:36864
  v_mfma_f32_16x16x32_bf16 v[32:35], a[232:235], a[48:51], v[32:35]
  s_add_u32 m0, s43, 32768
  ds_read_b64_tr_b16 a[242:243], v232 offset:38912
  v_mfma_f32_16x16x32_bf16 v[36:39], a[232:235], a[52:55], v[36:39]
  s_add_u32 s48, s47, 327808
  ds_read_b64_tr_b16 a[244:245], v233 offset:36864
  v_mfma_f32_16x16x32_bf16 v[36:39], a[216:219], a[36:39], v[36:39]
  s_waitcnt lgkmcnt(3)
  buffer_load_dwordx4 v243, s[24:27], s48 offen lds
  v_mfma_f32_16x16x32_bf16 v[40:43], a[216:219], a[40:43], v[40:43]
  ds_read_b64_tr_b16 a[246:247], v233 offset:38912
  v_mfma_f32_16x16x32_bf16 v[40:43], a[232:235], a[56:59], v[40:43]
  ds_read_b64_tr_b16 a[248:249], v234 offset:36864
  v_mfma_f32_16x16x32_bf16 v[44:47], a[232:235], a[60:63], v[44:47]
  ds_read_b64_tr_b16 a[250:251], v234 offset:38912
  v_mfma_f32_16x16x32_bf16 v[44:47], a[216:219], a[44:47], v[44:47]
  buffer_load_dwordx4 v244, s[24:27], s48 offen offset:1024 lds
  v_mfma_f32_16x16x32_bf16 v[60:63], a[220:223], a[44:47], v[60:63]
  ds_read_b64_tr_b16 a[252:253], v235 offset:36864
  v_mfma_f32_16x16x32_bf16 v[60:63], a[236:239], a[60:63], v[60:63]
  ds_read_b64_tr_b16 a[254:255], v235 offset:38912
  v_mfma_f32_16x16x32_bf16 v[56:59], a[236:239], a[56:59], v[56:59]
  v_mfma_f32_16x16x32_bf16 v[56:59], a[220:223], a[40:43], v[56:59]
  buffer_load_dwordx4 v245, s[24:27], s48 offen offset:2048 lds
  v_mfma_f32_16x16x32_bf16 v[52:55], a[220:223], a[36:39], v[52:55]
  v_mfma_f32_16x16x32_bf16 v[52:55], a[236:239], a[52:55], v[52:55]
  v_mfma_f32_16x16x32_bf16 v[48:51], a[236:239], a[48:51], v[48:51]
  v_mfma_f32_16x16x32_bf16 v[48:51], a[220:223], a[32:35], v[48:51]
  buffer_load_dwordx4 v246, s[24:27], s48 offen offset:3072 lds
  v_mfma_f32_16x16x32_bf16 v[0:3], a[192:195], a[64:67], v[0:3]
  s_waitcnt vmcnt(16)
  s_waitcnt lgkmcnt(6)
  ds_read_b64_tr_b16 a[208:209], v232 offset:0
  v_mfma_f32_16x16x32_bf16 v[0:3], a[240:243], a[80:83], v[0:3]
  s_add_u32 m0, s43, 36864
  ds_read_b64_tr_b16 a[210:211], v232 offset:2048
  v_mfma_f32_16x16x32_bf16 v[4:7], a[240:243], a[84:87], v[4:7]
  s_add_u32 s48, s47, 360576
  ds_read_b64_tr_b16 a[212:213], v233 offset:0
  v_mfma_f32_16x16x32_bf16 v[4:7], a[192:195], a[68:71], v[4:7]
  s_waitcnt lgkmcnt(3)
  buffer_load_dwordx4 v243, s[24:27], s48 offen lds
  v_mfma_f32_16x16x32_bf16 v[8:11], a[192:195], a[72:75], v[8:11]
  ds_read_b64_tr_b16 a[214:215], v233 offset:2048
  v_mfma_f32_16x16x32_bf16 v[8:11], a[240:243], a[88:91], v[8:11]
  ds_read_b64_tr_b16 a[216:217], v234 offset:0
  v_mfma_f32_16x16x32_bf16 v[12:15], a[240:243], a[92:95], v[12:15]
  ds_read_b64_tr_b16 a[218:219], v234 offset:2048
  v_mfma_f32_16x16x32_bf16 v[12:15], a[192:195], a[76:79], v[12:15]
  buffer_load_dwordx4 v244, s[24:27], s48 offen offset:1024 lds
  v_mfma_f32_16x16x32_bf16 v[28:31], a[196:199], a[76:79], v[28:31]
  ds_read_b64_tr_b16 a[220:221], v235 offset:0
  v_mfma_f32_16x16x32_bf16 v[28:31], a[244:247], a[92:95], v[28:31]
  ds_read_b64_tr_b16 a[222:223], v235 offset:2048
  v_mfma_f32_16x16x32_bf16 v[24:27], a[244:247], a[88:91], v[24:27]
  v_mfma_f32_16x16x32_bf16 v[24:27], a[196:199], a[72:75], v[24:27]
  buffer_load_dwordx4 v245, s[24:27], s48 offen offset:2048 lds
  v_mfma_f32_16x16x32_bf16 v[20:23], a[196:199], a[68:71], v[20:23]
  v_mfma_f32_16x16x32_bf16 v[20:23], a[244:247], a[84:87], v[20:23]
  v_mfma_f32_16x16x32_bf16 v[16:19], a[244:247], a[80:83], v[16:19]
  v_mfma_f32_16x16x32_bf16 v[16:19], a[196:199], a[64:67], v[16:19]
  buffer_load_dwordx4 v246, s[24:27], s48 offen offset:3072 lds
  v_mfma_f32_16x16x32_bf16 v[32:35], a[200:203], a[64:67], v[32:35]
  s_waitcnt vmcnt(16)
  ds_read_b64_tr_b16 a[224:225], v232 offset:4096
  v_mfma_f32_16x16x32_bf16 v[32:35], a[248:251], a[80:83], v[32:35]
  s_add_u32 m0, s43, 0
  ds_read_b64_tr_b16 a[226:227], v232 offset:6144
  v_mfma_f32_16x16x32_bf16 v[36:39], a[248:251], a[84:87], v[36:39]
  s_add_u32 s48, s47, 393344
  ds_read_b64_tr_b16 a[228:229], v233 offset:4096
  v_mfma_f32_16x16x32_bf16 v[36:39], a[200:203], a[68:71], v[36:39]
  s_waitcnt lgkmcnt(3)
  buffer_load_dwordx4 v243, s[24:27], s48 offen lds
  v_mfma_f32_16x16x32_bf16 v[40:43], a[200:203], a[72:75], v[40:43]
  ds_read_b64_tr_b16 a[230:231], v233 offset:6144
  v_mfma_f32_16x16x32_bf16 v[40:43], a[248:251], a[88:91], v[40:43]
  ds_read_b64_tr_b16 a[232:233], v234 offset:4096
  v_mfma_f32_16x16x32_bf16 v[44:47], a[248:251], a[92:95], v[44:47]
  ds_read_b64_tr_b16 a[234:235], v234 offset:6144
  v_mfma_f32_16x16x32_bf16 v[44:47], a[200:203], a[76:79], v[44:47]
  buffer_load_dwordx4 v244, s[24:27], s48 offen offset:1024 lds
  v_mfma_f32_16x16x32_bf16 v[60:63], a[204:207], a[76:79], v[60:63]
  ds_read_b64_tr_b16 a[236:237], v235 offset:4096
  v_mfma_f32_16x16x32_bf16 v[60:63], a[252:255], a[92:95], v[60:63]
  ds_read_b64_tr_b16 a[238:239], v235 offset:6144
  v_mfma_f32_16x16x32_bf16 v[56:59], a[252:255], a[88:91], v[56:59]
  v_mfma_f32_16x16x32_bf16 v[56:59], a[204:207], a[72:75], v[56:59]
  buffer_load_dwordx4 v245, s[24:27], s48 offen offset:2048 lds
  v_mfma_f32_16x16x32_bf16 v[52:55], a[204:207], a[68:71], v[52:55]
  v_mfma_f32_16x16x32_bf16 v[52:55], a[252:255], a[84:87], v[52:55]
  v_mfma_f32_16x16x32_bf16 v[48:51], a[252:255], a[80:83], v[48:51]
  v_mfma_f32_16x16x32_bf16 v[48:51], a[204:207], a[64:67], v[48:51]
  buffer_load_dwordx4 v246, s[24:27], s48 offen offset:3072 lds
  v_mfma_f32_16x16x32_bf16 v[0:3], a[208:211], a[96:99], v[0:3]
  s_waitcnt vmcnt(16)
  s_waitcnt lgkmcnt(6)
  ds_read_b64_tr_b16 a[192:193], v236 offset:0
  v_mfma_f32_16x16x32_bf16 v[0:3], a[224:227], a[112:115], v[0:3]
  s_add_u32 m0, s43, 4096
  ds_read_b64_tr_b16 a[194:195], v236 offset:2048
  v_mfma_f32_16x16x32_bf16 v[4:7], a[224:227], a[116:119], v[4:7]
  s_add_u32 s48, s47, 426112
  ds_read_b64_tr_b16 a[196:197], v237 offset:0
  v_mfma_f32_16x16x32_bf16 v[4:7], a[208:211], a[100:103], v[4:7]
  s_waitcnt lgkmcnt(3)
  buffer_load_dwordx4 v243, s[24:27], s48 offen lds
  v_mfma_f32_16x16x32_bf16 v[8:11], a[208:211], a[104:107], v[8:11]
  ds_read_b64_tr_b16 a[198:199], v237 offset:2048
  v_mfma_f32_16x16x32_bf16 v[8:11], a[224:227], a[120:123], v[8:11]
  ds_read_b64_tr_b16 a[200:201], v238 offset:0
  v_mfma_f32_16x16x32_bf16 v[12:15], a[224:227], a[124:127], v[12:15]
  ds_read_b64_tr_b16 a[202:203], v238 offset:2048
  v_mfma_f32_16x16x32_bf16 v[12:15], a[208:211], a[108:111], v[12:15]
  buffer_load_dwordx4 v244, s[24:27], s48 offen offset:1024 lds
  v_mfma_f32_16x16x32_bf16 v[28:31], a[212:215], a[108:111], v[28:31]
  ds_read_b64_tr_b16 a[204:205], v239 offset:0
  v_mfma_f32_16x16x32_bf16 v[28:31], a[228:231], a[124:127], v[28:31]
  ds_read_b64_tr_b16 a[206:207], v239 offset:2048
  v_mfma_f32_16x16x32_bf16 v[24:27], a[228:231], a[120:123], v[24:27]
  v_mfma_f32_16x16x32_bf16 v[24:27], a[212:215], a[104:107], v[24:27]
  buffer_load_dwordx4 v245, s[24:27], s48 offen offset:2048 lds
  v_mfma_f32_16x16x32_bf16 v[20:23], a[212:215], a[100:103], v[20:23]
  v_mfma_f32_16x16x32_bf16 v[20:23], a[228:231], a[116:119], v[20:23]
  v_mfma_f32_16x16x32_bf16 v[16:19], a[228:231], a[112:115], v[16:19]
  v_mfma_f32_16x16x32_bf16 v[16:19], a[212:215], a[96:99], v[16:19]
  buffer_load_dwordx4 v246, s[24:27], s48 offen offset:3072 lds
  v_mfma_f32_16x16x32_bf16 v[32:35], a[216:219], a[96:99], v[32:35]
  s_waitcnt vmcnt(16)
  ds_read_b64_tr_b16 a[240:241], v236 offset:4096
  v_mfma_f32_16x16x32_bf16 v[32:35], a[232:235], a[112:115], v[32:35]
  s_add_u32 m0, s43, 65536
  ds_read_b64_tr_b16 a[242:243], v236 offset:6144
  v_mfma_f32_16x16x32_bf16 v[36:39], a[232:235], a[116:119], v[36:39]
  s_add_u32 s48, s47, 458880
  ds_read_b64_tr_b16 a[244:245], v237 offset:4096
  v_mfma_f32_16x16x32_bf16 v[36:39], a[216:219], a[100:103], v[36:39]
  s_waitcnt lgkmcnt(3)
  buffer_load_dwordx4 v243, s[24:27], s48 offen lds
  v_mfma_f32_16x16x32_bf16 v[40:43], a[216:219], a[104:107], v[40:43]
  ds_read_b64_tr_b16 a[246:247], v237 offset:6144
  v_mfma_f32_16x16x32_bf16 v[40:43], a[232:235], a[120:123], v[40:43]
  ds_read_b64_tr_b16 a[248:249], v238 offset:4096
  v_mfma_f32_16x16x32_bf16 v[44:47], a[232:235], a[124:127], v[44:47]
  ds_read_b64_tr_b16 a[250:251], v238 offset:6144
  v_mfma_f32_16x16x32_bf16 v[44:47], a[216:219], a[108:111], v[44:47]
  buffer_load_dwordx4 v244, s[24:27], s48 offen offset:1024 lds
  v_mfma_f32_16x16x32_bf16 v[60:63], a[220:223], a[108:111], v[60:63]
  ds_read_b64_tr_b16 a[252:253], v239 offset:4096
  v_mfma_f32_16x16x32_bf16 v[60:63], a[236:239], a[124:127], v[60:63]
  ds_read_b64_tr_b16 a[254:255], v239 offset:6144
  v_mfma_f32_16x16x32_bf16 v[56:59], a[236:239], a[120:123], v[56:59]
  v_mfma_f32_16x16x32_bf16 v[56:59], a[220:223], a[104:107], v[56:59]
  buffer_load_dwordx4 v245, s[24:27], s48 offen offset:2048 lds
  v_mfma_f32_16x16x32_bf16 v[52:55], a[220:223], a[100:103], v[52:55]
  v_mfma_f32_16x16x32_bf16 v[52:55], a[236:239], a[116:119], v[52:55]
  v_mfma_f32_16x16x32_bf16 v[48:51], a[236:239], a[112:115], v[48:51]
  v_mfma_f32_16x16x32_bf16 v[48:51], a[220:223], a[96:99], v[48:51]
  buffer_load_dwordx4 v246, s[24:27], s48 offen offset:3072 lds
  v_mfma_f32_16x16x32_bf16 v[64:67], a[192:195], a[0:3], v[64:67]
  s_waitcnt vmcnt(16)
  s_waitcnt lgkmcnt(6)
  ds_read_b64_tr_b16 a[208:209], v232 offset:32768
  v_mfma_f32_16x16x32_bf16 v[64:67], a[240:243], a[16:19], v[64:67]
  s_add_u32 m0, s43, 69632
  ds_read_b64_tr_b16 a[210:211], v232 offset:34816
  v_cvt_pk_bf16_f32 v0, v0, v1
  v_mfma_f32_16x16x32_bf16 v[68:71], a[240:243], a[20:23], v[68:71]
  s_add_u32 s48, s47, 491648
  ds_read_b64_tr_b16 a[212:213], v233 offset:32768
  v_cvt_pk_bf16_f32 v1, v2, v3
  v_mfma_f32_16x16x32_bf16 v[68:71], a[192:195], a[4:7], v[68:71]
  s_waitcnt lgkmcnt(3)
  buffer_load_dwordx4 v243, s[24:27], s48 offen lds
  v_mfma_f32_16x16x32_bf16 v[72:75], a[192:195], a[8:11], v[72:75]
  ds_read_b64_tr_b16 a[214:215], v233 offset:34816
  v_cvt_pk_bf16_f32 v2, v16, v17
  v_mfma_f32_16x16x32_bf16 v[72:75], a[240:243], a[24:27], v[72:75]
  ds_read_b64_tr_b16 a[216:217], v234 offset:32768
  v_cvt_pk_bf16_f32 v3, v18, v19
  v_mfma_f32_16x16x32_bf16 v[76:79], a[240:243], a[28:31], v[76:79]
  ds_read_b64_tr_b16 a[218:219], v234 offset:34816
  v_mfma_f32_16x16x32_bf16 v[76:79], a[192:195], a[12:15], v[76:79]
  buffer_load_dwordx4 v244, s[24:27], s48 offen offset:1024 lds
  v_mfma_f32_16x16x32_bf16 v[92:95], a[196:199], a[12:15], v[92:95]
  ds_read_b64_tr_b16 a[220:221], v235 offset:32768
  v_mfma_f32_16x16x32_bf16 v[92:95], a[244:247], a[28:31], v[92:95]
  s_add_u32 s50, s56, 0
  ds_read_b64_tr_b16 a[222:223], v235 offset:34816
  v_mfma_f32_16x16x32_bf16 v[88:91], a[244:247], a[24:27], v[88:91]
  buffer_store_dwordx4 v[0:3], v217, s[36:39], s50 offen sc1
  v_mfma_f32_16x16x32_bf16 v[88:91], a[196:199], a[8:11], v[88:91]
  buffer_load_dwordx4 v245, s[24:27], s48 offen offset:2048 lds
  v_mfma_f32_16x16x32_bf16 v[84:87], a[196:199], a[4:7], v[84:87]
  v_mfma_f32_16x16x32_bf16 v[84:87], a[244:247], a[20:23], v[84:87]
  v_mfma_f32_16x16x32_bf16 v[80:83], a[244:247], a[16:19], v[80:83]
  v_mfma_f32_16x16x32_bf16 v[80:83], a[196:199], a[0:3], v[80:83]
  buffer_load_dwordx4 v246, s[24:27], s48 offen offset:3072 lds
  v_mfma_f32_16x16x32_bf16 v[96:99], a[200:203], a[0:3], v[96:99]
  s_waitcnt vmcnt(17)
  ds_read_b64_tr_b16 a[224:225], v232 offset:36864
  v_mfma_f32_16x16x32_bf16 v[96:99], a[248:251], a[16:19], v[96:99]
  ds_read_b64_tr_b16 a[226:227], v232 offset:38912
  v_cvt_pk_bf16_f32 v4, v4, v5
  v_mfma_f32_16x16x32_bf16 v[100:103], a[248:251], a[20:23], v[100:103]
  ds_read_b64_tr_b16 a[228:229], v233 offset:36864
  v_cvt_pk_bf16_f32 v5, v6, v7
  v_mfma_f32_16x16x32_bf16 v[100:103], a[200:203], a[4:7], v[100:103]
  ds_read_b64_tr_b16 a[230:231], v233 offset:38912
  v_cvt_pk_bf16_f32 v6, v20, v21
  v_mfma_f32_16x16x32_bf16 v[104:107], a[200:203], a[8:11], v[104:107]
  ds_read_b64_tr_b16 a[232:233], v234 offset:36864
  v_cvt_pk_bf16_f32 v7, v22, v23
  v_mfma_f32_16x16x32_bf16 v[104:107], a[248:251], a[24:27], v[104:107]
  ds_read_b64_tr_b16 a[234:235], v234 offset:38912
  v_mfma_f32_16x16x32_bf16 v[108:111], a[248:251], a[28:31], v[108:111]
  ds_read_b64_tr_b16 a[236:237], v235 offset:36864
  v_mfma_f32_16x16x32_bf16 v[108:111], a[200:203], a[12:15], v[108:111]
  ds_read_b64_tr_b16 a[238:239], v235 offset:38912
  v_mfma_f32_16x16x32_bf16 v[124:127], a[204:207], a[12:15], v[124:127]
  buffer_store_dwordx4 v[4:7], v217, s[36:39], s50 offen offset:1024 sc1
  v_mfma_f32_16x16x32_bf16 v[124:127], a[252:255], a[28:31], v[124:127]
  v_mfma_f32_16x16x32_bf16 v[120:123], a[252:255], a[24:27], v[120:123]
  v_mfma_f32_16x16x32_bf16 v[120:123], a[204:207], a[8:11], v[120:123]
  v_mfma_f32_16x16x32_bf16 v[116:119], a[204:207], a[4:7], v[116:119]
  v_mfma_f32_16x16x32_bf16 v[116:119], a[252:255], a[20:23], v[116:119]
  v_mfma_f32_16x16x32_bf16 v[112:115], a[252:255], a[16:19], v[112:115]
  v_mfma_f32_16x16x32_bf16 v[112:115], a[204:207], a[0:3], v[112:115]
  s_waitcnt lgkmcnt(14)
  v_mfma_f32_16x16x32_bf16 v[64:67], a[208:211], a[32:35], v[64:67]
  s_waitcnt vmcnt(14)
  s_waitcnt lgkmcnt(6)
  ds_read_b64_tr_b16 a[192:193], v232 offset:0
  v_mfma_f32_16x16x32_bf16 v[64:67], a[224:227], a[48:51], v[64:67]
  ds_read_b64_tr_b16 a[194:195], v232 offset:2048
  v_cvt_pk_bf16_f32 v8, v8, v9
  v_mfma_f32_16x16x32_bf16 v[68:71], a[224:227], a[52:55], v[68:71]
  ds_read_b64_tr_b16 a[196:197], v233 offset:0
  v_cvt_pk_bf16_f32 v9, v10, v11
  v_mfma_f32_16x16x32_bf16 v[68:71], a[208:211], a[36:39], v[68:71]
  ds_read_b64_tr_b16 a[198:199], v233 offset:2048
  v_cvt_pk_bf16_f32 v10, v24, v25
  v_mfma_f32_16x16x32_bf16 v[72:75], a[208:211], a[40:43], v[72:75]
  ds_read_b64_tr_b16 a[200:201], v234 offset:0
  v_cvt_pk_bf16_f32 v11, v26, v27
  v_mfma_f32_16x16x32_bf16 v[72:75], a[224:227], a[56:59], v[72:75]
  ds_read_b64_tr_b16 a[202:203], v234 offset:2048
  v_mfma_f32_16x16x32_bf16 v[76:79], a[224:227], a[60:63], v[76:79]
  ds_read_b64_tr_b16 a[204:205], v235 offset:0
  v_mfma_f32_16x16x32_bf16 v[76:79], a[208:211], a[44:47], v[76:79]
  ds_read_b64_tr_b16 a[206:207], v235 offset:2048
  v_mfma_f32_16x16x32_bf16 v[92:95], a[212:215], a[44:47], v[92:95]
  s_waitcnt lgkmcnt(12)
  buffer_store_dwordx4 v[8:11], v217, s[36:39], s50 offen offset:2048 sc1
  v_mfma_f32_16x16x32_bf16 v[92:95], a[228:231], a[60:63], v[92:95]
  v_mfma_f32_16x16x32_bf16 v[88:91], a[228:231], a[56:59], v[88:91]
  v_mfma_f32_16x16x32_bf16 v[88:91], a[212:215], a[40:43], v[88:91]
  v_mfma_f32_16x16x32_bf16 v[84:87], a[212:215], a[36:39], v[84:87]
  v_mfma_f32_16x16x32_bf16 v[84:87], a[228:231], a[52:55], v[84:87]
  v_mfma_f32_16x16x32_bf16 v[80:83], a[228:231], a[48:51], v[80:83]
  v_mfma_f32_16x16x32_bf16 v[80:83], a[212:215], a[32:35], v[80:83]
  v_mfma_f32_16x16x32_bf16 v[96:99], a[216:219], a[32:35], v[96:99]
  s_waitcnt vmcnt(11)
  s_waitcnt lgkmcnt(10)
  ds_read_b64_tr_b16 a[240:241], v232 offset:4096
  v_mfma_f32_16x16x32_bf16 v[96:99], a[232:235], a[48:51], v[96:99]
  ds_read_b64_tr_b16 a[242:243], v232 offset:6144
  v_cvt_pk_bf16_f32 v12, v12, v13
  v_mfma_f32_16x16x32_bf16 v[100:103], a[232:235], a[52:55], v[100:103]
  ds_read_b64_tr_b16 a[244:245], v233 offset:4096
  v_cvt_pk_bf16_f32 v13, v14, v15
  v_mfma_f32_16x16x32_bf16 v[100:103], a[216:219], a[36:39], v[100:103]
  ds_read_b64_tr_b16 a[246:247], v233 offset:6144
  v_cvt_pk_bf16_f32 v14, v28, v29
  v_mfma_f32_16x16x32_bf16 v[104:107], a[216:219], a[40:43], v[104:107]
  ds_read_b64_tr_b16 a[248:249], v234 offset:4096
  v_cvt_pk_bf16_f32 v15, v30, v31
  v_mfma_f32_16x16x32_bf16 v[104:107], a[232:235], a[56:59], v[104:107]
  ds_read_b64_tr_b16 a[250:251], v234 offset:6144
  v_mfma_f32_16x16x32_bf16 v[108:111], a[232:235], a[60:63], v[108:111]
  ds_read_b64_tr_b16 a[252:253], v235 offset:4096
  v_mfma_f32_16x16x32_bf16 v[108:111], a[216:219], a[44:47], v[108:111]
  ds_read_b64_tr_b16 a[254:255], v235 offset:6144
  v_mfma_f32_16x16x32_bf16 v[124:127], a[220:223], a[44:47], v[124:127]
  s_waitcnt lgkmcnt(15)
  buffer_store_dwordx4 v[12:15], v217, s[36:39], s50 offen offset:3072 sc1
  v_mfma_f32_16x16x32_bf16 v[124:127], a[236:239], a[60:63], v[124:127]
  v_mfma_f32_16x16x32_bf16 v[120:123], a[236:239], a[56:59], v[120:123]
  v_mfma_f32_16x16x32_bf16 v[120:123], a[220:223], a[40:43], v[120:123]
  v_mfma_f32_16x16x32_bf16 v[116:119], a[220:223], a[36:39], v[116:119]
  v_mfma_f32_16x16x32_bf16 v[116:119], a[236:239], a[52:55], v[116:119]
  v_mfma_f32_16x16x32_bf16 v[112:115], a[236:239], a[48:51], v[112:115]
  v_mfma_f32_16x16x32_bf16 v[112:115], a[220:223], a[32:35], v[112:115]
  s_waitcnt lgkmcnt(14)
  v_mfma_f32_16x16x32_bf16 v[64:67], a[192:195], a[64:67], v[64:67]
  s_waitcnt vmcnt(8)
  s_waitcnt lgkmcnt(6)
  ds_read_b64_tr_b16 a[208:209], v236 offset:0
  v_mfma_f32_16x16x32_bf16 v[64:67], a[240:243], a[80:83], v[64:67]
  ds_read_b64_tr_b16 a[210:211], v236 offset:2048
  v_cvt_pk_bf16_f32 v32, v32, v33
  v_mfma_f32_16x16x32_bf16 v[68:71], a[240:243], a[84:87], v[68:71]
  ds_read_b64_tr_b16 a[212:213], v237 offset:0
  v_cvt_pk_bf16_f32 v33, v34, v35
  v_mfma_f32_16x16x32_bf16 v[68:71], a[192:195], a[68:71], v[68:71]
  ds_read_b64_tr_b16 a[214:215], v237 offset:2048
  v_cvt_pk_bf16_f32 v34, v48, v49
  v_mfma_f32_16x16x32_bf16 v[72:75], a[192:195], a[72:75], v[72:75]
  ds_read_b64_tr_b16 a[216:217], v238 offset:0
  v_cvt_pk_bf16_f32 v35, v50, v51
  v_mfma_f32_16x16x32_bf16 v[72:75], a[240:243], a[88:91], v[72:75]
  ds_read_b64_tr_b16 a[218:219], v238 offset:2048
  v_mfma_f32_16x16x32_bf16 v[76:79], a[240:243], a[92:95], v[76:79]
  ds_read_b64_tr_b16 a[220:221], v239 offset:0
  v_mfma_f32_16x16x32_bf16 v[76:79], a[192:195], a[76:79], v[76:79]
  s_add_u32 s50, s56, 4096
  ds_read_b64_tr_b16 a[222:223], v239 offset:2048
  v_mfma_f32_16x16x32_bf16 v[92:95], a[196:199], a[76:79], v[92:95]
  s_waitcnt lgkmcnt(12)
  buffer_store_dwordx4 v[32:35], v219, s[36:39], s50 offen sc1
  v_mfma_f32_16x16x32_bf16 v[92:95], a[244:247], a[92:95], v[92:95]
  v_mfma_f32_16x16x32_bf16 v[88:91], a[244:247], a[88:91], v[88:91]
  v_mfma_f32_16x16x32_bf16 v[88:91], a[196:199], a[72:75], v[88:91]
  v_mfma_f32_16x16x32_bf16 v[84:87], a[196:199], a[68:71], v[84:87]
  v_mfma_f32_16x16x32_bf16 v[84:87], a[244:247], a[84:87], v[84:87]
  v_mfma_f32_16x16x32_bf16 v[80:83], a[244:247], a[80:83], v[80:83]
  v_mfma_f32_16x16x32_bf16 v[80:83], a[196:199], a[64:67], v[80:83]
  v_mfma_f32_16x16x32_bf16 v[96:99], a[200:203], a[64:67], v[96:99]
  s_waitcnt vmcnt(4)
  s_waitcnt lgkmcnt(10)
  ds_read_b64_tr_b16 a[224:225], v236 offset:4096
  v_mfma_f32_16x16x32_bf16 v[96:99], a[248:251], a[80:83], v[96:99]
  ds_read_b64_tr_b16 a[226:227], v236 offset:6144
  v_cvt_pk_bf16_f32 v36, v36, v37
  v_mfma_f32_16x16x32_bf16 v[100:103], a[248:251], a[84:87], v[100:103]
  ds_read_b64_tr_b16 a[228:229], v237 offset:4096
  v_cvt_pk_bf16_f32 v37, v38, v39
  v_mfma_f32_16x16x32_bf16 v[100:103], a[200:203], a[68:71], v[100:103]
  ds_read_b64_tr_b16 a[230:231], v237 offset:6144
  v_cvt_pk_bf16_f32 v38, v52, v53
  v_mfma_f32_16x16x32_bf16 v[104:107], a[200:203], a[72:75], v[104:107]
  ds_read_b64_tr_b16 a[232:233], v238 offset:4096
  v_cvt_pk_bf16_f32 v39, v54, v55
  v_mfma_f32_16x16x32_bf16 v[104:107], a[248:251], a[88:91], v[104:107]
  ds_read_b64_tr_b16 a[234:235], v238 offset:6144
  v_mfma_f32_16x16x32_bf16 v[108:111], a[248:251], a[92:95], v[108:111]
  ds_read_b64_tr_b16 a[236:237], v239 offset:4096
  v_mfma_f32_16x16x32_bf16 v[108:111], a[200:203], a[76:79], v[108:111]
L_hop12:
  s_cbranch_execz L_hop_done
  ds_read_b64_tr_b16 a[238:239], v239 offset:6144
  v_mfma_f32_16x16x32_bf16 v[124:127], a[204:207], a[76:79], v[124:127]
  s_waitcnt lgkmcnt(15)
  buffer_store_dwordx4 v[36:39], v219, s[36:39], s50 offen offset:1024 sc1
  v_mfma_f32_16x16x32_bf16 v[124:127], a[252:255], a[92:95], v[124:127]
  v_mfma_f32_16x16x32_bf16 v[120:123], a[252:255], a[88:91], v[120:123]
  v_mfma_f32_16x16x32_bf16 v[120:123], a[204:207], a[72:75], v[120:123]
  v_mfma_f32_16x16x32_bf16 v[116:119], a[204:207], a[68:71], v[116:119]
  v_mfma_f32_16x16x32_bf16 v[116:119], a[252:255], a[84:87], v[116:119]
  v_mfma_f32_16x16x32_bf16 v[112:115], a[252:255], a[80:83], v[112:115]
  v_mfma_f32_16x16x32_bf16 v[112:115], a[204:207], a[64:67], v[112:115]
  s_waitcnt lgkmcnt(14)
  v_mfma_f32_16x16x32_bf16 v[64:67], a[208:211], a[96:99], v[64:67]
  s_waitcnt lgkmcnt(6)
  v_mfma_f32_16x16x32_bf16 v[64:67], a[224:227], a[112:115], v[64:67]
  v_cvt_pk_bf16_f32 v40, v40, v41
  v_cvt_pk_bf16_f32 v41, v42, v43
  v_mfma_f32_16x16x32_bf16 v[68:71], a[224:227], a[116:119], v[68:71]
  v_cvt_pk_bf16_f32 v42, v56, v57
  v_cvt_pk_bf16_f32 v43, v58, v59
  v_mfma_f32_16x16x32_bf16 v[68:71], a[208:211], a[100:103], v[68:71]
  buffer_store_dwordx4 v[40:43], v219, s[36:39], s50 offen offset:2048 sc1
  v_mfma_f32_16x16x32_bf16 v[72:75], a[208:211], a[104:107], v[72:75]
  v_mfma_f32_16x16x32_bf16 v[72:75], a[224:227], a[120:123], v[72:75]
  v_mfma_f32_16x16x32_bf16 v[76:79], a[224:227], a[124:127], v[76:79]
  v_mfma_f32_16x16x32_bf16 v[76:79], a[208:211], a[108:111], v[76:79]
  v_mfma_f32_16x16x32_bf16 v[92:95], a[212:215], a[108:111], v[92:95]
  s_waitcnt lgkmcnt(4)
  v_mfma_f32_16x16x32_bf16 v[92:95], a[228:231], a[124:127], v[92:95]
  v_mfma_f32_16x16x32_bf16 v[88:91], a[228:231], a[120:123], v[88:91]
  v_mfma_f32_16x16x32_bf16 v[88:91], a[212:215], a[104:107], v[88:91]
  v_mfma_f32_16x16x32_bf16 v[84:87], a[212:215], a[100:103], v[84:87]
  v_mfma_f32_16x16x32_bf16 v[84:87], a[228:231], a[116:119], v[84:87]
  v_mfma_f32_16x16x32_bf16 v[80:83], a[228:231], a[112:115], v[80:83]
  v_mfma_f32_16x16x32_bf16 v[80:83], a[212:215], a[96:99], v[80:83]
  v_mfma_f32_16x16x32_bf16 v[96:99], a[216:219], a[96:99], v[96:99]
  s_waitcnt lgkmcnt(2)
  v_mfma_f32_16x16x32_bf16 v[96:99], a[232:235], a[112:115], v[96:99]
  v_cvt_pk_bf16_f32 v44, v44, v45
  v_cvt_pk_bf16_f32 v45, v46, v47
  v_mfma_f32_16x16x32_bf16 v[100:103], a[232:235], a[116:119], v[100:103]
  v_cvt_pk_bf16_f32 v46, v60, v61
  v_cvt_pk_bf16_f32 v47, v62, v63
  v_mfma_f32_16x16x32_bf16 v[100:103], a[216:219], a[100:103], v[100:103]
  buffer_store_dwordx4 v[44:47], v219, s[36:39], s50 offen offset:3072 sc1
  v_mfma_f32_16x16x32_bf16 v[104:107], a[216:219], a[104:107], v[104:107]
  v_mfma_f32_16x16x32_bf16 v[104:107], a[232:235], a[120:123], v[104:107]
  v_mfma_f32_16x16x32_bf16 v[108:111], a[232:235], a[124:127], v[108:111]
  v_mfma_f32_16x16x32_bf16 v[108:111], a[216:219], a[108:111], v[108:111]
  v_mfma_f32_16x16x32_bf16 v[124:127], a[220:223], a[108:111], v[124:127]
  s_waitcnt lgkmcnt(0)
  v_mfma_f32_16x16x32_bf16 v[124:127], a[236:239], a[124:127], v[124:127]
  v_mfma_f32_16x16x32_bf16 v[120:123], a[236:239], a[120:123], v[120:123]
  v_mfma_f32_16x16x32_bf16 v[120:123], a[220:223], a[104:107], v[120:123]
  v_mfma_f32_16x16x32_bf16 v[116:119], a[220:223], a[100:103], v[116:119]
  v_mfma_f32_16x16x32_bf16 v[116:119], a[236:239], a[116:119], v[116:119]
  v_mfma_f32_16x16x32_bf16 v[112:115], a[236:239], a[112:115], v[112:115]
  v_mfma_f32_16x16x32_bf16 v[112:115], a[220:223], a[96:99], v[112:115]
  s_add_u32 s50, s56, 8192
  v_cvt_pk_bf16_f32 v64, v64, v65
  v_cvt_pk_bf16_f32 v65, v66, v67
  v_cvt_pk_bf16_f32 v66, v80, v81
  v_cvt_pk_bf16_f32 v67, v82, v83
  buffer_store_dwordx4 v[64:67], v217, s[36:39], s50 offen sc1
  v_cvt_pk_bf16_f32 v68, v68, v69
  v_cvt_pk_bf16_f32 v69, v70, v71
  v_cvt_pk_bf16_f32 v70, v84, v85
  v_cvt_pk_bf16_f32 v71, v86, v87
  buffer_store_dwordx4 v[68:71], v217, s[36:39], s50 offen offset:1024 sc1
  v_cvt_pk_bf16_f32 v72, v72, v73
  v_cvt_pk_bf16_f32 v73, v74, v75
  v_cvt_pk_bf16_f32 v74, v88, v89
  v_cvt_pk_bf16_f32 v75, v90, v91
  buffer_store_dwordx4 v[72:75], v217, s[36:39], s50 offen offset:2048 sc1
  v_cvt_pk_bf16_f32 v76, v76, v77
  v_cvt_pk_bf16_f32 v77, v78, v79
  v_cvt_pk_bf16_f32 v78, v92, v93
  v_cvt_pk_bf16_f32 v79, v94, v95
  buffer_store_dwordx4 v[76:79], v217, s[36:39], s50 offen offset:3072 sc1
  s_add_u32 s50, s56, 12288
  v_cvt_pk_bf16_f32 v96, v96, v97
  v_cvt_pk_bf16_f32 v97, v98, v99
  v_cvt_pk_bf16_f32 v98, v112, v113
  v_cvt_pk_bf16_f32 v99, v114, v115
  buffer_store_dwordx4 v[96:99], v219, s[36:39], s50 offen sc1
  v_cvt_pk_bf16_f32 v100, v100, v101
  v_cvt_pk_bf16_f32 v101, v102, v103
  v_cvt_pk_bf16_f32 v102, v116, v117
  v_cvt_pk_bf16_f32 v103, v118, v119
  buffer_store_dwordx4 v[100:103], v219, s[36:39], s50 offen offset:1024 sc1
  v_cvt_pk_bf16_f32 v104, v104, v105
  v_cvt_pk_bf16_f32 v105, v106, v107
  v_cvt_pk_bf16_f32 v106, v120, v121
  v_cvt_pk_bf16_f32 v107, v122, v123
  buffer_store_dwordx4 v[104:107], v219, s[36:39], s50 offen offset:2048 sc1
  v_cvt_pk_bf16_f32 v108, v108, v109
  v_cvt_pk_bf16_f32 v109, v110, v111
  v_cvt_pk_bf16_f32 v110, v124, v125
  v_cvt_pk_bf16_f32 v111, v126, v127
  buffer_store_dwordx4 v[108:111], v219, s[36:39], s50 offen offset:3072 sc1
  buffer_load_dwordx4 v[24:27], v242, s[36:39], s81 offen sc1
  v_mfma_f32_16x16x32_bf16 v[200:203], v[192:195], v[128:131], 0
  v_mfma_f32_16x16x32_bf16 v[204:207], v[196:199], v[128:131], 0
  v_mfma_f32_16x16x32_bf16 v[208:211], v[192:195], v[132:135], 0
  v_mfma_f32_16x16x32_bf16 v[212:215], v[196:199], v[132:135], 0
  buffer_load_dwordx4 v[48:51], v242, s[36:39], s82 offen sc1
  v_mfma_f32_16x16x32_bf16 v[200:203], v[192:195], v[136:139], v[200:203]
  v_mfma_f32_16x16x32_bf16 v[204:207], v[196:199], v[136:139], v[204:207]
  v_mfma_f32_16x16x32_bf16 v[208:211], v[192:195], v[140:143], v[208:211]
  v_mfma_f32_16x16x32_bf16 v[212:215], v[196:199], v[140:143], v[212:215]
  buffer_load_dwordx4 v[56:59], v242, s[36:39], s83 offen sc1
  v_mfma_f32_16x16x32_bf16 v[200:203], v[192:195], v[144:147], v[200:203]
  v_mfma_f32_16x16x32_bf16 v[204:207], v[196:199], v[144:147], v[204:207]
  v_mfma_f32_16x16x32_bf16 v[208:211], v[192:195], v[148:151], v[208:211]
  v_mfma_f32_16x16x32_bf16 v[212:215], v[196:199], v[148:151], v[212:215]
  buffer_load_dwordx4 v[80:83], v242, s[36:39], s84 offen sc1
  v_mfma_f32_16x16x32_bf16 v[200:203], v[192:195], v[152:155], v[200:203]
  v_mfma_f32_16x16x32_bf16 v[204:207], v[196:199], v[152:155], v[204:207]
  v_mfma_f32_16x16x32_bf16 v[208:211], v[192:195], v[156:159], v[208:211]
  v_mfma_f32_16x16x32_bf16 v[212:215], v[196:199], v[156:159], v[212:215]
  buffer_load_dwordx4 v[88:91], v242, s[36:39], s85 offen sc1
  v_mfma_f32_16x16x32_bf16 v[200:203], v[192:195], v[160:163], v[200:203]
  v_mfma_f32_16x16x32_bf16 v[204:207], v[196:199], v[160:163], v[204:207]
  v_mfma_f32_16x16x32_bf16 v[208:211], v[192:195], v[164:167], v[208:211]
  v_mfma_f32_16x16x32_bf16 v[212:215], v[196:199], v[164:167], v[212:215]
  buffer_load_dwordx4 v[112:115], v242, s[36:39], s86 offen sc1
  v_mfma_f32_16x16x32_bf16 v[200:203], v[192:195], v[168:171], v[200:203]
  v_mfma_f32_16x16x32_bf16 v[204:207], v[196:199], v[168:171], v[204:207]
  v_mfma_f32_16x16x32_bf16 v[208:211], v[192:195], v[172:175], v[208:211]
  v_mfma_f32_16x16x32_bf16 v[212:215], v[196:199], v[172:175], v[212:215]
  buffer_load_dwordx4 v[120:123], v242, s[36:39], s87 offen sc1
  v_mfma_f32_16x16x32_bf16 v[200:203], v[192:195], v[176:179], v[200:203]
  v_mfma_f32_16x16x32_bf16 v[204:207], v[196:199], v[176:179], v[204:207]
  v_mfma_f32_16x16x32_bf16 v[208:211], v[192:195], v[180:183], v[208:211]
  v_mfma_f32_16x16x32_bf16 v[212:215], v[196:199], v[180:183], v[212:215]
  v_mfma_f32_16x16x32_bf16 v[200:203], v[192:195], v[184:187], v[200:203]
  v_mfma_f32_16x16x32_bf16 v[204:207], v[196:199], v[184:187], v[204:207]
  v_mfma_f32_16x16x32_bf16 v[208:211], v[192:195], v[188:191], v[208:211]
  v_mfma_f32_16x16x32_bf16 v[212:215], v[196:199], v[188:191], v[212:215]
  s_lshr_b32 s49, s40, 1
  s_cmp_lg_u32 s49, s42
  s_cbranch_scc1 L_nown
  s_bitcmp1_b32 s40, 0
  s_cbranch_scc1 L_own1
  ds_write_b128 v224, v[0:3] offset:0
  ds_write_b128 v224, v[4:7] offset:1024
  ds_write_b128 v224, v[8:11] offset:2048
  ds_write_b128 v224, v[12:15] offset:3072
  ds_write_b128 v224, v[64:67] offset:4096
  ds_write_b128 v224, v[68:71] offset:5120
  ds_write_b128 v224, v[72:75] offset:6144
  ds_write_b128 v224, v[76:79] offset:7168
  s_branch L_nown
L_own1:
  ds_write_b128 v224, v[32:35] offset:0
  ds_write_b128 v224, v[36:39] offset:1024
  ds_write_b128 v224, v[40:43] offset:2048
  ds_write_b128 v224, v[44:47] offset:3072
  ds_write_b128 v224, v[96:99] offset:4096
  ds_write_b128 v224, v[100:103] offset:5120
  ds_write_b128 v224, v[104:107] offset:6144
  ds_write_b128 v224, v[108:111] offset:7168
L_nown:
  s_mov_b32 s58, 65536
  s_nop 0
  v_mul_f32 v200, 0x40faf233, v200
  v_mul_f32 v201, 0x40faf233, v201
  v_mul_f32 v202, 0x40faf233, v202
  v_mul_f32 v203, 0x40faf233, v203
  v_mul_f32 v204, 0x40faf233, v204
  v_mul_f32 v205, 0x40faf233, v205
  v_mul_f32 v206, 0x40faf233, v206
  v_mul_f32 v207, 0x40faf233, v207
  v_mul_f32 v208, 0x40faf233, v208
  v_mul_f32 v209, 0x40faf233, v209
  v_mul_f32 v210, 0x40faf233, v210
  v_mul_f32 v211, 0x40faf233, v211
  v_mul_f32 v212, 0x40faf233, v212
  v_mul_f32 v213, 0x40faf233, v213
  v_mul_f32 v214, 0x40faf233, v214
  v_mul_f32 v215, 0x40faf233, v215
  v_mul_f32 v128, 0xbfb8aa3b, v200
  v_mul_f32 v129, 0xbfb8aa3b, v201
  v_mul_f32 v130, 0xbfb8aa3b, v202
  v_mul_f32 v131, 0xbfb8aa3b, v203
  v_mul_f32 v132, 0xbfb8aa3b, v204
  v_mul_f32 v133, 0xbfb8aa3b, v205
  v_mul_f32 v134, 0xbfb8aa3b, v206
  v_mul_f32 v135, 0xbfb8aa3b, v207
  v_mul_f32 v136, 0xbfb8aa3b, v208
  v_mul_f32 v137, 0xbfb8aa3b, v209
  v_mul_f32 v138, 0xbfb8aa3b, v210
  v_mul_f32 v139, 0xbfb8aa3b, v211
  v_mul_f32 v140, 0xbfb8aa3b, v212
  v_mul_f32 v141, 0xbfb8aa3b, v213
  v_mul_f32 v142, 0xbfb8aa3b, v214
  v_mul_f32 v143, 0xbfb8aa3b, v215
  v_exp_f32 v128, v128
  v_exp_f32 v129, v129
  v_exp_f32 v130, v130
  v_exp_f32 v131, v131
  v_exp_f32 v132, v132
  v_exp_f32 v133, v133
  v_exp_f32 v134, v134
  v_exp_f32 v135, v135
  v_exp_f32 v136, v136
  v_exp_f32 v137, v137
  v_exp_f32 v138, v138
  v_exp_f32 v139, v139
  v_exp_f32 v140, v140
  v_exp_f32 v141, v141
  v_exp_f32 v142, v142
  v_exp_f32 v143, v143
  v_add_f32 v128, 1.0, v128
  v_add_f32 v129, 1.0, v129
  v_add_f32 v130, 1.0, v130
  v_add_f32 v131, 1.0, v131
  v_add_f32 v132, 1.0, v132
  v_add_f32 v133, 1.0, v133
  v_add_f32 v134, 1.0, v134
  v_add_f32 v135, 1.0, v135
  v_add_f32 v136, 1.0, v136
  v_add_f32 v137, 1.0, v137
  v_add_f32 v138, 1.0, v138
  v_add_f32 v139, 1.0, v139
  v_add_f32 v140, 1.0, v140
  v_add_f32 v141, 1.0, v141
  v_add_f32 v142, 1.0, v142
  v_add_f32 v143, 1.0, v143
  v_rcp_f32 v128, v128
  v_rcp_f32 v129, v129
  v_rcp_f32 v130, v130
  v_rcp_f32 v131, v131
  v_rcp_f32 v132, v132
  v_rcp_f32 v133, v133
  v_rcp_f32 v134, v134
  v_rcp_f32 v135, v135
  v_rcp_f32 v136, v136
  v_rcp_f32 v137, v137
  v_rcp_f32 v138, v138
  v_rcp_f32 v139, v139
  v_rcp_f32 v140, v140
  v_rcp_f32 v141, v141
  v_rcp_f32 v142, v142
  v_rcp_f32 v143, v143
  v_mul_f32 v200, v200, v128
  v_mul_f32 v201, v201, v129
  v_mul_f32 v202, v202, v130
  v_mul_f32 v203, v203, v131
  v_mul_f32 v204, v204, v132
  v_mul_f32 v205, v205, v133
  v_mul_f32 v206, v206, v134
  v_mul_f32 v207, v207, v135
  v_mul_f32 v208, v208, v136
  v_mul_f32 v209, v209, v137
  v_mul_f32 v210, v210, v138
  v_mul_f32 v211, v211, v139
  v_mul_f32 v212, v212, v140
  v_mul_f32 v213, v213, v141
  v_mul_f32 v214, v214, v142
  v_mul_f32 v215, v215, v143
  v_lshlrev_b32 v144, 16, v248
  v_and_b32 v145, 0xffff0000, v248
  v_lshlrev_b32 v146, 16, v249
  v_and_b32 v147, 0xffff0000, v249
  v_lshlrev_b32 v148, 16, v250
  v_and_b32 v149, 0xffff0000, v250
  v_lshlrev_b32 v150, 16, v251
  v_and_b32 v151, 0xffff0000, v251
  v_lshlrev_b32 v152, 16, v252
  v_and_b32 v153, 0xffff0000, v252
  v_lshlrev_b32 v154, 16, v253
  v_and_b32 v155, 0xffff0000, v253
  v_lshlrev_b32 v156, 16, v254
  v_and_b32 v157, 0xffff0000, v254
  v_lshlrev_b32 v158, 16, v255
  v_and_b32 v159, 0xffff0000, v255
  s_waitcnt lgkmcnt(0)
  s_barrier
  ds_read_b128 v[16:19], v225
  ds_read_b128 v[20:23], v225 offset:4096
  buffer_load_dwordx4 v[28:31], v228, s[36:39], s81 offen sc1
  buffer_load_dwordx4 v[52:55], v228, s[36:39], s82 offen sc1
  buffer_load_dwordx4 v[60:63], v228, s[36:39], s83 offen sc1
  buffer_load_dwordx4 v[84:87], v228, s[36:39], s84 offen sc1
  buffer_load_dwordx4 v[92:95], v228, s[36:39], s85 offen sc1
  buffer_load_dwordx4 v[116:119], v228, s[36:39], s86 offen sc1
  buffer_load_dwordx4 v[124:127], v228, s[36:39], s87 offen sc1
  s_waitcnt vmcnt(0)
L_scheck:
  v_max3_u32 v220, v24, v25, v26
  v_max_u32 v220, v220, v27
  v_cmp_eq_u32 s[16:17], -1, v220
  v_max3_u32 v221, v28, v29, v30
  v_max_u32 v221, v221, v31
  v_cmp_eq_u32 s[18:19], -1, v221
  v_max3_u32 v220, v48, v49, v50
  v_max_u32 v220, v220, v51
  v_cmp_eq_u32 s[20:21], -1, v220
  v_max3_u32 v221, v52, v53, v54
  v_max_u32 v221, v221, v55
  v_cmp_eq_u32 s[22:23], -1, v221
  v_max3_u32 v220, v56, v57, v58
  v_max_u32 v220, v220, v59
  v_cmp_eq_u32 s[28:29], -1, v220
  v_max3_u32 v221, v60, v61, v62
  v_max_u32 v221, v221, v63
  v_cmp_eq_u32 s[30:31], -1, v221
  v_max3_u32 v220, v80, v81, v82
  v_max_u32 v220, v220, v83
  v_cmp_eq_u32 s[32:33], -1, v220
  v_max3_u32 v221, v84, v85, v86
  v_max_u32 v221, v221, v87
  v_cmp_eq_u32 s[34:35], -1, v221
  v_max3_u32 v220, v88, v89, v90
  v_max_u32 v220, v220, v91
  v_cmp_eq_u32 s[44:45], -1, v220
  v_max3_u32 v221, v92, v93, v94
  v_max_u32 v221, v221, v95
  v_cmp_eq_u32 s[64:65], -1, v221
  v_max3_u32 v220, v112, v113, v114
  v_max_u32 v220, v220, v115
  v_cmp_eq_u32 s[66:67], -1, v220
  v_max3_u32 v221, v116, v117, v118
  v_max_u32 v221, v221, v119
  v_cmp_eq_u32 s[68:69], -1, v221
  v_max3_u32 v220, v120, v121, v122
  v_max_u32 v220, v220, v123
  v_cmp_eq_u32 s[70:71], -1, v220
  v_max3_u32 v221, v124, v125, v126
  v_max_u32 v221, v221, v127
  v_cmp_eq_u32 s[76:77], -1, v221
  s_or_b64 vcc, s[16:17], s[18:19]
  s_or_b64 vcc, vcc, s[20:21]
  s_or_b64 vcc, vcc, s[22:23]
  s_or_b64 vcc, vcc, s[28:29]
  s_or_b64 vcc, vcc, s[30:31]
  s_or_b64 vcc, vcc, s[32:33]
  s_or_b64 vcc, vcc, s[34:35]
  s_or_b64 vcc, vcc, s[44:45]
  s_or_b64 vcc, vcc, s[64:65]
  s_or_b64 vcc, vcc, s[66:67]
  s_or_b64 vcc, vcc, s[68:69]
  s_or_b64 vcc, vcc, s[70:71]
  s_or_b64 vcc, vcc, s[76:77]
  s_cbranch_scc1 L_sagain
L_sok:
  s_waitcnt lgkmcnt(1)
  v_mfma_f32_16x16x32_bf16 v[160:163], v[192:195], v[16:19], 0
  v_mfma_f32_16x16x32_bf16 v[160:163], v[192:195], v[24:27], v[160:163]
  v_mfma_f32_16x16x32_bf16 v[160:163], v[192:195], v[48:51], v[160:163]
  v_mfma_f32_16x16x32_bf16 v[160:163], v[192:195], v[56:59], v[160:163]
  v_mfma_f32_16x16x32_bf16 v[160:163], v[192:195], v[80:83], v[160:163]
  v_mfma_f32_16x16x32_bf16 v[160:163], v[192:195], v[88:91], v[160:163]
  v_mfma_f32_16x16x32_bf16 v[160:163], v[192:195], v[112:115], v[160:163]
  v_mfma_f32_16x16x32_bf16 v[160:163], v[192:195], v[120:123], v[160:163]
  v_mfma_f32_16x16x32_bf16 v[164:167], v[196:199], v[16:19], 0
  v_mfma_f32_16x16x32_bf16 v[164:167], v[196:199], v[24:27], v[164:167]
  v_mfma_f32_16x16x32_bf16 v[164:167], v[196:199], v[48:51], v[164:167]
  v_mfma_f32_16x16x32_bf16 v[164:167], v[196:199], v[56:59], v[164:167]
  v_mfma_f32_16x16x32_bf16 v[164:167], v[196:199], v[80:83], v[164:167]
  v_mfma_f32_16x16x32_bf16 v[164:167], v[196:199], v[88:91], v[164:167]
  v_mfma_f32_16x16x32_bf16 v[164:167], v[196:199], v[112:115], v[164:167]
  v_mfma_f32_16x16x32_bf16 v[164:167], v[196:199], v[120:123], v[164:167]
  s_waitcnt lgkmcnt(0)
  v_mfma_f32_16x16x32_bf16 v[168:171], v[192:195], v[20:23], 0
  v_fma_f32 v160, v160, v200, v144
  v_fma_f32 v161, v161, v201, v145
  v_mfma_f32_16x16x32_bf16 v[168:171], v[192:195], v[28:31], v[168:171]
  v_fma_f32 v162, v162, v202, v146
  v_fma_f32 v163, v163, v203, v147
  v_mfma_f32_16x16x32_bf16 v[168:171], v[192:195], v[52:55], v[168:171]
  v_cvt_pk_bf16_f32 v176, v160, v161
  v_cvt_pk_bf16_f32 v177, v162, v163
  v_mfma_f32_16x16x32_bf16 v[168:171], v[192:195], v[60:63], v[168:171]
  v_mfma_f32_16x16x32_bf16 v[168:171], v[192:195], v[84:87], v[168:171]
  v_mfma_f32_16x16x32_bf16 v[168:171], v[192:195], v[92:95], v[168:171]
  v_mfma_f32_16x16x32_bf16 v[168:171], v[192:195], v[116:119], v[168:171]
  v_fma_f32 v164, v164, v204, v148
  v_fma_f32 v165, v165, v205, v149
  v_mfma_f32_16x16x32_bf16 v[168:171], v[192:195], v[124:127], v[168:171]
  v_fma_f32 v166, v166, v206, v150
  v_fma_f32 v167, v167, v207, v151
  v_mfma_f32_16x16x32_bf16 v[172:175], v[196:199], v[20:23], 0
  v_cvt_pk_bf16_f32 v178, v164, v165
  v_cvt_pk_bf16_f32 v179, v166, v167
  v_mfma_f32_16x16x32_bf16 v[172:175], v[196:199], v[28:31], v[172:175]
  buffer_store_dwordx4 v[176:179], v230, s[96:99], s75 offen
  v_mfma_f32_16x16x32_bf16 v[172:175], v[196:199], v[52:55], v[172:175]
  v_mfma_f32_16x16x32_bf16 v[172:175], v[196:199], v[60:63], v[172:175]
  v_mfma_f32_16x16x32_bf16 v[172:175], v[196:199], v[84:87], v[172:175]
  v_mfma_f32_16x16x32_bf16 v[172:175], v[196:199], v[92:95], v[172:175]
  v_mfma_f32_16x16x32_bf16 v[172:175], v[196:199], v[116:119], v[172:175]
  v_mfma_f32_16x16x32_bf16 v[172:175], v[196:199], v[124:127], v[172:175]
  v_fma_f32 v168, v168, v208, v152
  v_fma_f32 v169, v169, v209, v153
  v_fma_f32 v170, v170, v210, v154
  v_fma_f32 v171, v171, v211, v155
  v_cvt_pk_bf16_f32 v180, v168, v169
  v_cvt_pk_bf16_f32 v181, v170, v171
  s_nop 1
  v_fma_f32 v172, v172, v212, v156
  v_fma_f32 v173, v173, v213, v157
  v_fma_f32 v174, v174, v214, v158
  v_fma_f32 v175, v175, v215, v159
  v_cvt_pk_bf16_f32 v182, v172, v173
  v_cvt_pk_bf16_f32 v183, v174, v175
  buffer_store_dwordx4 v[180:183], v230, s[96:99], s75 offen offset:128
L_main_end:
  s_endpgm
L_hop_end:
L_sagain:
L_hop13:
  s_cbranch_execz L_hop_done
  s_sub_u32 s58, s58, 1
  s_cmp_eq_u32 s58, 0
  s_cbranch_scc1 L_sok
  s_mov_b64 exec, s[16:17]
  buffer_load_dwordx4 v[24:27], v242, s[36:39], s81 offen sc1
  s_mov_b64 exec, s[18:19]
  buffer_load_dwordx4 v[28:31], v228, s[36:39], s81 offen sc1
  s_mov_b64 exec, s[20:21]
  buffer_load_dwordx4 v[48:51], v242, s[36:39], s82 offen sc1
  s_mov_b64 exec, s[22:23]
  buffer_load_dwordx4 v[52:55], v228, s[36:39], s82 offen sc1
  s_mov_b64 exec, s[28:29]
  buffer_load_dwordx4 v[56:59], v242, s[36:39], s83 offen sc1
  s_mov_b64 exec, s[30:31]
  buffer_load_dwordx4 v[60:63], v228, s[36:39], s83 offen sc1
  s_mov_b64 exec, s[32:33]
  buffer_load_dwordx4 v[80:83], v242, s[36:39], s84 offen sc1
  s_mov_b64 exec, s[34:35]
  buffer_load_dwordx4 v[84:87], v228, s[36:39], s84 offen sc1
  s_mov_b64 exec, s[44:45]
  buffer_load_dwordx4 v[88:91], v242, s[36:39], s85 offen sc1
  s_mov_b64 exec, s[64:65]
  buffer_load_dwordx4 v[92:95], v228, s[36:39], s85 offen sc1
  s_mov_b64 exec, s[66:67]
  buffer_load_dwordx4 v[112:115], v242, s[36:39], s86 offen sc1
  s_mov_b64 exec, s[68:69]
  buffer_load_dwordx4 v[116:119], v228, s[36:39], s86 offen sc1
  s_mov_b64 exec, s[70:71]
  buffer_load_dwordx4 v[120:123], v242, s[36:39], s87 offen sc1
  s_mov_b64 exec, s[76:77]
  buffer_load_dwordx4 v[124:127], v228, s[36:39], s87 offen sc1
  s_mov_b64 exec, -1
  s_waitcnt vmcnt(0)
  s_branch L_scheck
L_redo:
  s_mov_b32 s55, 1
  s_mov_b32 s52, s57
  s_mov_b32 s58, 16
  s_mov_b32 s60, 16384
  v_mov_b32 v216, 0xff800000
  v_mov_b32 v217, 0xff800000
  v_mov_b32 v218, 0xff800000
  v_mov_b32 v219, 0xff800000
L_redo_blk:
  s_add_u32 m0, s53, 32768
  s_add_u32 s48, s52, 0
  buffer_load_dwordx4 v200, s[12:15], s48 offen lds
  buffer_load_dwordx4 v201, s[12:15], s48 offen offset:1024 lds
  buffer_load_dwordx4 v202, s[12:15], s48 offen offset:2048 lds
  buffer_load_dwordx4 v203, s[12:15], s48 offen offset:3072 lds
  s_add_u32 m0, s53, 36864
  s_add_u32 s48, s52, 4096
  buffer_load_dwordx4 v200, s[12:15], s48 offen lds
  buffer_load_dwordx4 v201, s[12:15], s48 offen offset:1024 lds
  buffer_load_dwordx4 v202, s[12:15], s48 offen offset:2048 lds
  buffer_load_dwordx4 v203, s[12:15], s48 offen offset:3072 lds
  s_waitcnt vmcnt(0)
  s_barrier
  ds_read_b128 a[192:195], v192 offset:32768
  ds_read_b128 a[196:199], v193 offset:32768
  ds_read_b128 a[200:203], v194 offset:32768
  ds_read_b128 a[204:207], v195 offset:32768
  s_waitcnt lgkmcnt(3)
  v_mfma_f32_16x16x32_bf16 v[128:131], a[192:195], a[128:131], 0
  s_waitcnt lgkmcnt(2)
  v_mfma_f32_16x16x32_bf16 v[128:131], a[196:199], a[132:135], v[128:131]
  s_waitcnt lgkmcnt(1)
  v_mfma_f32_16x16x32_bf16 v[128:131], a[200:203], a[136:139], v[128:131]
  s_waitcnt lgkmcnt(0)
  v_mfma_f32_16x16x32_bf16 v[128:131], a[204:207], a[140:143], v[128:131]
  v_mfma_f32_16x16x32_bf16 v[132:135], a[204:207], a[156:159], 0
  v_mfma_f32_16x16x32_bf16 v[132:135], a[200:203], a[152:155], v[132:135]
  v_mfma_f32_16x16x32_bf16 v[132:135], a[196:199], a[148:151], v[132:135]
  v_mfma_f32_16x16x32_bf16 v[132:135], a[192:195], a[144:147], v[132:135]
  v_mfma_f32_16x16x32_bf16 v[136:139], a[192:195], a[160:163], 0
  v_mfma_f32_16x16x32_bf16 v[136:139], a[196:199], a[164:167], v[136:139]
  v_mfma_f32_16x16x32_bf16 v[136:139], a[200:203], a[168:171], v[136:139]
  v_mfma_f32_16x16x32_bf16 v[136:139], a[204:207], a[172:175], v[136:139]
  v_mfma_f32_16x16x32_bf16 v[140:143], a[204:207], a[188:191], 0
  v_mfma_f32_16x16x32_bf16 v[140:143], a[200:203], a[184:187], v[140:143]
  v_mfma_f32_16x16x32_bf16 v[140:143], a[196:199], a[180:183], v[140:143]
  v_mfma_f32_16x16x32_bf16 v[140:143], a[192:195], a[176:179], v[140:143]
  v_max3_f32 v216, v216, v128, v129
  v_max3_f32 v216, v216, v130, v131
  v_max3_f32 v217, v217, v132, v133
  v_max3_f32 v217, v217, v134, v135
  v_max3_f32 v218, v218, v136, v137
  v_max3_f32 v218, v218, v138, v139
  s_nop 1
  v_max3_f32 v219, v219, v140, v141
  v_max3_f32 v219, v219, v142, v143
  ds_read_b128 a[192:195], v192 offset:36864
  ds_read_b128 a[196:199], v193 offset:36864
  ds_read_b128 a[200:203], v194 offset:36864
  ds_read_b128 a[204:207], v195 offset:36864
  s_waitcnt lgkmcnt(3)
  v_mfma_f32_16x16x32_bf16 v[128:131], a[192:195], a[128:131], 0
  s_waitcnt lgkmcnt(2)
  v_mfma_f32_16x16x32_bf16 v[128:131], a[196:199], a[132:135], v[128:131]
  s_waitcnt lgkmcnt(1)
  v_mfma_f32_16x16x32_bf16 v[128:131], a[200:203], a[136:139], v[128:131]
  s_waitcnt lgkmcnt(0)
  v_mfma_f32_16x16x32_bf16 v[128:131], a[204:207], a[140:143], v[128:131]
  v_mfma_f32_16x16x32_bf16 v[132:135], a[204:207], a[156:159], 0
  v_mfma_f32_16x16x32_bf16 v[132:135], a[200:203], a[152:155], v[132:135]
  v_mfma_f32_16x16x32_bf16 v[132:135], a[196:199], a[148:151], v[132:135]
  v_mfma_f32_16x16x32_bf16 v[132:135], a[192:195], a[144:147], v[132:135]
  v_mfma_f32_16x16x32_bf16 v[136:139], a[192:195], a[160:163], 0
  v_mfma_f32_16x16x32_bf16 v[136:139], a[196:199], a[164:167], v[136:139]
  v_mfma_f32_16x16x32_bf16 v[136:139], a[200:203], a[168:171], v[136:139]
  v_mfma_f32_16x16x32_bf16 v[136:139], a[204:207], a[172:175], v[136:139]
  v_mfma_f32_16x16x32_bf16 v[140:143], a[204:207], a[188:191], 0
  v_mfma_f32_16x16x32_bf16 v[140:143], a[200:203], a[184:187], v[140:143]
  v_mfma_f32_16x16x32_bf16 v[140:143], a[196:199], a[180:183], v[140:143]
  v_mfma_f32_16x16x32_bf16 v[140:143], a[192:195], a[176:179], v[140:143]
  v_max3_f32 v216, v216, v128, v129
  v_max3_f32 v216, v216, v130, v131
  v_max3_f32 v217, v217, v132, v133
  v_max3_f32 v217, v217, v134, v135
  v_max3_f32 v218, v218, v136, v137
  v_max3_f32 v218, v218, v138, v139
  s_nop 1
  v_max3_f32 v219, v219, v140, v141
  v_max3_f32 v219, v219, v142, v143
  ds_read_b128 a[192:195], v192 offset:40960
  ds_read_b128 a[196:199], v193 offset:40960
  ds_read_b128 a[200:203], v194 offset:40960
  ds_read_b128 a[204:207], v195 offset:40960
  s_waitcnt lgkmcnt(3)
  v_mfma_f32_16x16x32_bf16 v[128:131], a[192:195], a[128:131], 0
  s_waitcnt lgkmcnt(2)
  v_mfma_f32_16x16x32_bf16 v[128:131], a[196:199], a[132:135], v[128:131]
  s_waitcnt lgkmcnt(1)
  v_mfma_f32_16x16x32_bf16 v[128:131], a[200:203], a[136:139], v[128:131]
  s_waitcnt lgkmcnt(0)
  v_mfma_f32_16x16x32_bf16 v[128:131], a[204:207], a[140:143], v[128:131]
  v_mfma_f32_16x16x32_bf16 v[132:135], a[204:207], a[156:159], 0
  v_mfma_f32_16x16x32_bf16 v[132:135], a[200:203], a[152:155], v[132:135]
  v_mfma_f32_16x16x32_bf16 v[132:135], a[196:199], a[148:151], v[132:135]
  v_mfma_f32_16x16x32_bf16 v[132:135], a[192:195], a[144:147], v[132:135]
  v_mfma_f32_16x16x32_bf16 v[136:139], a[192:195], a[160:163], 0
  v_mfma_f32_16x16x32_bf16 v[136:139], a[196:199], a[164:167], v[136:139]
  v_mfma_f32_16x16x32_bf16 v[136:139], a[200:203], a[168:171], v[136:139]
  v_mfma_f32_16x16x32_bf16 v[136:139], a[204:207], a[172:175], v[136:139]
  v_mfma_f32_16x16x32_bf16 v[140:143], a[204:207], a[188:191], 0
  v_mfma_f32_16x16x32_bf16 v[140:143], a[200:203], a[184:187], v[140:143]
  v_mfma_f32_16x16x32_bf16 v[140:143], a[196:199], a[180:183], v[140:143]
  v_mfma_f32_16x16x32_bf16 v[140:143], a[192:195], a[176:179], v[140:143]
  v_max3_f32 v216, v216, v128, v129
  v_max3_f32 v216, v216, v130, v131
  v_max3_f32 v217, v217, v132, v133
  v_max3_f32 v217, v217, v134, v135
  v_max3_f32 v218, v218, v136, v137
  v_max3_f32 v218, v218, v138, v139
  s_nop 1
  v_max3_f32 v219, v219, v140, v141
  v_max3_f32 v219, v219, v142, v143
  ds_read_b128 a[192:195], v192 offset:45056
  ds_read_b128 a[196:199], v193 offset:45056
  ds_read_b128 a[200:203], v194 offset:45056
  ds_read_b128 a[204:207], v195 offset:45056
  s_waitcnt lgkmcnt(3)
  v_mfma_f32_16x16x32_bf16 v[128:131], a[192:195], a[128:131], 0
  s_waitcnt lgkmcnt(2)
  v_mfma_f32_16x16x32_bf16 v[128:131], a[196:199], a[132:135], v[128:131]
  s_waitcnt lgkmcnt(1)
  v_mfma_f32_16x16x32_bf16 v[128:131], a[200:203], a[136:139], v[128:131]
  s_waitcnt lgkmcnt(0)
  v_mfma_f32_16x16x32_bf16 v[128:131], a[204:207], a[140:143], v[128:131]
  v_mfma_f32_16x16x32_bf16 v[132:135], a[204:207], a[156:159], 0
  v_mfma_f32_16x16x32_bf16 v[132:135], a[200:203], a[152:155], v[132:135]
  v_mfma_f32_16x16x32_bf16 v[132:135], a[196:199], a[148:151], v[132:135]
  v_mfma_f32_16x16x32_bf16 v[132:135], a[192:195], a[144:147], v[132:135]
  v_mfma_f32_16x16x32_bf16 v[136:139], a[192:195], a[160:163], 0
  v_mfma_f32_16x16x32_bf16 v[136:139], a[196:199], a[164:167], v[136:139]
  v_mfma_f32_16x16x32_bf16 v[136:139], a[200:203], a[168:171], v[136:139]
  v_mfma_f32_16x16x32_bf16 v[136:139], a[204:207], a[172:175], v[136:139]
  v_mfma_f32_16x16x32_bf16 v[140:143], a[204:207], a[188:191], 0
  v_mfma_f32_16x16x32_bf16 v[140:143], a[200:203], a[184:187], v[140:143]
  v_mfma_f32_16x16x32_bf16 v[140:143], a[196:199], a[180:183], v[140:143]
  v_mfma_f32_16x16x32_bf16 v[140:143], a[192:195], a[176:179], v[140:143]
  v_max3_f32 v216, v216, v128, v129
  v_max3_f32 v216, v216, v130, v131
  v_max3_f32 v217, v217, v132, v133
  v_max3_f32 v217, v217, v134, v135
  v_max3_f32 v218, v218, v136, v137
  v_max3_f32 v218, v218, v138, v139
  s_nop 1
  v_max3_f32 v219, v219, v140, v141
  v_max3_f32 v219, v219, v142, v143
  ds_read_b128 a[192:195], v192 offset:49152
  ds_read_b128 a[196:199], v193 offset:49152
  ds_read_b128 a[200:203], v194 offset:49152
  ds_read_b128 a[204:207], v195 offset:49152
  s_waitcnt lgkmcnt(3)
  v_mfma_f32_16x16x32_bf16 v[128:131], a[192:195], a[128:131], 0
  s_waitcnt lgkmcnt(2)
  v_mfma_f32_16x16x32_bf16 v[128:131], a[196:199], a[132:135], v[128:131]
  s_waitcnt lgkmcnt(1)
  v_mfma_f32_16x16x32_bf16 v[128:131], a[200:203], a[136:139], v[128:131]
  s_waitcnt lgkmcnt(0)
  v_mfma_f32_16x16x32_bf16 v[128:131], a[204:207], a[140:143], v[128:131]
  v_mfma_f32_16x16x32_bf16 v[132:135], a[204:207], a[156:159], 0
  v_mfma_f32_16x16x32_bf16 v[132:135], a[200:203], a[152:155], v[132:135]
  v_mfma_f32_16x16x32_bf16 v[132:135], a[196:199], a[148:151], v[132:135]
  v_mfma_f32_16x16x32_bf16 v[132:135], a[192:195], a[144:147], v[132:135]
  v_mfma_f32_16x16x32_bf16 v[136:139], a[192:195], a[160:163], 0
  v_mfma_f32_16x16x32_bf16 v[136:139], a[196:199], a[164:167], v[136:139]
  v_mfma_f32_16x16x32_bf16 v[136:139], a[200:203], a[168:171], v[136:139]
  v_mfma_f32_16x16x32_bf16 v[136:139], a[204:207], a[172:175], v[136:139]
  v_mfma_f32_16x16x32_bf16 v[140:143], a[204:207], a[188:191], 0
  v_mfma_f32_16x16x32_bf16 v[140:143], a[200:203], a[184:187], v[140:143]
  v_mfma_f32_16x16x32_bf16 v[140:143], a[196:199], a[180:183], v[140:143]
  v_mfma_f32_16x16x32_bf16 v[140:143], a[192:195], a[176:179], v[140:143]
  v_max3_f32 v216, v216, v128, v129
  v_max3_f32 v216, v216, v130, v131
  v_max3_f32 v217, v217, v132, v133
  v_max3_f32 v217, v217, v134, v135
  v_max3_f32 v218, v218, v136, v137
  v_max3_f32 v218, v218, v138, v139
  s_nop 1
  v_max3_f32 v219, v219, v140, v141
  v_max3_f32 v219, v219, v142, v143
  ds_read_b128 a[192:195], v192 offset:53248
  ds_read_b128 a[196:199], v193 offset:53248
  ds_read_b128 a[200:203], v194 offset:53248
  ds_read_b128 a[204:207], v195 offset:53248
  s_waitcnt lgkmcnt(3)
  v_mfma_f32_16x16x32_bf16 v[128:131], a[192:195], a[128:131], 0
  s_waitcnt lgkmcnt(2)
  v_mfma_f32_16x16x32_bf16 v[128:131], a[196:199], a[132:135], v[128:131]
  s_waitcnt lgkmcnt(1)
  v_mfma_f32_16x16x32_bf16 v[128:131], a[200:203], a[136:139], v[128:131]
  s_waitcnt lgkmcnt(0)
  v_mfma_f32_16x16x32_bf16 v[128:131], a[204:207], a[140:143], v[128:131]
  v_mfma_f32_16x16x32_bf16 v[132:135], a[204:207], a[156:159], 0
  v_mfma_f32_16x16x32_bf16 v[132:135], a[200:203], a[152:155], v[132:135]
  v_mfma_f32_16x16x32_bf16 v[132:135], a[196:199], a[148:151], v[132:135]
  v_mfma_f32_16x16x32_bf16 v[132:135], a[192:195], a[144:147], v[132:135]
  v_mfma_f32_16x16x32_bf16 v[136:139], a[192:195], a[160:163], 0
  v_mfma_f32_16x16x32_bf16 v[136:139], a[196:199], a[164:167], v[136:139]
  v_mfma_f32_16x16x32_bf16 v[136:139], a[200:203], a[168:171], v[136:139]
  v_mfma_f32_16x16x32_bf16 v[136:139], a[204:207], a[172:175], v[136:139]
  v_mfma_f32_16x16x32_bf16 v[140:143], a[204:207], a[188:191], 0
  v_mfma_f32_16x16x32_bf16 v[140:143], a[200:203], a[184:187], v[140:143]
  v_mfma_f32_16x16x32_bf16 v[140:143], a[196:199], a[180:183], v[140:143]
  v_mfma_f32_16x16x32_bf16 v[140:143], a[192:195], a[176:179], v[140:143]
  v_max3_f32 v216, v216, v128, v129
  v_max3_f32 v216, v216, v130, v131
  v_max3_f32 v217, v217, v132, v133
  v_max3_f32 v217, v217, v134, v135
  v_max3_f32 v218, v218, v136, v137
  v_max3_f32 v218, v218, v138, v139
  s_nop 1
  v_max3_f32 v219, v219, v140, v141
  v_max3_f32 v219, v219, v142, v143
  ds_read_b128 a[192:195], v192 offset:57344
  ds_read_b128 a[196:199], v193 offset:57344
  ds_read_b128 a[200:203], v194 offset:57344
  ds_read_b128 a[204:207], v195 offset:57344
  s_waitcnt lgkmcnt(3)
  v_mfma_f32_16x16x32_bf16 v[128:131], a[192:195], a[128:131], 0
  s_waitcnt lgkmcnt(2)
  v_mfma_f32_16x16x32_bf16 v[128:131], a[196:199], a[132:135], v[128:131]
  s_waitcnt lgkmcnt(1)
  v_mfma_f32_16x16x32_bf16 v[128:131], a[200:203], a[136:139], v[128:131]
  s_waitcnt lgkmcnt(0)
  v_mfma_f32_16x16x32_bf16 v[128:131], a[204:207], a[140:143], v[128:131]
  v_mfma_f32_16x16x32_bf16 v[132:135], a[204:207], a[156:159], 0
  v_mfma_f32_16x16x32_bf16 v[132:135], a[200:203], a[152:155], v[132:135]
  v_mfma_f32_16x16x32_bf16 v[132:135], a[196:199], a[148:151], v[132:135]
  v_mfma_f32_16x16x32_bf16 v[132:135], a[192:195], a[144:147], v[132:135]
  v_mfma_f32_16x16x32_bf16 v[136:139], a[192:195], a[160:163], 0
  v_mfma_f32_16x16x32_bf16 v[136:139], a[196:199], a[164:167], v[136:139]
  v_mfma_f32_16x16x32_bf16 v[136:139], a[200:203], a[168:171], v[136:139]
  v_mfma_f32_16x16x32_bf16 v[136:139], a[204:207], a[172:175], v[136:139]
  v_mfma_f32_16x16x32_bf16 v[140:143], a[204:207], a[188:191], 0
  v_mfma_f32_16x16x32_bf16 v[140:143], a[200:203], a[184:187], v[140:143]
  v_mfma_f32_16x16x32_bf16 v[140:143], a[196:199], a[180:183], v[140:143]
  v_mfma_f32_16x16x32_bf16 v[140:143], a[192:195], a[176:179], v[140:143]
  v_max3_f32 v216, v216, v128, v129
  v_max3_f32 v216, v216, v130, v131
  v_max3_f32 v217, v217, v132, v133
  v_max3_f32 v217, v217, v134, v135
  v_max3_f32 v218, v218, v136, v137
  v_max3_f32 v218, v218, v138, v139
  s_nop 1
  v_max3_f32 v219, v219, v140, v141
  v_max3_f32 v219, v219, v142, v143
  ds_read_b128 a[192:195], v192 offset:61440
  ds_read_b128 a[196:199], v193 offset:61440
  ds_read_b128 a[200:203], v194 offset:61440
  ds_read_b128 a[204:207], v195 offset:61440
  s_waitcnt lgkmcnt(3)
  v_mfma_f32_16x16x32_bf16 v[128:131], a[192:195], a[128:131], 0
  s_waitcnt lgkmcnt(2)
  v_mfma_f32_16x16x32_bf16 v[128:131], a[196:199], a[132:135], v[128:131]
  s_waitcnt lgkmcnt(1)
  v_mfma_f32_16x16x32_bf16 v[128:131], a[200:203], a[136:139], v[128:131]
  s_waitcnt lgkmcnt(0)
  v_mfma_f32_16x16x32_bf16 v[128:131], a[204:207], a[140:143], v[128:131]
  v_mfma_f32_16x16x32_bf16 v[132:135], a[204:207], a[156:159], 0
  v_mfma_f32_16x16x32_bf16 v[132:135], a[200:203], a[152:155], v[132:135]
  v_mfma_f32_16x16x32_bf16 v[132:135], a[196:199], a[148:151], v[132:135]
  v_mfma_f32_16x16x32_bf16 v[132:135], a[192:195], a[144:147], v[132:135]
  v_mfma_f32_16x16x32_bf16 v[136:139], a[192:195], a[160:163], 0
  v_mfma_f32_16x16x32_bf16 v[136:139], a[196:199], a[164:167], v[136:139]
  v_mfma_f32_16x16x32_bf16 v[136:139], a[200:203], a[168:171], v[136:139]
  v_mfma_f32_16x16x32_bf16 v[136:139], a[204:207], a[172:175], v[136:139]
  v_mfma_f32_16x16x32_bf16 v[140:143], a[204:207], a[188:191], 0
  v_mfma_f32_16x16x32_bf16 v[140:143], a[200:203], a[184:187], v[140:143]
  v_mfma_f32_16x16x32_bf16 v[140:143], a[196:199], a[180:183], v[140:143]
  v_mfma_f32_16x16x32_bf16 v[140:143], a[192:195], a[176:179], v[140:143]
  v_max3_f32 v216, v216, v128, v129
  v_max3_f32 v216, v216, v130, v131
  v_max3_f32 v217, v217, v132, v133
  v_max3_f32 v217, v217, v134, v135
  v_max3_f32 v218, v218, v136, v137
  v_max3_f32 v218, v218, v138, v139
  s_nop 1
  v_max3_f32 v219, v219, v140, v141
  v_max3_f32 v219, v219, v142, v143
  s_barrier
  s_add_u32 s52, s52, 32768
  s_sub_u32 s58, s58, 1
  s_cmp_lg_u32 s58, 0
  s_cbranch_scc1 L_redo_blk
  v_mov_b32 v220, v216
  v_mov_b32 v221, v217
  v_mov_b32 v222, v218
  v_mov_b32 v223, v219
  v_permlane32_swap_b32 v216, v220
  v_permlane32_swap_b32 v217, v221
  v_permlane32_swap_b32 v218, v222
  v_permlane32_swap_b32 v219, v223
  v_max_f32 v216, v216, v220
  v_max_f32 v217, v217, v221
  v_max_f32 v218, v218, v222
  v_max_f32 v219, v219, v223
  v_mov_b32 v220, v216
  v_mov_b32 v221, v217
  v_mov_b32 v222, v218
  v_mov_b32 v223, v219
  v_permlane16_swap_b32 v216, v220
  v_permlane16_swap_b32 v217, v221
  v_permlane16_swap_b32 v218, v222
  v_permlane16_swap_b32 v219, v223
  v_max_f32 v216, v216, v220
  v_max_f32 v217, v217, v221
  v_max_f32 v218, v218, v222
  v_max_f32 v219, v219, v223
  v_sub_f32 v160, 0, v216
  v_sub_f32 v161, 0, v216
  v_sub_f32 v162, 0, v216
  v_sub_f32 v163, 0, v216
  v_sub_f32 v164, 0, v217
  v_sub_f32 v165, 0, v217
  v_sub_f32 v166, 0, v217
  v_sub_f32 v167, 0, v217
  v_sub_f32 v168, 0, v218
  v_sub_f32 v169, 0, v218
  v_sub_f32 v170, 0, v218
  v_sub_f32 v171, 0, v218
  v_sub_f32 v172, 0, v219
  v_sub_f32 v173, 0, v219
  v_sub_f32 v174, 0, v219
  v_sub_f32 v175, 0, v219
  v_accvgpr_write_b32 a112, 0
  v_accvgpr_write_b32 a113, 0
  v_accvgpr_write_b32 a114, 0
  v_accvgpr_write_b32 a115, 0
  v_accvgpr_write_b32 a116, 0
  v_accvgpr_write_b32 a117, 0
  v_accvgpr_write_b32 a118, 0
  v_accvgpr_write_b32 a119, 0
  v_accvgpr_write_b32 a120, 0
  v_accvgpr_write_b32 a121, 0
  v_accvgpr_write_b32 a122, 0
  v_accvgpr_write_b32 a123, 0
  v_accvgpr_write_b32 a124, 0
  v_accvgpr_write_b32 a125, 0
  v_accvgpr_write_b32 a126, 0
  v_accvgpr_write_b32 a127, 0
  s_mov_b32 s52, s57
  s_add_u32 m0, s53, 32768
  s_add_u32 s48, s52, 0
  buffer_load_dwordx4 v200, s[12:15], s48 offen lds
  buffer_load_dwordx4 v201, s[12:15], s48 offen offset:1024 lds
  buffer_load_dwordx4 v202, s[12:15], s48 offen offset:2048 lds
  buffer_load_dwordx4 v203, s[12:15], s48 offen offset:3072 lds
  s_add_u32 m0, s53, 0
  s_add_u32 s48, s52, 32768
  buffer_load_dwordx4 v200, s[12:15], s48 offen lds
  buffer_load_dwordx4 v201, s[12:15], s48 offen offset:1024 lds
  buffer_load_dwordx4 v202, s[12:15], s48 offen offset:2048 lds
  buffer_load_dwordx4 v203, s[12:15], s48 offen offset:3072 lds
  s_add_u32 m0, s43, 0
  s_add_u32 s48, s47, 0
  buffer_load_dwordx4 v243, s[24:27], s48 offen lds
  buffer_load_dwordx4 v244, s[24:27], s48 offen offset:1024 lds
  buffer_load_dwordx4 v245, s[24:27], s48 offen offset:2048 lds
  buffer_load_dwordx4 v246, s[24:27], s48 offen offset:3072 lds
  s_add_u32 m0, s53, 36864
  s_add_u32 s48, s52, 4096
  buffer_load_dwordx4 v200, s[12:15], s48 offen lds
  buffer_load_dwordx4 v201, s[12:15], s48 offen offset:1024 lds
  buffer_load_dwordx4 v202, s[12:15], s48 offen offset:2048 lds
  buffer_load_dwordx4 v203, s[12:15], s48 offen offset:3072 lds
  s_add_u32 m0, s53, 4096
  s_add_u32 s48, s52, 36864
  buffer_load_dwordx4 v200, s[12:15], s48 offen lds
  buffer_load_dwordx4 v201, s[12:15], s48 offen offset:1024 lds
  buffer_load_dwordx4 v202, s[12:15], s48 offen offset:2048 lds
  buffer_load_dwordx4 v203, s[12:15], s48 offen offset:3072 lds
  s_add_u32 m0, s43, 4096
  s_add_u32 s48, s47, 32768
  buffer_load_dwordx4 v243, s[24:27], s48 offen lds
  buffer_load_dwordx4 v244, s[24:27], s48 offen offset:1024 lds
  buffer_load_dwordx4 v245, s[24:27], s48 offen offset:2048 lds
  buffer_load_dwordx4 v246, s[24:27], s48 offen offset:3072 lds
  s_waitcnt vmcnt(0)
  s_barrier
  ds_read_b128 a[192:195], v192 offset:32768
  ds_read_b128 a[196:199], v193 offset:32768
  ds_read_b128 a[200:203], v194 offset:32768
  ds_read_b128 a[204:207], v195 offset:32768
  v_mov_b32 v207, 1073741824
  v_mov_b32 v229, 1073741824
  s_waitcnt lgkmcnt(0)
  s_branch L_attn
L_ywait:
  s_mov_b32 s58, 65536
L_ywait_loop:
  s_sleep 2
  buffer_load_dword v224, off, s[4:7], s59 sc1
  s_waitcnt vmcnt(0)
  v_readfirstlane_b32 s50, v224
  s_sub_u32 s58, s58, 1
  s_cmp_eq_u32 s58, 0
  s_cbranch_scc1 L_yok
  s_cmp_lt_u32 s50, 8
  s_cbranch_scc1 L_ywait_loop
  s_branch L_yok
L_code_end:
  s_endpgm
.section .rodata,"a"
.p2align 6
.amdhsa_kernel recurrent_scan__gqa_block_cached__dense_activation_relu__prompt_kernel
  .amdhsa_next_free_vgpr 512
  .amdhsa_next_free_sgpr 100
  .amdhsa_accum_offset 256
  .amdhsa_group_segment_fixed_size 0
  .amdhsa_kernarg_size 88
  .amdhsa_user_sgpr_count 2
  .amdhsa_user_sgpr_kernarg_segment_ptr 1
  .amdhsa_system_sgpr_workgroup_id_x 1
  .amdhsa_float_denorm_mode_32 3
.end_amdhsa_kernel
```
